```python
import torch

def _softmax(x, axis=-1):
    return torch.softmax(x, dim=axis)
def _gelu(x):
    return torch.nn.functional.gelu(x, approximate="tanh")
def _silu(x):
    return torch.nn.functional.silu(x)
def _sigmoid(x):
    return torch.sigmoid(x)
def _layernorm(x, axis=-1, eps=1e-5):
    m = x.mean(dim=axis, keepdim=True)
    v = x.var(dim=axis, keepdim=True, unbiased=False)
    return (x - m) / torch.sqrt(v + eps)
def _scatter_add(tgt, idx, src, axis=0):
    return tgt.clone().index_add_(axis, idx, src)
def _segment_sum(src, seg, n):
    out = torch.zeros((n,) + src.shape[1:], dtype=src.dtype)
    return out.index_add_(0, seg, src)
def _pad(x, pw):
    flat = tuple(v for pair in reversed(pw) for v in pair)
    return torch.nn.functional.pad(x, flat)

kernel_name = 'interleave_layers__spectral_gfnet__dense_activation_gelu__prompt'

def setup_inputs():

    _w = (lambda a: (lambda t: t.to(torch.bfloat16) if t.is_floating_point() else t)(torch.as_tensor(a)))
    def _A_setup():
        B, S, D = 1, 2048, 512
        Df = D // 2 + 1
        return {
            "x": _w((lambda *s: torch.randn(*s, dtype=torch.bfloat16) * 0.05)(B, S, D)),
            "w_r": _w((lambda *s: torch.randn(*s, dtype=torch.bfloat16) * 0.4)(S, Df) * 0.02),
            "w_i": _w((lambda *s: torch.randn(*s, dtype=torch.bfloat16) * 0.4)(S, Df) * 0.02),
        }
    _A_in = _A_setup()

    def _B_setup():
        B, S, D, F = 1, 2048, 512, 1792
        return {
            "x": _w((lambda *s: torch.randn(*s, dtype=torch.bfloat16) * 0.05)(B, S, D)),
            "w1": _w((lambda *s: torch.randn(*s, dtype=torch.bfloat16) * 0.4)(D, F) * (D ** -0.5)),
            "b1": _w((lambda *s: torch.randn(*s, dtype=torch.bfloat16) * 12.8)(F) * 0.01),
            "w2": _w((lambda *s: torch.randn(*s, dtype=torch.bfloat16) * 0.1)(F, D) * (F ** -0.5)),
            "b2": _w((lambda *s: torch.randn(*s, dtype=torch.bfloat16) * 0.8)(D) * 0.01),
        }
    _B_in = _B_setup()

    return {
        "A_x": _A_in["x"],
        "A_w_r": _A_in["w_r"],
        "A_w_i": _A_in["w_i"],
        "B_x": _B_in["x"],
        "B_w1": _B_in["w1"],
        "B_b1": _B_in["b1"],
        "B_w2": _B_in["w2"],
        "B_b2": _B_in["b2"],
    }

def reference(A_x, A_w_r, A_w_i, B_x, B_w1, B_b1, B_w2, B_b2):
    def _A_ref(x, w_r, w_i):
        B, S, D = x.shape
        X = (lambda x, axes=(-2,-1): torch.fft.rfft2(x.float(), dim=axes))(x, axes=(-2, -1))
        W = w_r + 1j * w_i
        X = X * W
        y = (lambda x, s, axes=(-2,-1): torch.fft.irfft2(x, s=s, dim=axes).to(torch.bfloat16))(X, (S, D), axes=(-2, -1))
        return y

    def _B_ref(x, w1, b1, w2, b2):
        h = torch.einsum("bsd,df->bsf", x, w1) + b1
        h = _gelu(h)
        return torch.einsum("bsf,fd->bsd", h, w2) + b2

    x = A_x
    x = x + _A_ref(_layernorm(x, axis=-1), A_w_r, A_w_i)
    x = x + _B_ref(_layernorm(x, axis=-1), B_w1, B_b1, B_w2, B_b2)
    x = x + _A_ref(_layernorm(x, axis=-1), A_w_r, A_w_i)
    x = x + _B_ref(_layernorm(x, axis=-1), B_w1, B_b1, B_w2, B_b2)
    return x
```

```asm
; @launch kernel=p1a_kernel grid=(512,1,1) block=(512,1,1) lds=65536
; @launch kernel=p2_kernel grid=(257,1,1) block=(256,1,1) lds=49152
; @launch kernel=c0_kernel grid=(256,1,1) block=(512,1,1) lds=131072
; @launch kernel=p2_kernel grid=(257,1,1) block=(256,1,1) lds=49152
; @launch kernel=c1_kernel grid=(256,1,1) block=(512,1,1) lds=131072
.amdgcn_target "amdgcn-amd-amdhsa--gfx950"
.text
.globl p1a_kernel
.p2align 8
.type p1a_kernel,@function
p1a_kernel:
  s_cmp_ge_u32 s2, 512
  s_cbranch_scc1 L_p1a_kernel_end_1
  s_load_dwordx2 s[6:7], s[0:1], 80
  s_load_dwordx2 s[4:5], s[0:1], 0
  v_lshrrev_b32 v2, 6, v0
  v_and_b32 v1, 63, v0
  v_readfirstlane_b32 s3, v2
  s_cmp_ge_u32 s2, 128
  s_cbranch_scc1 L_p1a_kernel_pre_2
  v_mov_b32 v16, 0
  v_mov_b32 v17, 0
  v_mov_b32 v18, 0
  v_mov_b32 v19, 0
  v_mov_b32 v20, 0
  v_mov_b32 v21, 0
  v_mov_b32 v22, 0
  v_mov_b32 v23, 0
  v_mov_b32 v24, 0
  v_mov_b32 v25, 0
  v_mov_b32 v26, 0
  v_mov_b32 v27, 0
  v_mov_b32 v28, 0
  v_mov_b32 v29, 0
  v_mov_b32 v30, 0
  v_mov_b32 v31, 0
  s_mov_b32 s20, 0x3f3504f3
  s_mov_b32 s21, 0x3f3504f3
  s_mov_b32 s22, 0xbf3504f3
  s_mov_b32 s23, 0xbf3504f3
  s_waitcnt lgkmcnt(0)
  s_mov_b32 s8, s4
  s_mov_b32 s9, s5
  s_mov_b32 s10, 2097152
  s_mov_b32 s11, 0x00020000
  s_mov_b32 s12, s6
  s_mov_b32 s13, s7
  s_mov_b32 s14, 4194304
  s_mov_b32 s15, 0x00020000
  s_lshl_b32 s16, s2, 3
  s_add_u32 s16, s16, s3
  s_lshl_b32 s16, s16, 10
  s_add_u32 s17, s16, 1048576
  v_lshlrev_b32 v3, 1, v1
  buffer_load_short_d16_hi v16, v3, s[8:11], s16 offen offset:0
  buffer_load_short_d16_hi v17, v3, s[8:11], s17 offen offset:0
  buffer_load_short_d16_hi v18, v3, s[8:11], s16 offen offset:128
  buffer_load_short_d16_hi v19, v3, s[8:11], s17 offen offset:128
  buffer_load_short_d16_hi v20, v3, s[8:11], s16 offen offset:256
  buffer_load_short_d16_hi v21, v3, s[8:11], s17 offen offset:256
  buffer_load_short_d16_hi v22, v3, s[8:11], s16 offen offset:384
  buffer_load_short_d16_hi v23, v3, s[8:11], s17 offen offset:384
  buffer_load_short_d16_hi v24, v3, s[8:11], s16 offen offset:512
  buffer_load_short_d16_hi v25, v3, s[8:11], s17 offen offset:512
  buffer_load_short_d16_hi v26, v3, s[8:11], s16 offen offset:640
  buffer_load_short_d16_hi v27, v3, s[8:11], s17 offen offset:640
  buffer_load_short_d16_hi v28, v3, s[8:11], s16 offen offset:768
  buffer_load_short_d16_hi v29, v3, s[8:11], s17 offen offset:768
  buffer_load_short_d16_hi v30, v3, s[8:11], s16 offen offset:896
  buffer_load_short_d16_hi v31, v3, s[8:11], s17 offen offset:896
  v_cvt_f32_u32 v4, v1
  v_and_b32 v5, 7, v1
  v_cvt_f32_u32 v5, v5
  v_mul_f32 v6, 0x3b000000, v4
  v_cos_f32 v48, v6
  v_sin_f32 v49, v6
  v_mul_f32 v6, 0x3b800000, v4
  v_cos_f32 v50, v6
  v_sin_f32 v51, v6
  v_mul_f32 v6, 0x3bc00000, v4
  v_cos_f32 v52, v6
  v_sin_f32 v53, v6
  v_mul_f32 v6, 0x3c000000, v4
  v_cos_f32 v54, v6
  v_sin_f32 v55, v6
  v_mul_f32 v6, 0x3c200000, v4
  v_cos_f32 v56, v6
  v_sin_f32 v57, v6
  v_mul_f32 v6, 0x3c400000, v4
  v_cos_f32 v58, v6
  v_sin_f32 v59, v6
  v_mul_f32 v6, 0x3c600000, v4
  v_cos_f32 v60, v6
  v_sin_f32 v61, v6
  v_mul_f32 v6, 0x3c800000, v5
  v_cos_f32 v62, v6
  v_sin_f32 v63, v6
  v_mul_f32 v6, 0x3d000000, v5
  v_cos_f32 v64, v6
  v_sin_f32 v65, v6
  v_mul_f32 v6, 0x3d400000, v5
  v_cos_f32 v66, v6
  v_sin_f32 v67, v6
  v_mul_f32 v6, 0x3d800000, v5
  v_cos_f32 v68, v6
  v_sin_f32 v69, v6
  v_mul_f32 v6, 0x3da00000, v5
  v_cos_f32 v70, v6
  v_sin_f32 v71, v6
  v_mul_f32 v6, 0x3dc00000, v5
  v_cos_f32 v72, v6
  v_sin_f32 v73, v6
  v_mul_f32 v6, 0x3de00000, v5
  v_cos_f32 v74, v6
  v_sin_f32 v75, v6
  s_lshl_b32 s18, s3, 12
  v_lshlrev_b32 v6, 3, v1
  v_add_u32 v6, s18, v6
  v_lshrrev_b32 v7, 3, v1
  v_lshl_add_u32 v8, v7, 9, v6
  v_and_b32 v9, 7, v1
  v_xor_b32 v9, s3, v9
  v_lshlrev_b32 v9, 3, v9
  v_lshl_add_u32 v9, v7, 6, v9
  v_add_u32 v9, s18, v9
  v_add_u32 v9, 0x8000, v9
  v_and_b32 v10, 7, v1
  v_mul_u32_u24 v10, 4104, v10
  v_lshl_add_u32 v10, v7, 6, v10
  s_lshl_b32 s19, s3, 9
  s_add_u32 s19, s19, 0x8000
  v_add_u32 v10, s19, v10
  v_and_b32 v11, 7, v1
  v_lshlrev_b32 v11, 3, v11
  v_lshl_add_u32 v11, v7, 13, v11
  s_lshl_b32 s24, s3, 16
  s_lshl_b32 s25, s2, 6
  s_add_u32 s24, s24, s25
  s_waitcnt vmcnt(0)
  v_pk_add_f32 v[32:33], v[16:17], v[18:19]
  v_pk_add_f32 v[34:35], v[20:21], v[22:23]
  v_pk_add_f32 v[36:37], v[24:25], v[26:27]
  v_pk_add_f32 v[38:39], v[28:29], v[30:31]
  v_pk_add_f32 v[32:33], v[32:33], v[34:35]
  v_pk_add_f32 v[36:37], v[36:37], v[38:39]
  v_pk_add_f32 v[32:33], v[32:33], v[36:37]
  s_nop 1
  v_add_f32_dpp v32, v32, v32 row_shr:1 row_mask:0xf bank_mask:0xf bound_ctrl:0
  v_add_f32_dpp v33, v33, v33 row_shr:1 row_mask:0xf bank_mask:0xf bound_ctrl:0
  s_nop 0
  v_add_f32_dpp v32, v32, v32 row_shr:2 row_mask:0xf bank_mask:0xf bound_ctrl:0
  v_add_f32_dpp v33, v33, v33 row_shr:2 row_mask:0xf bank_mask:0xf bound_ctrl:0
  s_nop 0
  v_add_f32_dpp v32, v32, v32 row_shr:4 row_mask:0xf bank_mask:0xf bound_ctrl:0
  v_add_f32_dpp v33, v33, v33 row_shr:4 row_mask:0xf bank_mask:0xf bound_ctrl:0
  s_nop 0
  v_add_f32_dpp v32, v32, v32 row_shr:8 row_mask:0xf bank_mask:0xf bound_ctrl:0
  v_add_f32_dpp v33, v33, v33 row_shr:8 row_mask:0xf bank_mask:0xf bound_ctrl:0
  s_nop 0
  v_add_f32_dpp v32, v32, v32 row_bcast:15 row_mask:0xa bank_mask:0xf
  v_add_f32_dpp v33, v33, v33 row_bcast:15 row_mask:0xa bank_mask:0xf
  s_nop 0
  v_add_f32_dpp v32, v32, v32 row_bcast:31 row_mask:0xc bank_mask:0xf
  v_add_f32_dpp v33, v33, v33 row_bcast:31 row_mask:0xc bank_mask:0xf
  s_nop 0
  v_mul_f32 v32, 0x3b000000, v32
  v_mul_f32 v33, 0x3b000000, v33
  v_cvt_pk_bf16_f32 v34, v32, v33
  v_and_b32 v35, 0xffff0000, v34
  v_lshlrev_b32 v34, 16, v34
  v_readlane_b32 s26, v32, 63
  v_readlane_b32 s27, v33, 63
  v_readlane_b32 s28, v34, 63
  v_readlane_b32 s29, v35, 63
  s_nop 1
  v_pk_add_f32 v[32:33], v[16:17], s[26:27] neg_lo:[0,1] neg_hi:[0,1]
  v_pk_add_f32 v[34:35], v[18:19], s[26:27] neg_lo:[0,1] neg_hi:[0,1]
  v_pk_add_f32 v[36:37], v[20:21], s[26:27] neg_lo:[0,1] neg_hi:[0,1]
  v_pk_add_f32 v[38:39], v[22:23], s[26:27] neg_lo:[0,1] neg_hi:[0,1]
  v_pk_add_f32 v[40:41], v[24:25], s[26:27] neg_lo:[0,1] neg_hi:[0,1]
  v_pk_add_f32 v[42:43], v[26:27], s[26:27] neg_lo:[0,1] neg_hi:[0,1]
  v_pk_add_f32 v[44:45], v[28:29], s[26:27] neg_lo:[0,1] neg_hi:[0,1]
  v_pk_add_f32 v[46:47], v[30:31], s[26:27] neg_lo:[0,1] neg_hi:[0,1]
  v_pk_mul_f32 v[32:33], v[32:33], v[32:33]
  v_pk_mul_f32 v[34:35], v[34:35], v[34:35]
  v_pk_fma_f32 v[32:33], v[36:37], v[36:37], v[32:33]
  v_pk_fma_f32 v[34:35], v[38:39], v[38:39], v[34:35]
  v_pk_fma_f32 v[32:33], v[40:41], v[40:41], v[32:33]
  v_pk_fma_f32 v[34:35], v[42:43], v[42:43], v[34:35]
  v_pk_fma_f32 v[32:33], v[44:45], v[44:45], v[32:33]
  v_pk_fma_f32 v[34:35], v[46:47], v[46:47], v[34:35]
  v_pk_add_f32 v[32:33], v[32:33], v[34:35]
  s_nop 1
  v_add_f32_dpp v32, v32, v32 row_shr:1 row_mask:0xf bank_mask:0xf bound_ctrl:0
  v_add_f32_dpp v33, v33, v33 row_shr:1 row_mask:0xf bank_mask:0xf bound_ctrl:0
  s_nop 0
  v_add_f32_dpp v32, v32, v32 row_shr:2 row_mask:0xf bank_mask:0xf bound_ctrl:0
  v_add_f32_dpp v33, v33, v33 row_shr:2 row_mask:0xf bank_mask:0xf bound_ctrl:0
  s_nop 0
  v_add_f32_dpp v32, v32, v32 row_shr:4 row_mask:0xf bank_mask:0xf bound_ctrl:0
  v_add_f32_dpp v33, v33, v33 row_shr:4 row_mask:0xf bank_mask:0xf bound_ctrl:0
  s_nop 0
  v_add_f32_dpp v32, v32, v32 row_shr:8 row_mask:0xf bank_mask:0xf bound_ctrl:0
  v_add_f32_dpp v33, v33, v33 row_shr:8 row_mask:0xf bank_mask:0xf bound_ctrl:0
  s_nop 0
  v_add_f32_dpp v32, v32, v32 row_bcast:15 row_mask:0xa bank_mask:0xf
  v_add_f32_dpp v33, v33, v33 row_bcast:15 row_mask:0xa bank_mask:0xf
  s_nop 0
  v_add_f32_dpp v32, v32, v32 row_bcast:31 row_mask:0xc bank_mask:0xf
  v_add_f32_dpp v33, v33, v33 row_bcast:31 row_mask:0xc bank_mask:0xf
  s_nop 0
  v_mul_f32 v32, 0x3b000000, v32
  v_mul_f32 v33, 0x3b000000, v33
  v_cvt_pk_bf16_f32 v34, v32, v33
  v_lshlrev_b32 v32, 16, v34
  v_and_b32 v33, 0xffff0000, v34
  v_add_f32 v32, 0x3727c5ac, v32
  v_add_f32 v33, 0x3727c5ac, v33
  v_cvt_pk_bf16_f32 v34, v32, v33
  v_lshlrev_b32 v32, 16, v34
  v_and_b32 v33, 0xffff0000, v34
  v_sqrt_f32 v32, v32
  v_sqrt_f32 v33, v33
  s_nop 0
  v_cvt_pk_bf16_f32 v34, v32, v33
  v_lshlrev_b32 v32, 16, v34
  v_and_b32 v33, 0xffff0000, v34
  v_rcp_f32 v32, v32
  v_rcp_f32 v33, v33
  s_nop 1
  v_readlane_b32 s30, v32, 63
  v_readlane_b32 s31, v33, 63
  v_pk_add_f32 v[16:17], v[16:17], s[28:29] neg_lo:[0,1] neg_hi:[0,1]
  v_cvt_pk_bf16_f32 v36, v16, v17
  v_lshlrev_b32 v16, 16, v36
  v_and_b32 v17, 0xffff0000, v36
  v_pk_add_f32 v[18:19], v[18:19], s[28:29] neg_lo:[0,1] neg_hi:[0,1]
  v_cvt_pk_bf16_f32 v38, v18, v19
  v_lshlrev_b32 v18, 16, v38
  v_and_b32 v19, 0xffff0000, v38
  v_pk_add_f32 v[20:21], v[20:21], s[28:29] neg_lo:[0,1] neg_hi:[0,1]
  v_cvt_pk_bf16_f32 v36, v20, v21
  v_lshlrev_b32 v20, 16, v36
  v_and_b32 v21, 0xffff0000, v36
  v_pk_add_f32 v[22:23], v[22:23], s[28:29] neg_lo:[0,1] neg_hi:[0,1]
  v_cvt_pk_bf16_f32 v38, v22, v23
  v_lshlrev_b32 v22, 16, v38
  v_and_b32 v23, 0xffff0000, v38
  v_pk_add_f32 v[24:25], v[24:25], s[28:29] neg_lo:[0,1] neg_hi:[0,1]
  v_cvt_pk_bf16_f32 v36, v24, v25
  v_lshlrev_b32 v24, 16, v36
  v_and_b32 v25, 0xffff0000, v36
  v_pk_add_f32 v[26:27], v[26:27], s[28:29] neg_lo:[0,1] neg_hi:[0,1]
  v_cvt_pk_bf16_f32 v38, v26, v27
  v_lshlrev_b32 v26, 16, v38
  v_and_b32 v27, 0xffff0000, v38
  v_pk_add_f32 v[28:29], v[28:29], s[28:29] neg_lo:[0,1] neg_hi:[0,1]
  v_cvt_pk_bf16_f32 v36, v28, v29
  v_lshlrev_b32 v28, 16, v36
  v_and_b32 v29, 0xffff0000, v36
  v_pk_add_f32 v[30:31], v[30:31], s[28:29] neg_lo:[0,1] neg_hi:[0,1]
  v_cvt_pk_bf16_f32 v38, v30, v31
  v_lshlrev_b32 v30, 16, v38
  v_and_b32 v31, 0xffff0000, v38
  v_pk_mul_f32 v[16:17], v[16:17], s[30:31]
  v_pk_mul_f32 v[18:19], v[18:19], s[30:31]
  v_pk_mul_f32 v[20:21], v[20:21], s[30:31]
  v_pk_mul_f32 v[22:23], v[22:23], s[30:31]
  v_pk_mul_f32 v[24:25], v[24:25], s[30:31]
  v_pk_mul_f32 v[26:27], v[26:27], s[30:31]
  v_pk_mul_f32 v[28:29], v[28:29], s[30:31]
  v_pk_mul_f32 v[30:31], v[30:31], s[30:31]
  v_cvt_pk_bf16_f32 v32, v16, v17
  v_lshlrev_b32 v16, 16, v32
  v_and_b32 v17, 0xffff0000, v32
  v_cvt_pk_bf16_f32 v34, v18, v19
  v_lshlrev_b32 v18, 16, v34
  v_and_b32 v19, 0xffff0000, v34
  v_cvt_pk_bf16_f32 v36, v20, v21
  v_lshlrev_b32 v20, 16, v36
  v_and_b32 v21, 0xffff0000, v36
  v_cvt_pk_bf16_f32 v38, v22, v23
  v_lshlrev_b32 v22, 16, v38
  v_and_b32 v23, 0xffff0000, v38
  v_cvt_pk_bf16_f32 v40, v24, v25
  v_lshlrev_b32 v24, 16, v40
  v_and_b32 v25, 0xffff0000, v40
  v_cvt_pk_bf16_f32 v42, v26, v27
  v_lshlrev_b32 v26, 16, v42
  v_and_b32 v27, 0xffff0000, v42
  v_cvt_pk_bf16_f32 v44, v28, v29
  v_lshlrev_b32 v28, 16, v44
  v_and_b32 v29, 0xffff0000, v44
  v_cvt_pk_bf16_f32 v46, v30, v31
  v_lshlrev_b32 v30, 16, v46
  v_and_b32 v31, 0xffff0000, v46
  v_pk_add_f32 v[32:33], v[16:17], v[24:25]
  v_pk_add_f32 v[40:41], v[16:17], v[24:25] neg_lo:[0,1] neg_hi:[0,1]
  v_pk_add_f32 v[34:35], v[18:19], v[26:27]
  v_pk_add_f32 v[42:43], v[18:19], v[26:27] neg_lo:[0,1] neg_hi:[0,1]
  v_pk_add_f32 v[36:37], v[20:21], v[28:29]
  v_pk_add_f32 v[44:45], v[20:21], v[28:29] neg_lo:[0,1] neg_hi:[0,1]
  v_pk_add_f32 v[38:39], v[22:23], v[30:31]
  v_pk_add_f32 v[46:47], v[22:23], v[30:31] neg_lo:[0,1] neg_hi:[0,1]
  v_pk_add_f32 v[26:27], v[42:43], v[42:43] op_sel:[0,1] op_sel_hi:[1,0] neg_hi:[0,1]
  v_pk_add_f32 v[30:31], v[46:47], v[46:47] op_sel:[0,1] op_sel_hi:[1,0] neg_lo:[0,1]
  v_pk_add_f32 v[16:17], v[32:33], v[36:37]
  v_pk_add_f32 v[18:19], v[32:33], v[36:37] neg_lo:[0,1] neg_hi:[0,1]
  v_pk_mul_f32 v[26:27], v[26:27], s[20:21]
  v_pk_mul_f32 v[30:31], v[30:31], s[22:23]
  v_pk_add_f32 v[20:21], v[34:35], v[38:39]
  v_pk_add_f32 v[22:23], v[34:35], v[38:39] neg_lo:[0,1] neg_hi:[0,1]
  v_pk_add_f32 v[24:25], v[40:41], v[44:45] op_sel:[0,1] op_sel_hi:[1,0] neg_hi:[0,1]
  v_pk_add_f32 v[28:29], v[40:41], v[44:45] op_sel:[0,1] op_sel_hi:[1,0] neg_lo:[0,1]
  v_pk_add_f32 v[42:43], v[26:27], v[30:31]
  v_pk_add_f32 v[46:47], v[26:27], v[30:31] neg_lo:[0,1] neg_hi:[0,1]
  v_pk_add_f32 v[32:33], v[16:17], v[20:21]
  v_pk_add_f32 v[36:37], v[16:17], v[20:21] neg_lo:[0,1] neg_hi:[0,1]
  v_pk_add_f32 v[34:35], v[18:19], v[22:23] op_sel:[0,1] op_sel_hi:[1,0] neg_hi:[0,1]
  v_pk_add_f32 v[38:39], v[18:19], v[22:23] op_sel:[0,1] op_sel_hi:[1,0] neg_lo:[0,1]
  v_pk_add_f32 v[40:41], v[24:25], v[42:43]
  v_pk_add_f32 v[44:45], v[24:25], v[42:43] neg_lo:[0,1] neg_hi:[0,1]
  v_pk_add_f32 v[26:27], v[28:29], v[46:47] op_sel:[0,1] op_sel_hi:[1,0] neg_hi:[0,1]
  v_pk_add_f32 v[30:31], v[28:29], v[46:47] op_sel:[0,1] op_sel_hi:[1,0] neg_lo:[0,1]
  v_pk_mul_f32 v[18:19], v[40:41], v[48:49] op_sel:[0,0] op_sel_hi:[1,0]
  v_pk_fma_f32 v[40:41], v[40:41], v[48:49], v[18:19] op_sel:[1,1,0] op_sel_hi:[0,1,1] neg_hi:[1,0,0]
  v_pk_mul_f32 v[16:17], v[34:35], v[50:51] op_sel:[0,0] op_sel_hi:[1,0]
  v_pk_fma_f32 v[34:35], v[34:35], v[50:51], v[16:17] op_sel:[1,1,0] op_sel_hi:[0,1,1] neg_hi:[1,0,0]
  v_pk_mul_f32 v[18:19], v[26:27], v[52:53] op_sel:[0,0] op_sel_hi:[1,0]
  v_pk_fma_f32 v[26:27], v[26:27], v[52:53], v[18:19] op_sel:[1,1,0] op_sel_hi:[0,1,1] neg_hi:[1,0,0]
  v_pk_mul_f32 v[16:17], v[36:37], v[54:55] op_sel:[0,0] op_sel_hi:[1,0]
  v_pk_fma_f32 v[36:37], v[36:37], v[54:55], v[16:17] op_sel:[1,1,0] op_sel_hi:[0,1,1] neg_hi:[1,0,0]
  v_pk_mul_f32 v[18:19], v[44:45], v[56:57] op_sel:[0,0] op_sel_hi:[1,0]
  v_pk_fma_f32 v[44:45], v[44:45], v[56:57], v[18:19] op_sel:[1,1,0] op_sel_hi:[0,1,1] neg_hi:[1,0,0]
  v_pk_mul_f32 v[16:17], v[38:39], v[58:59] op_sel:[0,0] op_sel_hi:[1,0]
  v_pk_fma_f32 v[38:39], v[38:39], v[58:59], v[16:17] op_sel:[1,1,0] op_sel_hi:[0,1,1] neg_hi:[1,0,0]
  v_pk_mul_f32 v[18:19], v[30:31], v[60:61] op_sel:[0,0] op_sel_hi:[1,0]
  v_pk_fma_f32 v[30:31], v[30:31], v[60:61], v[18:19] op_sel:[1,1,0] op_sel_hi:[0,1,1] neg_hi:[1,0,0]
  ds_write_b64 v6, v[32:33] offset:0
  v_xor_b32 v13, 64, v6
  ds_write_b64 v13, v[40:41] offset:512
  v_xor_b32 v12, 128, v6
  ds_write_b64 v12, v[34:35] offset:1024
  v_xor_b32 v13, 192, v6
  ds_write_b64 v13, v[26:27] offset:1536
  v_xor_b32 v12, 256, v6
  ds_write_b64 v12, v[36:37] offset:2048
  v_xor_b32 v13, 320, v6
  ds_write_b64 v13, v[44:45] offset:2560
  v_xor_b32 v12, 384, v6
  ds_write_b64 v12, v[38:39] offset:3072
  v_xor_b32 v13, 448, v6
  ds_write_b64 v13, v[30:31] offset:3584
  ds_read_b64 v[16:17], v8
  v_xor_b32 v13, 64, v8
  ds_read_b64 v[18:19], v13
  v_xor_b32 v12, 128, v8
  ds_read_b64 v[20:21], v12
  v_xor_b32 v13, 192, v8
  ds_read_b64 v[22:23], v13
  v_xor_b32 v12, 256, v8
  ds_read_b64 v[24:25], v12
  v_xor_b32 v13, 320, v8
  ds_read_b64 v[28:29], v13
  v_xor_b32 v12, 384, v8
  ds_read_b64 v[42:43], v12
  v_xor_b32 v13, 448, v8
  ds_read_b64 v[46:47], v13
  s_waitcnt lgkmcnt(0)
  v_pk_add_f32 v[32:33], v[16:17], v[24:25]
  v_pk_add_f32 v[36:37], v[16:17], v[24:25] neg_lo:[0,1] neg_hi:[0,1]
  v_pk_add_f32 v[40:41], v[18:19], v[28:29]
  v_pk_add_f32 v[44:45], v[18:19], v[28:29] neg_lo:[0,1] neg_hi:[0,1]
  v_pk_add_f32 v[34:35], v[20:21], v[42:43]
  v_pk_add_f32 v[38:39], v[20:21], v[42:43] neg_lo:[0,1] neg_hi:[0,1]
  v_pk_add_f32 v[26:27], v[22:23], v[46:47]
  v_pk_add_f32 v[30:31], v[22:23], v[46:47] neg_lo:[0,1] neg_hi:[0,1]
  v_pk_add_f32 v[28:29], v[44:45], v[44:45] op_sel:[0,1] op_sel_hi:[1,0] neg_hi:[0,1]
  v_pk_add_f32 v[46:47], v[30:31], v[30:31] op_sel:[0,1] op_sel_hi:[1,0] neg_lo:[0,1]
  v_pk_add_f32 v[16:17], v[32:33], v[34:35]
  v_pk_add_f32 v[18:19], v[32:33], v[34:35] neg_lo:[0,1] neg_hi:[0,1]
  v_pk_mul_f32 v[28:29], v[28:29], s[20:21]
  v_pk_mul_f32 v[46:47], v[46:47], s[22:23]
  v_pk_add_f32 v[20:21], v[40:41], v[26:27]
  v_pk_add_f32 v[22:23], v[40:41], v[26:27] neg_lo:[0,1] neg_hi:[0,1]
  v_pk_add_f32 v[24:25], v[36:37], v[38:39] op_sel:[0,1] op_sel_hi:[1,0] neg_hi:[0,1]
  v_pk_add_f32 v[42:43], v[36:37], v[38:39] op_sel:[0,1] op_sel_hi:[1,0] neg_lo:[0,1]
  v_pk_add_f32 v[44:45], v[28:29], v[46:47]
  v_pk_add_f32 v[30:31], v[28:29], v[46:47] neg_lo:[0,1] neg_hi:[0,1]
  v_pk_add_f32 v[32:33], v[16:17], v[20:21]
  v_pk_add_f32 v[34:35], v[16:17], v[20:21] neg_lo:[0,1] neg_hi:[0,1]
  v_pk_add_f32 v[40:41], v[18:19], v[22:23] op_sel:[0,1] op_sel_hi:[1,0] neg_hi:[0,1]
  v_pk_add_f32 v[26:27], v[18:19], v[22:23] op_sel:[0,1] op_sel_hi:[1,0] neg_lo:[0,1]
  v_pk_add_f32 v[36:37], v[24:25], v[44:45]
  v_pk_add_f32 v[38:39], v[24:25], v[44:45] neg_lo:[0,1] neg_hi:[0,1]
  v_pk_add_f32 v[28:29], v[42:43], v[30:31] op_sel:[0,1] op_sel_hi:[1,0] neg_hi:[0,1]
  v_pk_add_f32 v[46:47], v[42:43], v[30:31] op_sel:[0,1] op_sel_hi:[1,0] neg_lo:[0,1]
  v_pk_mul_f32 v[18:19], v[36:37], v[62:63] op_sel:[0,0] op_sel_hi:[1,0]
  v_pk_fma_f32 v[36:37], v[36:37], v[62:63], v[18:19] op_sel:[1,1,0] op_sel_hi:[0,1,1] neg_hi:[1,0,0]
  v_pk_mul_f32 v[16:17], v[40:41], v[64:65] op_sel:[0,0] op_sel_hi:[1,0]
  v_pk_fma_f32 v[40:41], v[40:41], v[64:65], v[16:17] op_sel:[1,1,0] op_sel_hi:[0,1,1] neg_hi:[1,0,0]
  v_pk_mul_f32 v[18:19], v[28:29], v[66:67] op_sel:[0,0] op_sel_hi:[1,0]
  v_pk_fma_f32 v[28:29], v[28:29], v[66:67], v[18:19] op_sel:[1,1,0] op_sel_hi:[0,1,1] neg_hi:[1,0,0]
  v_pk_mul_f32 v[16:17], v[34:35], v[68:69] op_sel:[0,0] op_sel_hi:[1,0]
  v_pk_fma_f32 v[34:35], v[34:35], v[68:69], v[16:17] op_sel:[1,1,0] op_sel_hi:[0,1,1] neg_hi:[1,0,0]
  v_pk_mul_f32 v[18:19], v[38:39], v[70:71] op_sel:[0,0] op_sel_hi:[1,0]
  v_pk_fma_f32 v[38:39], v[38:39], v[70:71], v[18:19] op_sel:[1,1,0] op_sel_hi:[0,1,1] neg_hi:[1,0,0]
  v_pk_mul_f32 v[16:17], v[26:27], v[72:73] op_sel:[0,0] op_sel_hi:[1,0]
  v_pk_fma_f32 v[26:27], v[26:27], v[72:73], v[16:17] op_sel:[1,1,0] op_sel_hi:[0,1,1] neg_hi:[1,0,0]
  v_pk_mul_f32 v[18:19], v[46:47], v[74:75] op_sel:[0,0] op_sel_hi:[1,0]
  v_pk_fma_f32 v[46:47], v[46:47], v[74:75], v[18:19] op_sel:[1,1,0] op_sel_hi:[0,1,1] neg_hi:[1,0,0]
  ds_write_b64 v9, v[32:33] offset:0
  ds_write_b64 v9, v[36:37] offset:512
  ds_write_b64 v9, v[40:41] offset:1024
  ds_write_b64 v9, v[28:29] offset:1536
  ds_write_b64 v9, v[34:35] offset:2048
  ds_write_b64 v9, v[38:39] offset:2560
  ds_write_b64 v9, v[26:27] offset:3072
  ds_write_b64 v9, v[46:47] offset:3584
  s_waitcnt lgkmcnt(0)
  s_barrier
  ds_read_b64 v[16:17], v10
  v_xor_b32 v13, 8, v10
  ds_read_b64 v[18:19], v13
  v_xor_b32 v12, 16, v10
  ds_read_b64 v[20:21], v12
  v_xor_b32 v13, 24, v10
  ds_read_b64 v[22:23], v13
  v_xor_b32 v12, 32, v10
  ds_read_b64 v[24:25], v12
  v_xor_b32 v13, 40, v10
  ds_read_b64 v[42:43], v13
  v_xor_b32 v12, 48, v10
  ds_read_b64 v[44:45], v12
  v_xor_b32 v13, 56, v10
  ds_read_b64 v[30:31], v13
  s_waitcnt lgkmcnt(0)
  v_pk_add_f32 v[32:33], v[16:17], v[24:25]
  v_pk_add_f32 v[34:35], v[16:17], v[24:25] neg_lo:[0,1] neg_hi:[0,1]
  v_pk_add_f32 v[36:37], v[18:19], v[42:43]
  v_pk_add_f32 v[38:39], v[18:19], v[42:43] neg_lo:[0,1] neg_hi:[0,1]
  v_pk_add_f32 v[40:41], v[20:21], v[44:45]
  v_pk_add_f32 v[26:27], v[20:21], v[44:45] neg_lo:[0,1] neg_hi:[0,1]
  v_pk_add_f32 v[28:29], v[22:23], v[30:31]
  v_pk_add_f32 v[46:47], v[22:23], v[30:31] neg_lo:[0,1] neg_hi:[0,1]
  v_pk_add_f32 v[42:43], v[38:39], v[38:39] op_sel:[0,1] op_sel_hi:[1,0] neg_hi:[0,1]
  v_pk_add_f32 v[30:31], v[46:47], v[46:47] op_sel:[0,1] op_sel_hi:[1,0] neg_lo:[0,1]
  v_pk_add_f32 v[16:17], v[32:33], v[40:41]
  v_pk_add_f32 v[18:19], v[32:33], v[40:41] neg_lo:[0,1] neg_hi:[0,1]
  v_pk_mul_f32 v[42:43], v[42:43], s[20:21]
  v_pk_mul_f32 v[30:31], v[30:31], s[22:23]
  v_pk_add_f32 v[20:21], v[36:37], v[28:29]
  v_pk_add_f32 v[22:23], v[36:37], v[28:29] neg_lo:[0,1] neg_hi:[0,1]
  v_pk_add_f32 v[24:25], v[34:35], v[26:27] op_sel:[0,1] op_sel_hi:[1,0] neg_hi:[0,1]
  v_pk_add_f32 v[44:45], v[34:35], v[26:27] op_sel:[0,1] op_sel_hi:[1,0] neg_lo:[0,1]
  v_pk_add_f32 v[38:39], v[42:43], v[30:31]
  v_pk_add_f32 v[46:47], v[42:43], v[30:31] neg_lo:[0,1] neg_hi:[0,1]
  v_pk_add_f32 v[32:33], v[16:17], v[20:21]
  v_pk_add_f32 v[40:41], v[16:17], v[20:21] neg_lo:[0,1] neg_hi:[0,1]
  v_pk_add_f32 v[36:37], v[18:19], v[22:23] op_sel:[0,1] op_sel_hi:[1,0] neg_hi:[0,1]
  v_pk_add_f32 v[28:29], v[18:19], v[22:23] op_sel:[0,1] op_sel_hi:[1,0] neg_lo:[0,1]
  v_pk_add_f32 v[34:35], v[24:25], v[38:39]
  v_pk_add_f32 v[26:27], v[24:25], v[38:39] neg_lo:[0,1] neg_hi:[0,1]
  v_pk_add_f32 v[42:43], v[44:45], v[46:47] op_sel:[0,1] op_sel_hi:[1,0] neg_hi:[0,1]
  v_pk_add_f32 v[30:31], v[44:45], v[46:47] op_sel:[0,1] op_sel_hi:[1,0] neg_lo:[0,1]
  buffer_store_dwordx2 v[32:33], v11, s[12:15], s24 offen
  s_add_u32 s24, s24, 524288
  buffer_store_dwordx2 v[34:35], v11, s[12:15], s24 offen
  s_add_u32 s24, s24, 524288
  buffer_store_dwordx2 v[36:37], v11, s[12:15], s24 offen
  s_add_u32 s24, s24, 524288
  buffer_store_dwordx2 v[42:43], v11, s[12:15], s24 offen
  s_add_u32 s24, s24, 524288
  buffer_store_dwordx2 v[40:41], v11, s[12:15], s24 offen
  s_add_u32 s24, s24, 524288
  buffer_store_dwordx2 v[26:27], v11, s[12:15], s24 offen
  s_add_u32 s24, s24, 524288
  buffer_store_dwordx2 v[28:29], v11, s[12:15], s24 offen
  s_add_u32 s24, s24, 524288
  buffer_store_dwordx2 v[30:31], v11, s[12:15], s24 offen
  s_endpgm
L_p1a_kernel_pre_2:
  s_load_dwordx4 s[8:11], s[0:1], 8
  s_load_dwordx2 s[12:13], s[0:1], 32
  s_load_dwordx2 s[14:15], s[0:1], 48
  s_sub_u32 s16, s2, 128
  s_lshl_b32 s16, s16, 3
  s_add_u32 s16, s16, s3
  v_and_b32 v2, 31, v1
  v_lshrrev_b32 v3, 5, v1
  v_lshlrev_b32 v4, 4, v1
  s_waitcnt lgkmcnt(0)
  s_cmp_ge_u32 s16, 896
  s_cbranch_scc1 L_p1a_kernel_w2_3
  s_mov_b32 s24, s12
  s_mov_b32 s25, s13
  s_mov_b32 s26, 1835008
  s_mov_b32 s27, 0x00020000
  s_add_u32 s28, s6, 25165824
  s_addc_u32 s29, s7, 0
  s_mov_b32 s30, 1835008
  s_mov_b32 s31, 0x00020000
  v_mul_u32_u24 v5, 3584, v3
  v_lshl_add_u32 v5, v2, 1, v5
  s_lshr_b32 s17, s16, 4
  s_and_b32 s18, s16, 15
  s_mul_i32 s18, s18, 14336
  s_lshl_b32 s17, s17, 6
  s_add_u32 s18, s18, s17
  s_add_u32 s19, s18, 0
  buffer_load_ushort v8, v5, s[24:27], s19 offen
  s_add_u32 s19, s18, 229376
  buffer_load_short_d16_hi v24, v5, s[24:27], s19 offen
  s_add_u32 s19, s18, 458752
  buffer_load_ushort v9, v5, s[24:27], s19 offen
  s_add_u32 s19, s18, 688128
  buffer_load_short_d16_hi v25, v5, s[24:27], s19 offen
  s_add_u32 s19, s18, 917504
  buffer_load_ushort v10, v5, s[24:27], s19 offen
  s_add_u32 s19, s18, 1146880
  buffer_load_short_d16_hi v26, v5, s[24:27], s19 offen
  s_add_u32 s19, s18, 1376256
  buffer_load_ushort v11, v5, s[24:27], s19 offen
  s_add_u32 s19, s18, 1605632
  buffer_load_short_d16_hi v27, v5, s[24:27], s19 offen
  s_add_u32 s19, s18, 7168
  buffer_load_ushort v12, v5, s[24:27], s19 offen
  s_add_u32 s19, s18, 236544
  buffer_load_short_d16_hi v28, v5, s[24:27], s19 offen
  s_add_u32 s19, s18, 465920
  buffer_load_ushort v13, v5, s[24:27], s19 offen
  s_add_u32 s19, s18, 695296
  buffer_load_short_d16_hi v29, v5, s[24:27], s19 offen
  s_add_u32 s19, s18, 924672
  buffer_load_ushort v14, v5, s[24:27], s19 offen
  s_add_u32 s19, s18, 1154048
  buffer_load_short_d16_hi v30, v5, s[24:27], s19 offen
  s_add_u32 s19, s18, 1383424
  buffer_load_ushort v15, v5, s[24:27], s19 offen
  s_add_u32 s19, s18, 1612800
  buffer_load_short_d16_hi v31, v5, s[24:27], s19 offen
  s_lshl_b32 s17, s16, 11
  s_waitcnt vmcnt(8)
  v_or_b32 v8, v8, v24
  v_or_b32 v9, v9, v25
  v_or_b32 v10, v10, v26
  v_or_b32 v11, v11, v27
  buffer_store_dwordx4 v[8:11], v4, s[28:31], s17 offen
  s_waitcnt vmcnt(1)
  v_or_b32 v12, v12, v28
  v_or_b32 v13, v13, v29
  v_or_b32 v14, v14, v30
  v_or_b32 v15, v15, v31
  buffer_store_dwordx4 v[12:15], v4, s[28:31], s17 offen offset:1024
  s_endpgm
L_p1a_kernel_w2_3:
  s_cmp_ge_u32 s16, 1792
  s_cbranch_scc1 L_p1a_kernel_wt_4
  s_mov_b32 s24, s14
  s_mov_b32 s25, s15
  s_mov_b32 s26, 1835008
  s_mov_b32 s27, 0x00020000
  s_add_u32 s28, s6, 27262976
  s_addc_u32 s29, s7, 0
  s_mov_b32 s30, 1835008
  s_mov_b32 s31, 0x00020000
  s_sub_u32 s16, s16, 896
  s_mul_hi_u32 s17, s16, 76695845
  s_mul_i32 s18, s17, 56
  s_sub_u32 s18, s16, s18
  v_and_b32 v5, 0x13, v2
  v_bfe_u32 v6, v2, 2, 1
  v_lshl_add_u32 v5, v6, 3, v5
  v_bfe_u32 v6, v2, 3, 1
  v_lshl_add_u32 v5, v6, 2, v5
  v_lshlrev_b32 v5, 1, v5
  v_lshl_add_u32 v5, v3, 12, v5
  s_lshl_b32 s18, s18, 15
  s_lshl_b32 s17, s17, 6
  s_add_u32 s18, s18, s17
  s_add_u32 s19, s18, 0
  buffer_load_ushort v8, v5, s[24:27], s19 offen
  s_add_u32 s19, s18, 1024
  buffer_load_short_d16_hi v24, v5, s[24:27], s19 offen
  s_add_u32 s19, s18, 2048
  buffer_load_ushort v9, v5, s[24:27], s19 offen
  s_add_u32 s19, s18, 3072
  buffer_load_short_d16_hi v25, v5, s[24:27], s19 offen
  s_add_u32 s19, s18, 8192
  buffer_load_ushort v10, v5, s[24:27], s19 offen
  s_add_u32 s19, s18, 9216
  buffer_load_short_d16_hi v26, v5, s[24:27], s19 offen
  s_add_u32 s19, s18, 10240
  buffer_load_ushort v11, v5, s[24:27], s19 offen
  s_add_u32 s19, s18, 11264
  buffer_load_short_d16_hi v27, v5, s[24:27], s19 offen
  s_add_u32 s19, s18, 16384
  buffer_load_ushort v12, v5, s[24:27], s19 offen
  s_add_u32 s19, s18, 17408
  buffer_load_short_d16_hi v28, v5, s[24:27], s19 offen
  s_add_u32 s19, s18, 18432
  buffer_load_ushort v13, v5, s[24:27], s19 offen
  s_add_u32 s19, s18, 19456
  buffer_load_short_d16_hi v29, v5, s[24:27], s19 offen
  s_add_u32 s19, s18, 24576
  buffer_load_ushort v14, v5, s[24:27], s19 offen
  s_add_u32 s19, s18, 25600
  buffer_load_short_d16_hi v30, v5, s[24:27], s19 offen
  s_add_u32 s19, s18, 26624
  buffer_load_ushort v15, v5, s[24:27], s19 offen
  s_add_u32 s19, s18, 27648
  buffer_load_short_d16_hi v31, v5, s[24:27], s19 offen
  s_lshl_b32 s17, s16, 11
  s_waitcnt vmcnt(8)
  v_or_b32 v8, v8, v24
  v_or_b32 v9, v9, v25
  v_or_b32 v10, v10, v26
  v_or_b32 v11, v11, v27
  buffer_store_dwordx4 v[8:11], v4, s[28:31], s17 offen
  s_waitcnt vmcnt(1)
  v_or_b32 v12, v12, v28
  v_or_b32 v13, v13, v29
  v_or_b32 v14, v14, v30
  v_or_b32 v15, v15, v31
  buffer_store_dwordx4 v[12:15], v4, s[28:31], s17 offen offset:1024
  s_endpgm
L_p1a_kernel_wt_4:
  s_mov_b32 s24, s8
  s_mov_b32 s25, s9
  s_mov_b32 s26, 1052672
  s_mov_b32 s27, 0x00020000
  s_mov_b32 s32, s10
  s_mov_b32 s33, s11
  s_mov_b32 s34, 1052672
  s_mov_b32 s35, 0x00020000
  s_add_u32 s28, s6, 29360128
  s_addc_u32 s29, s7, 0
  s_mov_b32 s30, 2105344
  s_mov_b32 s31, 0x00020000
  s_sub_u32 s16, s16, 1792
  s_lshr_b32 s17, s16, 8
  s_and_b32 s18, s16, 255
  s_lshr_b32 s19, s18, 5
  s_bfe_u32 s36, s18, 0x30002
  s_lshl_b32 s36, s36, 3
  s_add_u32 s19, s19, s36
  s_and_b32 s36, s18, 3
  s_lshl_b32 s36, s36, 6
  s_add_u32 s19, s19, s36
  s_mul_i32 s19, s19, 514
  s_lshl_b32 s36, s17, 7
  s_add_u32 s19, s19, s36
  v_lshlrev_b32 v5, 1, v1
  s_add_u32 s36, s19, 0
  buffer_load_ushort v8, v5, s[24:27], s36 offen
  buffer_load_short_d16_hi v24, v5, s[32:35], s36 offen
  s_add_u32 s36, s19, 263168
  buffer_load_ushort v9, v5, s[24:27], s36 offen
  buffer_load_short_d16_hi v25, v5, s[32:35], s36 offen
  s_add_u32 s36, s19, 526336
  buffer_load_ushort v10, v5, s[24:27], s36 offen
  buffer_load_short_d16_hi v26, v5, s[32:35], s36 offen
  s_add_u32 s36, s19, 789504
  buffer_load_ushort v11, v5, s[24:27], s36 offen
  buffer_load_short_d16_hi v27, v5, s[32:35], s36 offen
  s_add_u32 s36, s19, 131584
  buffer_load_ushort v12, v5, s[24:27], s36 offen
  buffer_load_short_d16_hi v28, v5, s[32:35], s36 offen
  s_add_u32 s36, s19, 394752
  buffer_load_ushort v13, v5, s[24:27], s36 offen
  buffer_load_short_d16_hi v29, v5, s[32:35], s36 offen
  s_add_u32 s36, s19, 657920
  buffer_load_ushort v14, v5, s[24:27], s36 offen
  buffer_load_short_d16_hi v30, v5, s[32:35], s36 offen
  s_add_u32 s36, s19, 921088
  buffer_load_ushort v15, v5, s[24:27], s36 offen
  buffer_load_short_d16_hi v31, v5, s[32:35], s36 offen
  v_lshlrev_b32 v6, 13, v1
  s_lshl_b32 s17, s17, 19
  s_lshl_b32 s18, s18, 5
  s_add_u32 s17, s17, s18
  s_waitcnt vmcnt(0)
  v_or_b32 v8, v8, v24
  v_or_b32 v9, v9, v25
  v_or_b32 v10, v10, v26
  v_or_b32 v11, v11, v27
  v_or_b32 v12, v12, v28
  v_or_b32 v13, v13, v29
  v_or_b32 v14, v14, v30
  v_or_b32 v15, v15, v31
  buffer_store_dwordx4 v[8:11], v6, s[28:31], s17 offen
  buffer_store_dwordx4 v[12:15], v6, s[28:31], s17 offen offset:16
  s_endpgm
L_p1a_kernel_end_1:
  s_endpgm
.globl p2_kernel
.p2align 8
.type p2_kernel,@function
p2_kernel:
  s_cmp_ge_u32 s2, 257
  s_cbranch_scc1 L_p2_kernel_end_1
  s_load_dwordx2 s[6:7], s[0:1], 80
  v_lshrrev_b32 v2, 6, v0
  v_lshlrev_b32 v1, 3, v0
  v_readfirstlane_b32 s3, v2
  s_mov_b32 s20, 0x3f3504f3
  s_mov_b32 s21, 0x3f3504f3
  s_mov_b32 s22, 0xbf3504f3
  s_mov_b32 s23, 0xbf3504f3
  s_waitcnt lgkmcnt(0)
  s_mov_b32 s8, s6
  s_mov_b32 s9, s7
  s_mov_b32 s10, 4194304
  s_mov_b32 s11, 0x00020000
  s_add_u32 s12, s6, 4194304
  s_addc_u32 s13, s7, 0
  s_mov_b32 s14, 4194304
  s_mov_b32 s15, 0x00020000
  s_add_u32 s24, s6, 29360128
  s_addc_u32 s25, s7, 0
  s_mov_b32 s26, 2105344
  s_mov_b32 s27, 0x00020000
  s_or_b32 s16, s2, s3
  s_cmp_lg_u32 s16, 0
  s_cbranch_scc1 L_p2_kernel_nz_2
  s_add_u32 s28, s6, 41943040
  s_addc_u32 s29, s7, 0
  s_mov_b32 s30, 8192
  s_mov_b32 s31, 0x00020000
  s_mov_b32 s17, 4096
  v_lshlrev_b32 v3, 4, v0
  v_mov_b32 v4, 0
  v_mov_b32 v5, 0
  v_mov_b32 v6, 0
  v_mov_b32 v7, 0
  buffer_store_dwordx4 v[4:7], v3, s[28:31], 0 offen offset:0
  buffer_store_dwordx4 v[4:7], v3, s[28:31], s17 offen offset:0
  buffer_store_dwordx4 v[4:7], v3, s[28:31], 0 offen offset:1024
  buffer_store_dwordx4 v[4:7], v3, s[28:31], s17 offen offset:1024
  buffer_store_dwordx4 v[4:7], v3, s[28:31], 0 offen offset:2048
  buffer_store_dwordx4 v[4:7], v3, s[28:31], s17 offen offset:2048
  buffer_store_dwordx4 v[4:7], v3, s[28:31], 0 offen offset:3072
  buffer_store_dwordx4 v[4:7], v3, s[28:31], s17 offen offset:3072
L_p2_kernel_nz_2:
  s_lshl_b32 s16, s2, 13
  s_sub_u32 s17, 512, s2
  s_and_b32 s17, s17, 511
  s_lshl_b32 s17, s17, 13
  s_add_u32 s18, s16, 4096
  s_add_u32 s19, s17, 4096
  buffer_load_dwordx2 v[32:33], v1, s[8:11], s16 offen offset:0
  buffer_load_dwordx2 v[40:41], v1, s[8:11], s17 offen offset:0
  buffer_load_dwordx2 v[34:35], v1, s[8:11], s16 offen offset:2048
  buffer_load_dwordx2 v[42:43], v1, s[8:11], s17 offen offset:2048
  buffer_load_dwordx2 v[36:37], v1, s[8:11], s18 offen offset:0
  buffer_load_dwordx2 v[44:45], v1, s[8:11], s19 offen offset:0
  buffer_load_dwordx2 v[38:39], v1, s[8:11], s18 offen offset:2048
  buffer_load_dwordx2 v[46:47], v1, s[8:11], s19 offen offset:2048
  v_lshlrev_b32 v3, 5, v0
  buffer_load_dwordx4 v[90:93], v3, s[24:27], s16 offen
  buffer_load_dwordx4 v[94:97], v3, s[24:27], s16 offen offset:16
  v_cvt_f32_u32 v4, v0
  v_and_b32 v5, 31, v0
  v_cvt_f32_u32 v5, v5
  v_and_b32 v6, 3, v0
  v_cvt_f32_u32 v6, v6
  v_mul_f32 v7, 0x3a000000, v4
  v_cos_f32 v48, v7
  v_sin_f32 v49, v7
  v_mul_f32 v7, 0x3a800000, v4
  v_cos_f32 v50, v7
  v_sin_f32 v51, v7
  v_mul_f32 v7, 0x3ac00000, v4
  v_cos_f32 v52, v7
  v_sin_f32 v53, v7
  v_mul_f32 v7, 0x3b000000, v4
  v_cos_f32 v54, v7
  v_sin_f32 v55, v7
  v_mul_f32 v7, 0x3b200000, v4
  v_cos_f32 v56, v7
  v_sin_f32 v57, v7
  v_mul_f32 v7, 0x3b400000, v4
  v_cos_f32 v58, v7
  v_sin_f32 v59, v7
  v_mul_f32 v7, 0x3b600000, v4
  v_cos_f32 v60, v7
  v_sin_f32 v61, v7
  v_mul_f32 v7, 0x3b800000, v5
  v_cos_f32 v62, v7
  v_sin_f32 v63, v7
  v_mul_f32 v7, 0x3c000000, v5
  v_cos_f32 v64, v7
  v_sin_f32 v65, v7
  v_mul_f32 v7, 0x3c400000, v5
  v_cos_f32 v66, v7
  v_sin_f32 v67, v7
  v_mul_f32 v7, 0x3c800000, v5
  v_cos_f32 v68, v7
  v_sin_f32 v69, v7
  v_mul_f32 v7, 0x3ca00000, v5
  v_cos_f32 v70, v7
  v_sin_f32 v71, v7
  v_mul_f32 v7, 0x3cc00000, v5
  v_cos_f32 v72, v7
  v_sin_f32 v73, v7
  v_mul_f32 v7, 0x3ce00000, v5
  v_cos_f32 v74, v7
  v_sin_f32 v75, v7
  v_mul_f32 v7, 0x3d000000, v6
  v_cos_f32 v76, v7
  v_sin_f32 v77, v7
  v_mul_f32 v7, 0x3d800000, v6
  v_cos_f32 v78, v7
  v_sin_f32 v79, v7
  v_mul_f32 v7, 0x3dc00000, v6
  v_cos_f32 v80, v7
  v_sin_f32 v81, v7
  v_mul_f32 v7, 0x3e000000, v6
  v_cos_f32 v82, v7
  v_sin_f32 v83, v7
  v_mul_f32 v7, 0x3e200000, v6
  v_cos_f32 v84, v7
  v_sin_f32 v85, v7
  v_mul_f32 v7, 0x3e400000, v6
  v_cos_f32 v86, v7
  v_sin_f32 v87, v7
  v_mul_f32 v7, 0x3e600000, v6
  v_cos_f32 v88, v7
  v_sin_f32 v89, v7
  v_and_b32 v8, 31, v0
  v_lshrrev_b32 v9, 5, v0
  v_lshlrev_b32 v8, 3, v8
  v_lshl_add_u32 v8, v9, 11, v8
  s_lshl_b32 s28, s3, 12
  s_add_u32 s28, s28, 0x8000
  v_and_b32 v9, 31, v0
  v_lshlrev_b32 v9, 3, v9
  v_bfe_u32 v10, v0, 5, 1
  v_lshl_add_u32 v9, v10, 11, v9
  v_add_u32 v9, s28, v9
  v_bfe_u32 v11, v0, 2, 3
  v_lshl_add_u32 v10, v11, 8, v9
  v_and_b32 v11, 63, v0
  v_lshlrev_b32 v11, 3, v11
  v_add_u32 v11, s28, v11
  v_and_b32 v12, 3, v0
  v_lshl_add_u32 v12, v12, 9, v11
  s_waitcnt vmcnt(2)
  v_pk_add_f32 v[16:17], v[32:33], v[40:41] neg_hi:[0,1]
  v_pk_add_f32 v[24:25], v[32:33], v[40:41] op_sel:[1,1] op_sel_hi:[0,0] neg_hi:[1,0]
  v_pk_add_f32 v[18:19], v[34:35], v[42:43] neg_hi:[0,1]
  v_pk_add_f32 v[26:27], v[34:35], v[42:43] op_sel:[1,1] op_sel_hi:[0,0] neg_hi:[1,0]
  v_pk_add_f32 v[20:21], v[36:37], v[44:45] neg_hi:[0,1]
  v_pk_add_f32 v[28:29], v[36:37], v[44:45] op_sel:[1,1] op_sel_hi:[0,0] neg_hi:[1,0]
  v_pk_add_f32 v[22:23], v[38:39], v[46:47] neg_hi:[0,1]
  v_pk_add_f32 v[30:31], v[38:39], v[46:47] op_sel:[1,1] op_sel_hi:[0,0] neg_hi:[1,0]
  v_pk_add_f32 v[32:33], v[16:17], v[24:25]
  v_pk_add_f32 v[40:41], v[16:17], v[24:25] neg_lo:[0,1] neg_hi:[0,1]
  v_pk_add_f32 v[34:35], v[18:19], v[26:27]
  v_pk_add_f32 v[42:43], v[18:19], v[26:27] neg_lo:[0,1] neg_hi:[0,1]
  v_pk_add_f32 v[36:37], v[20:21], v[28:29]
  v_pk_add_f32 v[44:45], v[20:21], v[28:29] neg_lo:[0,1] neg_hi:[0,1]
  v_pk_add_f32 v[38:39], v[22:23], v[30:31]
  v_pk_add_f32 v[46:47], v[22:23], v[30:31] neg_lo:[0,1] neg_hi:[0,1]
  v_pk_add_f32 v[26:27], v[42:43], v[42:43] op_sel:[0,1] op_sel_hi:[1,0] neg_hi:[0,1]
  v_pk_add_f32 v[30:31], v[46:47], v[46:47] op_sel:[0,1] op_sel_hi:[1,0] neg_lo:[0,1]
  v_pk_add_f32 v[16:17], v[32:33], v[36:37]
  v_pk_add_f32 v[18:19], v[32:33], v[36:37] neg_lo:[0,1] neg_hi:[0,1]
  v_pk_mul_f32 v[26:27], v[26:27], s[20:21]
  v_pk_mul_f32 v[30:31], v[30:31], s[22:23]
  v_pk_add_f32 v[20:21], v[34:35], v[38:39]
  v_pk_add_f32 v[22:23], v[34:35], v[38:39] neg_lo:[0,1] neg_hi:[0,1]
  v_pk_add_f32 v[24:25], v[40:41], v[44:45] op_sel:[0,1] op_sel_hi:[1,0] neg_hi:[0,1]
  v_pk_add_f32 v[28:29], v[40:41], v[44:45] op_sel:[0,1] op_sel_hi:[1,0] neg_lo:[0,1]
  v_pk_add_f32 v[42:43], v[26:27], v[30:31]
  v_pk_add_f32 v[46:47], v[26:27], v[30:31] neg_lo:[0,1] neg_hi:[0,1]
  v_pk_add_f32 v[32:33], v[16:17], v[20:21]
  v_pk_add_f32 v[36:37], v[16:17], v[20:21] neg_lo:[0,1] neg_hi:[0,1]
  v_pk_add_f32 v[34:35], v[18:19], v[22:23] op_sel:[0,1] op_sel_hi:[1,0] neg_hi:[0,1]
  v_pk_add_f32 v[38:39], v[18:19], v[22:23] op_sel:[0,1] op_sel_hi:[1,0] neg_lo:[0,1]
  v_pk_add_f32 v[40:41], v[24:25], v[42:43]
  v_pk_add_f32 v[44:45], v[24:25], v[42:43] neg_lo:[0,1] neg_hi:[0,1]
  v_pk_add_f32 v[26:27], v[28:29], v[46:47] op_sel:[0,1] op_sel_hi:[1,0] neg_hi:[0,1]
  v_pk_add_f32 v[30:31], v[28:29], v[46:47] op_sel:[0,1] op_sel_hi:[1,0] neg_lo:[0,1]
  v_pk_mul_f32 v[18:19], v[40:41], v[48:49] op_sel:[0,0] op_sel_hi:[1,0]
  v_pk_fma_f32 v[40:41], v[40:41], v[48:49], v[18:19] op_sel:[1,1,0] op_sel_hi:[0,1,1] neg_hi:[1,0,0]
  v_pk_mul_f32 v[16:17], v[34:35], v[50:51] op_sel:[0,0] op_sel_hi:[1,0]
  v_pk_fma_f32 v[34:35], v[34:35], v[50:51], v[16:17] op_sel:[1,1,0] op_sel_hi:[0,1,1] neg_hi:[1,0,0]
  v_pk_mul_f32 v[18:19], v[26:27], v[52:53] op_sel:[0,0] op_sel_hi:[1,0]
  v_pk_fma_f32 v[26:27], v[26:27], v[52:53], v[18:19] op_sel:[1,1,0] op_sel_hi:[0,1,1] neg_hi:[1,0,0]
  v_pk_mul_f32 v[16:17], v[36:37], v[54:55] op_sel:[0,0] op_sel_hi:[1,0]
  v_pk_fma_f32 v[36:37], v[36:37], v[54:55], v[16:17] op_sel:[1,1,0] op_sel_hi:[0,1,1] neg_hi:[1,0,0]
  v_pk_mul_f32 v[18:19], v[44:45], v[56:57] op_sel:[0,0] op_sel_hi:[1,0]
  v_pk_fma_f32 v[44:45], v[44:45], v[56:57], v[18:19] op_sel:[1,1,0] op_sel_hi:[0,1,1] neg_hi:[1,0,0]
  v_pk_mul_f32 v[16:17], v[38:39], v[58:59] op_sel:[0,0] op_sel_hi:[1,0]
  v_pk_fma_f32 v[38:39], v[38:39], v[58:59], v[16:17] op_sel:[1,1,0] op_sel_hi:[0,1,1] neg_hi:[1,0,0]
  v_pk_mul_f32 v[18:19], v[30:31], v[60:61] op_sel:[0,0] op_sel_hi:[1,0]
  v_pk_fma_f32 v[30:31], v[30:31], v[60:61], v[18:19] op_sel:[1,1,0] op_sel_hi:[0,1,1] neg_hi:[1,0,0]
  ds_write_b64 v1, v[32:33] offset:0
  ds_write_b64 v1, v[40:41] offset:2048
  ds_write_b64 v1, v[34:35] offset:4096
  ds_write_b64 v1, v[26:27] offset:6144
  ds_write_b64 v1, v[36:37] offset:8192
  ds_write_b64 v1, v[44:45] offset:10240
  ds_write_b64 v1, v[38:39] offset:12288
  ds_write_b64 v1, v[30:31] offset:14336
  s_waitcnt lgkmcnt(0)
  s_barrier
  ds_read_b64 v[16:17], v8 offset:0
  ds_read_b64 v[18:19], v8 offset:256
  ds_read_b64 v[20:21], v8 offset:512
  ds_read_b64 v[22:23], v8 offset:768
  ds_read_b64 v[24:25], v8 offset:1024
  ds_read_b64 v[28:29], v8 offset:1280
  ds_read_b64 v[42:43], v8 offset:1536
  ds_read_b64 v[46:47], v8 offset:1792
  s_waitcnt lgkmcnt(0)
  v_pk_add_f32 v[32:33], v[16:17], v[24:25]
  v_pk_add_f32 v[36:37], v[16:17], v[24:25] neg_lo:[0,1] neg_hi:[0,1]
  v_pk_add_f32 v[40:41], v[18:19], v[28:29]
  v_pk_add_f32 v[44:45], v[18:19], v[28:29] neg_lo:[0,1] neg_hi:[0,1]
  v_pk_add_f32 v[34:35], v[20:21], v[42:43]
  v_pk_add_f32 v[38:39], v[20:21], v[42:43] neg_lo:[0,1] neg_hi:[0,1]
  v_pk_add_f32 v[26:27], v[22:23], v[46:47]
  v_pk_add_f32 v[30:31], v[22:23], v[46:47] neg_lo:[0,1] neg_hi:[0,1]
  v_pk_add_f32 v[28:29], v[44:45], v[44:45] op_sel:[0,1] op_sel_hi:[1,0] neg_hi:[0,1]
  v_pk_add_f32 v[46:47], v[30:31], v[30:31] op_sel:[0,1] op_sel_hi:[1,0] neg_lo:[0,1]
  v_pk_add_f32 v[16:17], v[32:33], v[34:35]
  v_pk_add_f32 v[18:19], v[32:33], v[34:35] neg_lo:[0,1] neg_hi:[0,1]
  v_pk_mul_f32 v[28:29], v[28:29], s[20:21]
  v_pk_mul_f32 v[46:47], v[46:47], s[22:23]
  v_pk_add_f32 v[20:21], v[40:41], v[26:27]
  v_pk_add_f32 v[22:23], v[40:41], v[26:27] neg_lo:[0,1] neg_hi:[0,1]
  v_pk_add_f32 v[24:25], v[36:37], v[38:39] op_sel:[0,1] op_sel_hi:[1,0] neg_hi:[0,1]
  v_pk_add_f32 v[42:43], v[36:37], v[38:39] op_sel:[0,1] op_sel_hi:[1,0] neg_lo:[0,1]
  v_pk_add_f32 v[44:45], v[28:29], v[46:47]
  v_pk_add_f32 v[30:31], v[28:29], v[46:47] neg_lo:[0,1] neg_hi:[0,1]
  v_pk_add_f32 v[32:33], v[16:17], v[20:21]
  v_pk_add_f32 v[34:35], v[16:17], v[20:21] neg_lo:[0,1] neg_hi:[0,1]
  v_pk_add_f32 v[40:41], v[18:19], v[22:23] op_sel:[0,1] op_sel_hi:[1,0] neg_hi:[0,1]
  v_pk_add_f32 v[26:27], v[18:19], v[22:23] op_sel:[0,1] op_sel_hi:[1,0] neg_lo:[0,1]
  v_pk_add_f32 v[36:37], v[24:25], v[44:45]
  v_pk_add_f32 v[38:39], v[24:25], v[44:45] neg_lo:[0,1] neg_hi:[0,1]
  v_pk_add_f32 v[28:29], v[42:43], v[30:31] op_sel:[0,1] op_sel_hi:[1,0] neg_hi:[0,1]
  v_pk_add_f32 v[46:47], v[42:43], v[30:31] op_sel:[0,1] op_sel_hi:[1,0] neg_lo:[0,1]
  v_pk_mul_f32 v[18:19], v[36:37], v[62:63] op_sel:[0,0] op_sel_hi:[1,0]
  v_pk_fma_f32 v[36:37], v[36:37], v[62:63], v[18:19] op_sel:[1,1,0] op_sel_hi:[0,1,1] neg_hi:[1,0,0]
  v_pk_mul_f32 v[16:17], v[40:41], v[64:65] op_sel:[0,0] op_sel_hi:[1,0]
  v_pk_fma_f32 v[40:41], v[40:41], v[64:65], v[16:17] op_sel:[1,1,0] op_sel_hi:[0,1,1] neg_hi:[1,0,0]
  v_pk_mul_f32 v[18:19], v[28:29], v[66:67] op_sel:[0,0] op_sel_hi:[1,0]
  v_pk_fma_f32 v[28:29], v[28:29], v[66:67], v[18:19] op_sel:[1,1,0] op_sel_hi:[0,1,1] neg_hi:[1,0,0]
  v_pk_mul_f32 v[16:17], v[34:35], v[68:69] op_sel:[0,0] op_sel_hi:[1,0]
  v_pk_fma_f32 v[34:35], v[34:35], v[68:69], v[16:17] op_sel:[1,1,0] op_sel_hi:[0,1,1] neg_hi:[1,0,0]
  v_pk_mul_f32 v[18:19], v[38:39], v[70:71] op_sel:[0,0] op_sel_hi:[1,0]
  v_pk_fma_f32 v[38:39], v[38:39], v[70:71], v[18:19] op_sel:[1,1,0] op_sel_hi:[0,1,1] neg_hi:[1,0,0]
  v_pk_mul_f32 v[16:17], v[26:27], v[72:73] op_sel:[0,0] op_sel_hi:[1,0]
  v_pk_fma_f32 v[26:27], v[26:27], v[72:73], v[16:17] op_sel:[1,1,0] op_sel_hi:[0,1,1] neg_hi:[1,0,0]
  v_pk_mul_f32 v[18:19], v[46:47], v[74:75] op_sel:[0,0] op_sel_hi:[1,0]
  v_pk_fma_f32 v[46:47], v[46:47], v[74:75], v[18:19] op_sel:[1,1,0] op_sel_hi:[0,1,1] neg_hi:[1,0,0]
  ds_write_b64 v9, v[32:33] offset:0
  v_xor_b32 v14, 32, v9
  ds_write_b64 v14, v[36:37] offset:256
  v_xor_b32 v13, 64, v9
  ds_write_b64 v13, v[40:41] offset:512
  v_xor_b32 v14, 96, v9
  ds_write_b64 v14, v[28:29] offset:768
  v_xor_b32 v13, 128, v9
  ds_write_b64 v13, v[34:35] offset:1024
  v_xor_b32 v14, 160, v9
  ds_write_b64 v14, v[38:39] offset:1280
  v_xor_b32 v13, 192, v9
  ds_write_b64 v13, v[26:27] offset:1536
  v_xor_b32 v14, 224, v9
  ds_write_b64 v14, v[46:47] offset:1792
  ds_read_b64 v[16:17], v10
  v_xor_b32 v14, 32, v10
  ds_read_b64 v[18:19], v14
  v_xor_b32 v13, 64, v10
  ds_read_b64 v[20:21], v13
  v_xor_b32 v14, 96, v10
  ds_read_b64 v[22:23], v14
  v_xor_b32 v13, 128, v10
  ds_read_b64 v[24:25], v13
  v_xor_b32 v14, 160, v10
  ds_read_b64 v[42:43], v14
  v_xor_b32 v13, 192, v10
  ds_read_b64 v[44:45], v13
  v_xor_b32 v14, 224, v10
  ds_read_b64 v[30:31], v14
  s_waitcnt lgkmcnt(0)
  v_pk_add_f32 v[32:33], v[16:17], v[24:25]
  v_pk_add_f32 v[34:35], v[16:17], v[24:25] neg_lo:[0,1] neg_hi:[0,1]
  v_pk_add_f32 v[36:37], v[18:19], v[42:43]
  v_pk_add_f32 v[38:39], v[18:19], v[42:43] neg_lo:[0,1] neg_hi:[0,1]
  v_pk_add_f32 v[40:41], v[20:21], v[44:45]
  v_pk_add_f32 v[26:27], v[20:21], v[44:45] neg_lo:[0,1] neg_hi:[0,1]
  v_pk_add_f32 v[28:29], v[22:23], v[30:31]
  v_pk_add_f32 v[46:47], v[22:23], v[30:31] neg_lo:[0,1] neg_hi:[0,1]
  v_pk_add_f32 v[42:43], v[38:39], v[38:39] op_sel:[0,1] op_sel_hi:[1,0] neg_hi:[0,1]
  v_pk_add_f32 v[30:31], v[46:47], v[46:47] op_sel:[0,1] op_sel_hi:[1,0] neg_lo:[0,1]
  v_pk_add_f32 v[16:17], v[32:33], v[40:41]
  v_pk_add_f32 v[18:19], v[32:33], v[40:41] neg_lo:[0,1] neg_hi:[0,1]
  v_pk_mul_f32 v[42:43], v[42:43], s[20:21]
  v_pk_mul_f32 v[30:31], v[30:31], s[22:23]
  v_pk_add_f32 v[20:21], v[36:37], v[28:29]
  v_pk_add_f32 v[22:23], v[36:37], v[28:29] neg_lo:[0,1] neg_hi:[0,1]
  v_pk_add_f32 v[24:25], v[34:35], v[26:27] op_sel:[0,1] op_sel_hi:[1,0] neg_hi:[0,1]
  v_pk_add_f32 v[44:45], v[34:35], v[26:27] op_sel:[0,1] op_sel_hi:[1,0] neg_lo:[0,1]
  v_pk_add_f32 v[38:39], v[42:43], v[30:31]
  v_pk_add_f32 v[46:47], v[42:43], v[30:31] neg_lo:[0,1] neg_hi:[0,1]
  v_pk_add_f32 v[32:33], v[16:17], v[20:21]
  v_pk_add_f32 v[40:41], v[16:17], v[20:21] neg_lo:[0,1] neg_hi:[0,1]
  v_pk_add_f32 v[36:37], v[18:19], v[22:23] op_sel:[0,1] op_sel_hi:[1,0] neg_hi:[0,1]
  v_pk_add_f32 v[28:29], v[18:19], v[22:23] op_sel:[0,1] op_sel_hi:[1,0] neg_lo:[0,1]
  v_pk_add_f32 v[34:35], v[24:25], v[38:39]
  v_pk_add_f32 v[26:27], v[24:25], v[38:39] neg_lo:[0,1] neg_hi:[0,1]
  v_pk_add_f32 v[42:43], v[44:45], v[46:47] op_sel:[0,1] op_sel_hi:[1,0] neg_hi:[0,1]
  v_pk_add_f32 v[30:31], v[44:45], v[46:47] op_sel:[0,1] op_sel_hi:[1,0] neg_lo:[0,1]
  v_pk_mul_f32 v[18:19], v[34:35], v[76:77] op_sel:[0,0] op_sel_hi:[1,0]
  v_pk_fma_f32 v[34:35], v[34:35], v[76:77], v[18:19] op_sel:[1,1,0] op_sel_hi:[0,1,1] neg_hi:[1,0,0]
  v_pk_mul_f32 v[16:17], v[36:37], v[78:79] op_sel:[0,0] op_sel_hi:[1,0]
  v_pk_fma_f32 v[36:37], v[36:37], v[78:79], v[16:17] op_sel:[1,1,0] op_sel_hi:[0,1,1] neg_hi:[1,0,0]
  v_pk_mul_f32 v[18:19], v[42:43], v[80:81] op_sel:[0,0] op_sel_hi:[1,0]
  v_pk_fma_f32 v[42:43], v[42:43], v[80:81], v[18:19] op_sel:[1,1,0] op_sel_hi:[0,1,1] neg_hi:[1,0,0]
  v_pk_mul_f32 v[16:17], v[40:41], v[82:83] op_sel:[0,0] op_sel_hi:[1,0]
  v_pk_fma_f32 v[40:41], v[40:41], v[82:83], v[16:17] op_sel:[1,1,0] op_sel_hi:[0,1,1] neg_hi:[1,0,0]
  v_pk_mul_f32 v[18:19], v[26:27], v[84:85] op_sel:[0,0] op_sel_hi:[1,0]
  v_pk_fma_f32 v[26:27], v[26:27], v[84:85], v[18:19] op_sel:[1,1,0] op_sel_hi:[0,1,1] neg_hi:[1,0,0]
  v_pk_mul_f32 v[16:17], v[28:29], v[86:87] op_sel:[0,0] op_sel_hi:[1,0]
  v_pk_fma_f32 v[28:29], v[28:29], v[86:87], v[16:17] op_sel:[1,1,0] op_sel_hi:[0,1,1] neg_hi:[1,0,0]
  v_pk_mul_f32 v[18:19], v[30:31], v[88:89] op_sel:[0,0] op_sel_hi:[1,0]
  v_pk_fma_f32 v[30:31], v[30:31], v[88:89], v[18:19] op_sel:[1,1,0] op_sel_hi:[0,1,1] neg_hi:[1,0,0]
  ds_write_b64 v11, v[32:33] offset:0
  v_xor_b32 v14, 8, v11
  ds_write_b64 v14, v[34:35] offset:512
  v_xor_b32 v13, 16, v11
  ds_write_b64 v13, v[36:37] offset:1024
  v_xor_b32 v14, 24, v11
  ds_write_b64 v14, v[42:43] offset:1536
  ds_write_b64 v11, v[40:41] offset:2048
  v_xor_b32 v14, 8, v11
  ds_write_b64 v14, v[26:27] offset:2560
  v_xor_b32 v13, 16, v11
  ds_write_b64 v13, v[28:29] offset:3072
  v_xor_b32 v14, 24, v11
  ds_write_b64 v14, v[30:31] offset:3584
  ds_read_b64 v[16:17], v12 offset:0
  v_xor_b32 v14, 8, v12
  ds_read_b64 v[18:19], v14 offset:0
  v_xor_b32 v13, 16, v12
  ds_read_b64 v[20:21], v13 offset:0
  v_xor_b32 v14, 24, v12
  ds_read_b64 v[22:23], v14 offset:0
  ds_read_b64 v[24:25], v12 offset:2048
  v_xor_b32 v14, 8, v12
  ds_read_b64 v[44:45], v14 offset:2048
  v_xor_b32 v13, 16, v12
  ds_read_b64 v[38:39], v13 offset:2048
  v_xor_b32 v14, 24, v12
  ds_read_b64 v[46:47], v14 offset:2048
  s_waitcnt lgkmcnt(0)
  v_pk_add_f32 v[32:33], v[16:17], v[20:21]
  v_pk_add_f32 v[34:35], v[16:17], v[20:21] neg_lo:[0,1] neg_hi:[0,1]
  v_pk_add_f32 v[36:37], v[18:19], v[22:23]
  v_pk_add_f32 v[42:43], v[18:19], v[22:23] neg_lo:[0,1] neg_hi:[0,1]
  v_pk_add_f32 v[16:17], v[32:33], v[36:37]
  v_pk_add_f32 v[20:21], v[32:33], v[36:37] neg_lo:[0,1] neg_hi:[0,1]
  v_pk_add_f32 v[18:19], v[34:35], v[42:43] op_sel:[0,1] op_sel_hi:[1,0] neg_hi:[0,1]
  v_pk_add_f32 v[22:23], v[34:35], v[42:43] op_sel:[0,1] op_sel_hi:[1,0] neg_lo:[0,1]
  v_pk_add_f32 v[40:41], v[24:25], v[38:39]
  v_pk_add_f32 v[26:27], v[24:25], v[38:39] neg_lo:[0,1] neg_hi:[0,1]
  v_pk_add_f32 v[28:29], v[44:45], v[46:47]
  v_pk_add_f32 v[30:31], v[44:45], v[46:47] neg_lo:[0,1] neg_hi:[0,1]
  v_pk_add_f32 v[24:25], v[40:41], v[28:29]
  v_pk_add_f32 v[38:39], v[40:41], v[28:29] neg_lo:[0,1] neg_hi:[0,1]
  v_pk_add_f32 v[44:45], v[26:27], v[30:31] op_sel:[0,1] op_sel_hi:[1,0] neg_hi:[0,1]
  v_pk_add_f32 v[46:47], v[26:27], v[30:31] op_sel:[0,1] op_sel_hi:[1,0] neg_lo:[0,1]
  s_waitcnt vmcnt(0)
  v_lshlrev_b32 v32, 16, v90
  v_and_b32 v33, 0xffff0000, v90
  v_lshlrev_b32 v34, 16, v91
  v_and_b32 v35, 0xffff0000, v91
  v_lshlrev_b32 v36, 16, v92
  v_and_b32 v37, 0xffff0000, v92
  v_lshlrev_b32 v42, 16, v93
  v_and_b32 v43, 0xffff0000, v93
  v_lshlrev_b32 v40, 16, v94
  v_and_b32 v41, 0xffff0000, v94
  v_lshlrev_b32 v26, 16, v95
  v_and_b32 v27, 0xffff0000, v95
  v_lshlrev_b32 v28, 16, v96
  v_and_b32 v29, 0xffff0000, v96
  v_lshlrev_b32 v30, 16, v97
  v_and_b32 v31, 0xffff0000, v97
  v_pk_mul_f32 v[4:5], v[16:17], v[32:33] op_sel:[0,0] op_sel_hi:[0,1]
  v_pk_fma_f32 v[16:17], v[16:17], v[32:33], v[4:5] op_sel:[1,1,0] op_sel_hi:[1,0,1] neg_lo:[1,0,0]
  v_pk_mul_f32 v[6:7], v[18:19], v[34:35] op_sel:[0,0] op_sel_hi:[0,1]
  v_pk_fma_f32 v[18:19], v[18:19], v[34:35], v[6:7] op_sel:[1,1,0] op_sel_hi:[1,0,1] neg_lo:[1,0,0]
  v_pk_mul_f32 v[4:5], v[20:21], v[36:37] op_sel:[0,0] op_sel_hi:[0,1]
  v_pk_fma_f32 v[20:21], v[20:21], v[36:37], v[4:5] op_sel:[1,1,0] op_sel_hi:[1,0,1] neg_lo:[1,0,0]
  v_pk_mul_f32 v[6:7], v[22:23], v[42:43] op_sel:[0,0] op_sel_hi:[0,1]
  v_pk_fma_f32 v[22:23], v[22:23], v[42:43], v[6:7] op_sel:[1,1,0] op_sel_hi:[1,0,1] neg_lo:[1,0,0]
  v_pk_mul_f32 v[4:5], v[24:25], v[40:41] op_sel:[0,0] op_sel_hi:[0,1]
  v_pk_fma_f32 v[24:25], v[24:25], v[40:41], v[4:5] op_sel:[1,1,0] op_sel_hi:[1,0,1] neg_lo:[1,0,0]
  v_pk_mul_f32 v[6:7], v[44:45], v[26:27] op_sel:[0,0] op_sel_hi:[0,1]
  v_pk_fma_f32 v[44:45], v[44:45], v[26:27], v[6:7] op_sel:[1,1,0] op_sel_hi:[1,0,1] neg_lo:[1,0,0]
  v_pk_mul_f32 v[4:5], v[38:39], v[28:29] op_sel:[0,0] op_sel_hi:[0,1]
  v_pk_fma_f32 v[38:39], v[38:39], v[28:29], v[4:5] op_sel:[1,1,0] op_sel_hi:[1,0,1] neg_lo:[1,0,0]
  v_pk_mul_f32 v[6:7], v[46:47], v[30:31] op_sel:[0,0] op_sel_hi:[0,1]
  v_pk_fma_f32 v[46:47], v[46:47], v[30:31], v[6:7] op_sel:[1,1,0] op_sel_hi:[1,0,1] neg_lo:[1,0,0]
  v_pk_add_f32 v[32:33], v[16:17], v[20:21]
  v_pk_add_f32 v[34:35], v[16:17], v[20:21] neg_lo:[0,1] neg_hi:[0,1]
  v_pk_add_f32 v[36:37], v[18:19], v[22:23]
  v_pk_add_f32 v[42:43], v[18:19], v[22:23] neg_lo:[0,1] neg_hi:[0,1]
  v_pk_add_f32 v[16:17], v[32:33], v[36:37]
  v_pk_add_f32 v[20:21], v[32:33], v[36:37] neg_lo:[0,1] neg_hi:[0,1]
  v_pk_add_f32 v[18:19], v[34:35], v[42:43] op_sel:[0,1] op_sel_hi:[1,0] neg_lo:[0,1]
  v_pk_add_f32 v[22:23], v[34:35], v[42:43] op_sel:[0,1] op_sel_hi:[1,0] neg_hi:[0,1]
  v_pk_add_f32 v[40:41], v[24:25], v[38:39]
  v_pk_add_f32 v[26:27], v[24:25], v[38:39] neg_lo:[0,1] neg_hi:[0,1]
  v_pk_add_f32 v[28:29], v[44:45], v[46:47]
  v_pk_add_f32 v[30:31], v[44:45], v[46:47] neg_lo:[0,1] neg_hi:[0,1]
  v_pk_add_f32 v[24:25], v[40:41], v[28:29]
  v_pk_add_f32 v[38:39], v[40:41], v[28:29] neg_lo:[0,1] neg_hi:[0,1]
  v_pk_add_f32 v[44:45], v[26:27], v[30:31] op_sel:[0,1] op_sel_hi:[1,0] neg_lo:[0,1]
  v_pk_add_f32 v[46:47], v[26:27], v[30:31] op_sel:[0,1] op_sel_hi:[1,0] neg_hi:[0,1]
  ds_write_b64 v12, v[16:17] offset:0
  v_xor_b32 v14, 8, v12
  ds_write_b64 v14, v[18:19] offset:0
  v_xor_b32 v13, 16, v12
  ds_write_b64 v13, v[20:21] offset:0
  v_xor_b32 v14, 24, v12
  ds_write_b64 v14, v[22:23] offset:0
  ds_write_b64 v12, v[24:25] offset:2048
  v_xor_b32 v14, 8, v12
  ds_write_b64 v14, v[44:45] offset:2048
  v_xor_b32 v13, 16, v12
  ds_write_b64 v13, v[38:39] offset:2048
  v_xor_b32 v14, 24, v12
  ds_write_b64 v14, v[46:47] offset:2048
  ds_read_b64 v[32:33], v11 offset:0
  v_xor_b32 v14, 8, v11
  ds_read_b64 v[34:35], v14 offset:512
  v_xor_b32 v13, 16, v11
  ds_read_b64 v[36:37], v13 offset:1024
  v_xor_b32 v14, 24, v11
  ds_read_b64 v[42:43], v14 offset:1536
  ds_read_b64 v[40:41], v11 offset:2048
  v_xor_b32 v14, 8, v11
  ds_read_b64 v[26:27], v14 offset:2560
  v_xor_b32 v13, 16, v11
  ds_read_b64 v[28:29], v13 offset:3072
  v_xor_b32 v14, 24, v11
  ds_read_b64 v[30:31], v14 offset:3584
  s_waitcnt lgkmcnt(0)
  v_pk_mul_f32 v[6:7], v[34:35], v[76:77] op_sel:[0,0] op_sel_hi:[0,1]
  v_pk_fma_f32 v[34:35], v[34:35], v[76:77], v[6:7] op_sel:[1,1,0] op_sel_hi:[1,0,1] neg_lo:[1,0,0]
  v_pk_mul_f32 v[4:5], v[36:37], v[78:79] op_sel:[0,0] op_sel_hi:[0,1]
  v_pk_fma_f32 v[36:37], v[36:37], v[78:79], v[4:5] op_sel:[1,1,0] op_sel_hi:[1,0,1] neg_lo:[1,0,0]
  v_pk_mul_f32 v[6:7], v[42:43], v[80:81] op_sel:[0,0] op_sel_hi:[0,1]
  v_pk_fma_f32 v[42:43], v[42:43], v[80:81], v[6:7] op_sel:[1,1,0] op_sel_hi:[1,0,1] neg_lo:[1,0,0]
  v_pk_mul_f32 v[4:5], v[40:41], v[82:83] op_sel:[0,0] op_sel_hi:[0,1]
  v_pk_fma_f32 v[40:41], v[40:41], v[82:83], v[4:5] op_sel:[1,1,0] op_sel_hi:[1,0,1] neg_lo:[1,0,0]
  v_pk_mul_f32 v[6:7], v[26:27], v[84:85] op_sel:[0,0] op_sel_hi:[0,1]
  v_pk_fma_f32 v[26:27], v[26:27], v[84:85], v[6:7] op_sel:[1,1,0] op_sel_hi:[1,0,1] neg_lo:[1,0,0]
  v_pk_mul_f32 v[4:5], v[28:29], v[86:87] op_sel:[0,0] op_sel_hi:[0,1]
  v_pk_fma_f32 v[28:29], v[28:29], v[86:87], v[4:5] op_sel:[1,1,0] op_sel_hi:[1,0,1] neg_lo:[1,0,0]
  v_pk_mul_f32 v[6:7], v[30:31], v[88:89] op_sel:[0,0] op_sel_hi:[0,1]
  v_pk_fma_f32 v[30:31], v[30:31], v[88:89], v[6:7] op_sel:[1,1,0] op_sel_hi:[1,0,1] neg_lo:[1,0,0]
  v_pk_add_f32 v[16:17], v[32:33], v[40:41]
  v_pk_add_f32 v[24:25], v[32:33], v[40:41] neg_lo:[0,1] neg_hi:[0,1]
  v_pk_add_f32 v[18:19], v[34:35], v[26:27]
  v_pk_add_f32 v[44:45], v[34:35], v[26:27] neg_lo:[0,1] neg_hi:[0,1]
  v_pk_add_f32 v[20:21], v[36:37], v[28:29]
  v_pk_add_f32 v[38:39], v[36:37], v[28:29] neg_lo:[0,1] neg_hi:[0,1]
  v_pk_add_f32 v[22:23], v[42:43], v[30:31]
  v_pk_add_f32 v[46:47], v[42:43], v[30:31] neg_lo:[0,1] neg_hi:[0,1]
  v_pk_add_f32 v[26:27], v[44:45], v[44:45] op_sel:[0,1] op_sel_hi:[1,0] neg_lo:[0,1]
  v_pk_add_f32 v[30:31], v[46:47], v[46:47] op_sel:[0,1] op_sel_hi:[1,0] neg_hi:[0,1]
  v_pk_add_f32 v[32:33], v[16:17], v[20:21]
  v_pk_add_f32 v[34:35], v[16:17], v[20:21] neg_lo:[0,1] neg_hi:[0,1]
  v_pk_mul_f32 v[26:27], v[26:27], s[20:21]
  v_pk_mul_f32 v[30:31], v[30:31], s[22:23]
  v_pk_add_f32 v[36:37], v[18:19], v[22:23]
  v_pk_add_f32 v[42:43], v[18:19], v[22:23] neg_lo:[0,1] neg_hi:[0,1]
  v_pk_add_f32 v[40:41], v[24:25], v[38:39] op_sel:[0,1] op_sel_hi:[1,0] neg_lo:[0,1]
  v_pk_add_f32 v[28:29], v[24:25], v[38:39] op_sel:[0,1] op_sel_hi:[1,0] neg_hi:[0,1]
  v_pk_add_f32 v[44:45], v[26:27], v[30:31]
  v_pk_add_f32 v[46:47], v[26:27], v[30:31] neg_lo:[0,1] neg_hi:[0,1]
  v_pk_add_f32 v[16:17], v[32:33], v[36:37]
  v_pk_add_f32 v[20:21], v[32:33], v[36:37] neg_lo:[0,1] neg_hi:[0,1]
  v_pk_add_f32 v[18:19], v[34:35], v[42:43] op_sel:[0,1] op_sel_hi:[1,0] neg_lo:[0,1]
  v_pk_add_f32 v[22:23], v[34:35], v[42:43] op_sel:[0,1] op_sel_hi:[1,0] neg_hi:[0,1]
  v_pk_add_f32 v[24:25], v[40:41], v[44:45]
  v_pk_add_f32 v[38:39], v[40:41], v[44:45] neg_lo:[0,1] neg_hi:[0,1]
  v_pk_add_f32 v[26:27], v[28:29], v[46:47] op_sel:[0,1] op_sel_hi:[1,0] neg_lo:[0,1]
  v_pk_add_f32 v[30:31], v[28:29], v[46:47] op_sel:[0,1] op_sel_hi:[1,0] neg_hi:[0,1]
  ds_write_b64 v10, v[16:17]
  v_xor_b32 v14, 32, v10
  ds_write_b64 v14, v[24:25]
  v_xor_b32 v13, 64, v10
  ds_write_b64 v13, v[18:19]
  v_xor_b32 v14, 96, v10
  ds_write_b64 v14, v[26:27]
  v_xor_b32 v13, 128, v10
  ds_write_b64 v13, v[20:21]
  v_xor_b32 v14, 160, v10
  ds_write_b64 v14, v[38:39]
  v_xor_b32 v13, 192, v10
  ds_write_b64 v13, v[22:23]
  v_xor_b32 v14, 224, v10
  ds_write_b64 v14, v[30:31]
  ds_read_b64 v[32:33], v9 offset:0
  v_xor_b32 v14, 32, v9
  ds_read_b64 v[34:35], v14 offset:256
  v_xor_b32 v13, 64, v9
  ds_read_b64 v[36:37], v13 offset:512
  v_xor_b32 v14, 96, v9
  ds_read_b64 v[42:43], v14 offset:768
  v_xor_b32 v13, 128, v9
  ds_read_b64 v[40:41], v13 offset:1024
  v_xor_b32 v14, 160, v9
  ds_read_b64 v[28:29], v14 offset:1280
  v_xor_b32 v13, 192, v9
  ds_read_b64 v[44:45], v13 offset:1536
  v_xor_b32 v14, 224, v9
  ds_read_b64 v[46:47], v14 offset:1792
  s_waitcnt lgkmcnt(0)
  v_pk_mul_f32 v[6:7], v[34:35], v[62:63] op_sel:[0,0] op_sel_hi:[0,1]
  v_pk_fma_f32 v[34:35], v[34:35], v[62:63], v[6:7] op_sel:[1,1,0] op_sel_hi:[1,0,1] neg_lo:[1,0,0]
  v_pk_mul_f32 v[4:5], v[36:37], v[64:65] op_sel:[0,0] op_sel_hi:[0,1]
  v_pk_fma_f32 v[36:37], v[36:37], v[64:65], v[4:5] op_sel:[1,1,0] op_sel_hi:[1,0,1] neg_lo:[1,0,0]
  v_pk_mul_f32 v[6:7], v[42:43], v[66:67] op_sel:[0,0] op_sel_hi:[0,1]
  v_pk_fma_f32 v[42:43], v[42:43], v[66:67], v[6:7] op_sel:[1,1,0] op_sel_hi:[1,0,1] neg_lo:[1,0,0]
  v_pk_mul_f32 v[4:5], v[40:41], v[68:69] op_sel:[0,0] op_sel_hi:[0,1]
  v_pk_fma_f32 v[40:41], v[40:41], v[68:69], v[4:5] op_sel:[1,1,0] op_sel_hi:[1,0,1] neg_lo:[1,0,0]
  v_pk_mul_f32 v[6:7], v[28:29], v[70:71] op_sel:[0,0] op_sel_hi:[0,1]
  v_pk_fma_f32 v[28:29], v[28:29], v[70:71], v[6:7] op_sel:[1,1,0] op_sel_hi:[1,0,1] neg_lo:[1,0,0]
  v_pk_mul_f32 v[4:5], v[44:45], v[72:73] op_sel:[0,0] op_sel_hi:[0,1]
  v_pk_fma_f32 v[44:45], v[44:45], v[72:73], v[4:5] op_sel:[1,1,0] op_sel_hi:[1,0,1] neg_lo:[1,0,0]
  v_pk_mul_f32 v[6:7], v[46:47], v[74:75] op_sel:[0,0] op_sel_hi:[0,1]
  v_pk_fma_f32 v[46:47], v[46:47], v[74:75], v[6:7] op_sel:[1,1,0] op_sel_hi:[1,0,1] neg_lo:[1,0,0]
  v_pk_add_f32 v[16:17], v[32:33], v[40:41]
  v_pk_add_f32 v[20:21], v[32:33], v[40:41] neg_lo:[0,1] neg_hi:[0,1]
  v_pk_add_f32 v[24:25], v[34:35], v[28:29]
  v_pk_add_f32 v[38:39], v[34:35], v[28:29] neg_lo:[0,1] neg_hi:[0,1]
  v_pk_add_f32 v[18:19], v[36:37], v[44:45]
  v_pk_add_f32 v[22:23], v[36:37], v[44:45] neg_lo:[0,1] neg_hi:[0,1]
  v_pk_add_f32 v[26:27], v[42:43], v[46:47]
  v_pk_add_f32 v[30:31], v[42:43], v[46:47] neg_lo:[0,1] neg_hi:[0,1]
  v_pk_add_f32 v[28:29], v[38:39], v[38:39] op_sel:[0,1] op_sel_hi:[1,0] neg_lo:[0,1]
  v_pk_add_f32 v[46:47], v[30:31], v[30:31] op_sel:[0,1] op_sel_hi:[1,0] neg_hi:[0,1]
  v_pk_add_f32 v[32:33], v[16:17], v[18:19]
  v_pk_add_f32 v[34:35], v[16:17], v[18:19] neg_lo:[0,1] neg_hi:[0,1]
  v_pk_mul_f32 v[28:29], v[28:29], s[20:21]
  v_pk_mul_f32 v[46:47], v[46:47], s[22:23]
  v_pk_add_f32 v[36:37], v[24:25], v[26:27]
  v_pk_add_f32 v[42:43], v[24:25], v[26:27] neg_lo:[0,1] neg_hi:[0,1]
  v_pk_add_f32 v[40:41], v[20:21], v[22:23] op_sel:[0,1] op_sel_hi:[1,0] neg_lo:[0,1]
  v_pk_add_f32 v[44:45], v[20:21], v[22:23] op_sel:[0,1] op_sel_hi:[1,0] neg_hi:[0,1]
  v_pk_add_f32 v[38:39], v[28:29], v[46:47]
  v_pk_add_f32 v[30:31], v[28:29], v[46:47] neg_lo:[0,1] neg_hi:[0,1]
  v_pk_add_f32 v[16:17], v[32:33], v[36:37]
  v_pk_add_f32 v[18:19], v[32:33], v[36:37] neg_lo:[0,1] neg_hi:[0,1]
  v_pk_add_f32 v[24:25], v[34:35], v[42:43] op_sel:[0,1] op_sel_hi:[1,0] neg_lo:[0,1]
  v_pk_add_f32 v[26:27], v[34:35], v[42:43] op_sel:[0,1] op_sel_hi:[1,0] neg_hi:[0,1]
  v_pk_add_f32 v[20:21], v[40:41], v[38:39]
  v_pk_add_f32 v[22:23], v[40:41], v[38:39] neg_lo:[0,1] neg_hi:[0,1]
  v_pk_add_f32 v[28:29], v[44:45], v[30:31] op_sel:[0,1] op_sel_hi:[1,0] neg_lo:[0,1]
  v_pk_add_f32 v[46:47], v[44:45], v[30:31] op_sel:[0,1] op_sel_hi:[1,0] neg_hi:[0,1]
  ds_write_b64 v8, v[16:17] offset:16384
  ds_write_b64 v8, v[20:21] offset:16640
  ds_write_b64 v8, v[24:25] offset:16896
  ds_write_b64 v8, v[28:29] offset:17152
  ds_write_b64 v8, v[18:19] offset:17408
  ds_write_b64 v8, v[22:23] offset:17664
  ds_write_b64 v8, v[26:27] offset:17920
  ds_write_b64 v8, v[46:47] offset:18176
  s_waitcnt lgkmcnt(0)
  s_barrier
  ds_read_b64 v[32:33], v1 offset:16384
  ds_read_b64 v[34:35], v1 offset:18432
  ds_read_b64 v[36:37], v1 offset:20480
  ds_read_b64 v[42:43], v1 offset:22528
  ds_read_b64 v[40:41], v1 offset:24576
  ds_read_b64 v[44:45], v1 offset:26624
  ds_read_b64 v[38:39], v1 offset:28672
  ds_read_b64 v[30:31], v1 offset:30720
  s_waitcnt lgkmcnt(0)
  v_pk_mul_f32 v[6:7], v[34:35], v[48:49] op_sel:[0,0] op_sel_hi:[0,1]
  v_pk_fma_f32 v[34:35], v[34:35], v[48:49], v[6:7] op_sel:[1,1,0] op_sel_hi:[1,0,1] neg_lo:[1,0,0]
  v_pk_mul_f32 v[4:5], v[36:37], v[50:51] op_sel:[0,0] op_sel_hi:[0,1]
  v_pk_fma_f32 v[36:37], v[36:37], v[50:51], v[4:5] op_sel:[1,1,0] op_sel_hi:[1,0,1] neg_lo:[1,0,0]
  v_pk_mul_f32 v[6:7], v[42:43], v[52:53] op_sel:[0,0] op_sel_hi:[0,1]
  v_pk_fma_f32 v[42:43], v[42:43], v[52:53], v[6:7] op_sel:[1,1,0] op_sel_hi:[1,0,1] neg_lo:[1,0,0]
  v_pk_mul_f32 v[4:5], v[40:41], v[54:55] op_sel:[0,0] op_sel_hi:[0,1]
  v_pk_fma_f32 v[40:41], v[40:41], v[54:55], v[4:5] op_sel:[1,1,0] op_sel_hi:[1,0,1] neg_lo:[1,0,0]
  v_pk_mul_f32 v[6:7], v[44:45], v[56:57] op_sel:[0,0] op_sel_hi:[0,1]
  v_pk_fma_f32 v[44:45], v[44:45], v[56:57], v[6:7] op_sel:[1,1,0] op_sel_hi:[1,0,1] neg_lo:[1,0,0]
  v_pk_mul_f32 v[4:5], v[38:39], v[58:59] op_sel:[0,0] op_sel_hi:[0,1]
  v_pk_fma_f32 v[38:39], v[38:39], v[58:59], v[4:5] op_sel:[1,1,0] op_sel_hi:[1,0,1] neg_lo:[1,0,0]
  v_pk_mul_f32 v[6:7], v[30:31], v[60:61] op_sel:[0,0] op_sel_hi:[0,1]
  v_pk_fma_f32 v[30:31], v[30:31], v[60:61], v[6:7] op_sel:[1,1,0] op_sel_hi:[1,0,1] neg_lo:[1,0,0]
  v_pk_add_f32 v[16:17], v[32:33], v[40:41]
  v_pk_add_f32 v[18:19], v[32:33], v[40:41] neg_lo:[0,1] neg_hi:[0,1]
  v_pk_add_f32 v[20:21], v[34:35], v[44:45]
  v_pk_add_f32 v[22:23], v[34:35], v[44:45] neg_lo:[0,1] neg_hi:[0,1]
  v_pk_add_f32 v[24:25], v[36:37], v[38:39]
  v_pk_add_f32 v[26:27], v[36:37], v[38:39] neg_lo:[0,1] neg_hi:[0,1]
  v_pk_add_f32 v[28:29], v[42:43], v[30:31]
  v_pk_add_f32 v[46:47], v[42:43], v[30:31] neg_lo:[0,1] neg_hi:[0,1]
  v_pk_add_f32 v[44:45], v[22:23], v[22:23] op_sel:[0,1] op_sel_hi:[1,0] neg_lo:[0,1]
  v_pk_add_f32 v[30:31], v[46:47], v[46:47] op_sel:[0,1] op_sel_hi:[1,0] neg_hi:[0,1]
  v_pk_add_f32 v[32:33], v[16:17], v[24:25]
  v_pk_add_f32 v[34:35], v[16:17], v[24:25] neg_lo:[0,1] neg_hi:[0,1]
  v_pk_mul_f32 v[44:45], v[44:45], s[20:21]
  v_pk_mul_f32 v[30:31], v[30:31], s[22:23]
  v_pk_add_f32 v[36:37], v[20:21], v[28:29]
  v_pk_add_f32 v[42:43], v[20:21], v[28:29] neg_lo:[0,1] neg_hi:[0,1]
  v_pk_add_f32 v[40:41], v[18:19], v[26:27] op_sel:[0,1] op_sel_hi:[1,0] neg_lo:[0,1]
  v_pk_add_f32 v[38:39], v[18:19], v[26:27] op_sel:[0,1] op_sel_hi:[1,0] neg_hi:[0,1]
  v_pk_add_f32 v[22:23], v[44:45], v[30:31]
  v_pk_add_f32 v[46:47], v[44:45], v[30:31] neg_lo:[0,1] neg_hi:[0,1]
  v_pk_add_f32 v[16:17], v[32:33], v[36:37]
  v_pk_add_f32 v[24:25], v[32:33], v[36:37] neg_lo:[0,1] neg_hi:[0,1]
  v_pk_add_f32 v[20:21], v[34:35], v[42:43] op_sel:[0,1] op_sel_hi:[1,0] neg_lo:[0,1]
  v_pk_add_f32 v[28:29], v[34:35], v[42:43] op_sel:[0,1] op_sel_hi:[1,0] neg_hi:[0,1]
  v_pk_add_f32 v[18:19], v[40:41], v[22:23]
  v_pk_add_f32 v[26:27], v[40:41], v[22:23] neg_lo:[0,1] neg_hi:[0,1]
  v_pk_add_f32 v[44:45], v[38:39], v[46:47] op_sel:[0,1] op_sel_hi:[1,0] neg_lo:[0,1]
  v_pk_add_f32 v[30:31], v[38:39], v[46:47] op_sel:[0,1] op_sel_hi:[1,0] neg_hi:[0,1]
  v_lshrrev_b32 v2, 3, v0
  v_and_b32 v3, 7, v0
  v_lshlrev_b32 v3, 3, v3
  v_lshl_add_u32 v2, v2, 15, v3
  s_lshr_b32 s16, s16, 7
  s_lshr_b32 s17, s17, 7
  s_and_b32 s29, s2, 255
  s_cmp_eq_u32 s29, 0
  s_cbranch_scc1 L_p2_kernel_spec_3
  v_pk_add_f32 v[32:33], v[16:17], v[24:25] op_sel:[0,1] op_sel_hi:[1,0] neg_lo:[0,1]
  v_pk_add_f32 v[40:41], v[16:17], v[24:25] op_sel:[0,1] op_sel_hi:[1,0] neg_hi:[1,0]
  v_pk_add_f32 v[34:35], v[18:19], v[26:27] op_sel:[0,1] op_sel_hi:[1,0] neg_lo:[0,1]
  v_pk_add_f32 v[38:39], v[18:19], v[26:27] op_sel:[0,1] op_sel_hi:[1,0] neg_hi:[1,0]
  v_pk_add_f32 v[36:37], v[20:21], v[28:29] op_sel:[0,1] op_sel_hi:[1,0] neg_lo:[0,1]
  v_pk_add_f32 v[22:23], v[20:21], v[28:29] op_sel:[0,1] op_sel_hi:[1,0] neg_hi:[1,0]
  v_pk_add_f32 v[42:43], v[44:45], v[30:31] op_sel:[0,1] op_sel_hi:[1,0] neg_lo:[0,1]
  v_pk_add_f32 v[46:47], v[44:45], v[30:31] op_sel:[0,1] op_sel_hi:[1,0] neg_hi:[1,0]
  buffer_store_dwordx2 v[32:33], v2, s[12:15], s16 offen
  buffer_store_dwordx2 v[40:41], v2, s[12:15], s17 offen
  s_add_u32 s16, s16, 1048576
  s_add_u32 s17, s17, 1048576
  buffer_store_dwordx2 v[34:35], v2, s[12:15], s16 offen
  buffer_store_dwordx2 v[38:39], v2, s[12:15], s17 offen
  s_add_u32 s16, s16, 1048576
  s_add_u32 s17, s17, 1048576
  buffer_store_dwordx2 v[36:37], v2, s[12:15], s16 offen
  buffer_store_dwordx2 v[22:23], v2, s[12:15], s17 offen
  s_add_u32 s16, s16, 1048576
  s_add_u32 s17, s17, 1048576
  buffer_store_dwordx2 v[42:43], v2, s[12:15], s16 offen
  buffer_store_dwordx2 v[46:47], v2, s[12:15], s17 offen
  s_endpgm
L_p2_kernel_spec_3:
  v_mov_b32 v17, v24
  v_mov_b32 v19, v26
  v_mov_b32 v21, v28
  v_mov_b32 v45, v30
  buffer_store_dwordx2 v[16:17], v2, s[12:15], s16 offen
  s_add_u32 s16, s16, 1048576
  buffer_store_dwordx2 v[18:19], v2, s[12:15], s16 offen
  s_add_u32 s16, s16, 1048576
  buffer_store_dwordx2 v[20:21], v2, s[12:15], s16 offen
  s_add_u32 s16, s16, 1048576
  buffer_store_dwordx2 v[44:45], v2, s[12:15], s16 offen
L_p2_kernel_end_1:
  s_endpgm
.globl c0_kernel
.p2align 8
.type c0_kernel,@function
c0_kernel:
  s_cmp_ge_u32 s2, 256
  s_cbranch_scc1 L_c0_kernel_end_1
  s_load_dwordx2 s[72:73], s[0:1], 80
  v_mov_b32 v255, v0
  s_mov_b32 s95, s2
  v_lshrrev_b32 v2, 6, v0
  s_nop 0
  v_readfirstlane_b32 s3, v2
  s_nop 3
  s_mov_b32 s93, s3
  s_waitcnt lgkmcnt(0)
  s_add_u32 s84, s72, 41943040
  s_addc_u32 s85, s73, 0
  s_mov_b32 s86, 3072
  s_mov_b32 s87, 0x00020000
  s_cmp_ge_u32 s3, 4
  s_cbranch_scc1 L_c0_kernel_p3s_3
  s_load_dwordx2 s[6:7], s[0:1], 80
  s_load_dwordx2 s[4:5], s[0:1], 0
  v_lshrrev_b32 v2, 6, v0
  v_and_b32 v1, 63, v0
  v_readfirstlane_b32 s3, v2
  v_mov_b32 v80, 0
  v_mov_b32 v81, 0
  v_mov_b32 v82, 0
  v_mov_b32 v83, 0
  v_mov_b32 v84, 0
  v_mov_b32 v85, 0
  v_mov_b32 v86, 0
  v_mov_b32 v87, 0
  v_mov_b32 v88, 0
  v_mov_b32 v89, 0
  v_mov_b32 v90, 0
  v_mov_b32 v91, 0
  v_mov_b32 v92, 0
  v_mov_b32 v93, 0
  v_mov_b32 v94, 0
  v_mov_b32 v95, 0
  s_mov_b32 s20, 0x3f3504f3
  s_mov_b32 s21, 0x3f3504f3
  s_mov_b32 s22, 0xbf3504f3
  s_mov_b32 s23, 0xbf3504f3
  s_waitcnt lgkmcnt(0)
  s_mov_b32 s8, s4
  s_mov_b32 s9, s5
  s_mov_b32 s10, 2097152
  s_mov_b32 s11, 0x00020000
  s_add_u32 s12, s6, 4194304
  s_addc_u32 s13, s7, 0
  s_mov_b32 s14, 4194304
  s_mov_b32 s15, 0x00020000
  s_add_u32 s32, s6, 10485760
  s_addc_u32 s33, s7, 0
  s_mov_b32 s34, 2097152
  s_mov_b32 s35, 0x00020000
  s_add_u32 s36, s6, 8388608
  s_addc_u32 s37, s7, 0
  s_mov_b32 s38, 2097152
  s_mov_b32 s39, 0x00020000
  v_lshrrev_b32 v7, 3, v1
  v_lshrrev_b32 v11, 2, v1
  v_and_b32 v12, 3, v1
  v_lshlrev_b32 v12, 3, v12
  v_lshl_add_u32 v11, v11, 6, v12
  s_lshl_b32 s24, s3, 10
  s_lshr_b32 s25, s2, 1
  s_lshl_b32 s25, s25, 15
  s_add_u32 s24, s24, s25
  s_and_b32 s25, s2, 1
  s_lshl_b32 s25, s25, 5
  s_add_u32 s24, s24, s25
  buffer_load_dwordx2 v[16:17], v11, s[12:15], s24 offen
  s_add_u32 s24, s24, 4096
  buffer_load_dwordx2 v[18:19], v11, s[12:15], s24 offen
  s_add_u32 s24, s24, 4096
  buffer_load_dwordx2 v[20:21], v11, s[12:15], s24 offen
  s_add_u32 s24, s24, 4096
  buffer_load_dwordx2 v[22:23], v11, s[12:15], s24 offen
  s_add_u32 s24, s24, 4096
  buffer_load_dwordx2 v[24:25], v11, s[12:15], s24 offen
  s_add_u32 s24, s24, 4096
  buffer_load_dwordx2 v[26:27], v11, s[12:15], s24 offen
  s_add_u32 s24, s24, 4096
  buffer_load_dwordx2 v[28:29], v11, s[12:15], s24 offen
  s_add_u32 s24, s24, 4096
  buffer_load_dwordx2 v[30:31], v11, s[12:15], s24 offen
  s_lshl_b32 s16, s2, 2
  s_add_u32 s16, s16, s3
  s_lshl_b32 s16, s16, 10
  s_add_u32 s17, s16, 1048576
  v_lshlrev_b32 v3, 1, v1
  buffer_load_short_d16_hi v80, v3, s[8:11], s16 offen offset:0
  buffer_load_short_d16_hi v81, v3, s[8:11], s17 offen offset:0
  buffer_load_short_d16_hi v82, v3, s[8:11], s16 offen offset:128
  buffer_load_short_d16_hi v83, v3, s[8:11], s17 offen offset:128
  buffer_load_short_d16_hi v84, v3, s[8:11], s16 offen offset:256
  buffer_load_short_d16_hi v85, v3, s[8:11], s17 offen offset:256
  buffer_load_short_d16_hi v86, v3, s[8:11], s16 offen offset:384
  buffer_load_short_d16_hi v87, v3, s[8:11], s17 offen offset:384
  buffer_load_short_d16_hi v88, v3, s[8:11], s16 offen offset:512
  buffer_load_short_d16_hi v89, v3, s[8:11], s17 offen offset:512
  buffer_load_short_d16_hi v90, v3, s[8:11], s16 offen offset:640
  buffer_load_short_d16_hi v91, v3, s[8:11], s17 offen offset:640
  buffer_load_short_d16_hi v92, v3, s[8:11], s16 offen offset:768
  buffer_load_short_d16_hi v93, v3, s[8:11], s17 offen offset:768
  buffer_load_short_d16_hi v94, v3, s[8:11], s16 offen offset:896
  buffer_load_short_d16_hi v95, v3, s[8:11], s17 offen offset:896
  v_lshrrev_b32 v5, 5, v0
  v_cvt_f32_u32 v5, v5
  v_mul_f32 v6, 0x3c800000, v5
  v_cos_f32 v64, v6
  v_sin_f32 v65, v6
  v_mul_f32 v6, 0x3d000000, v5
  v_cos_f32 v66, v6
  v_sin_f32 v67, v6
  v_mul_f32 v6, 0x3d400000, v5
  v_cos_f32 v68, v6
  v_sin_f32 v69, v6
  v_mul_f32 v6, 0x3d800000, v5
  v_cos_f32 v70, v6
  v_sin_f32 v71, v6
  v_mul_f32 v6, 0x3da00000, v5
  v_cos_f32 v72, v6
  v_sin_f32 v73, v6
  v_mul_f32 v6, 0x3dc00000, v5
  v_cos_f32 v74, v6
  v_sin_f32 v75, v6
  v_mul_f32 v6, 0x3de00000, v5
  v_cos_f32 v76, v6
  v_sin_f32 v77, v6
  v_and_b32 v4, 7, v1
  v_add_u32 v5, 0, v4
  v_mul_u32_u24 v5, v5, v7
  v_cvt_f32_u32 v5, v5
  v_mul_f32 v6, 0x3b000000, v5
  v_cos_f32 v48, v6
  v_sin_f32 v49, v6
  v_add_u32 v5, 8, v4
  v_mul_u32_u24 v5, v5, v7
  v_cvt_f32_u32 v5, v5
  v_mul_f32 v6, 0x3b000000, v5
  v_cos_f32 v50, v6
  v_sin_f32 v51, v6
  v_add_u32 v5, 16, v4
  v_mul_u32_u24 v5, v5, v7
  v_cvt_f32_u32 v5, v5
  v_mul_f32 v6, 0x3b000000, v5
  v_cos_f32 v52, v6
  v_sin_f32 v53, v6
  v_add_u32 v5, 24, v4
  v_mul_u32_u24 v5, v5, v7
  v_cvt_f32_u32 v5, v5
  v_mul_f32 v6, 0x3b000000, v5
  v_cos_f32 v54, v6
  v_sin_f32 v55, v6
  v_add_u32 v5, 32, v4
  v_mul_u32_u24 v5, v5, v7
  v_cvt_f32_u32 v5, v5
  v_mul_f32 v6, 0x3b000000, v5
  v_cos_f32 v56, v6
  v_sin_f32 v57, v6
  v_add_u32 v5, 40, v4
  v_mul_u32_u24 v5, v5, v7
  v_cvt_f32_u32 v5, v5
  v_mul_f32 v6, 0x3b000000, v5
  v_cos_f32 v58, v6
  v_sin_f32 v59, v6
  v_add_u32 v5, 48, v4
  v_mul_u32_u24 v5, v5, v7
  v_cvt_f32_u32 v5, v5
  v_mul_f32 v6, 0x3b000000, v5
  v_cos_f32 v60, v6
  v_sin_f32 v61, v6
  v_add_u32 v5, 56, v4
  v_mul_u32_u24 v5, v5, v7
  v_cvt_f32_u32 v5, v5
  v_mul_f32 v6, 0x3b000000, v5
  v_cos_f32 v62, v6
  v_sin_f32 v63, v6
  s_lshl_b32 s18, s3, 12
  v_lshlrev_b32 v6, 3, v1
  v_add_u32 v6, s18, v6
  v_lshl_add_u32 v8, v7, 9, v6
  v_and_b32 v9, 7, v1
  s_lshl_b32 s19, s3, 3
  v_add_u32 v10, s19, v7
  v_lshlrev_b32 v11, 1, v9
  v_xor_b32 v10, v10, v11
  v_lshl_add_u32 v9, v9, 5, v10
  v_lshlrev_b32 v9, 3, v9
  v_add_u32 v9, 0x4000, v9
  v_and_b32 v10, 3, v1
  v_bfe_u32 v11, v1, 2, 3
  v_lshrrev_b32 v12, 5, v1
  v_lshl_add_u32 v10, v10, 3, v11
  v_lshl_add_u32 v10, v12, 8, v10
  v_lshlrev_b32 v10, 3, v10
  s_lshl_b32 s19, s3, 12
  s_add_u32 s19, s19, 0x4000
  v_add_u32 v10, s19, v10
  s_mov_b32 s40, 0x35000000
  s_mov_b32 s41, 0x35000000
  s_waitcnt vmcnt(16)
  v_pk_add_f32 v[32:33], v[16:17], v[24:25]
  v_pk_add_f32 v[40:41], v[16:17], v[24:25] neg_lo:[0,1] neg_hi:[0,1]
  v_pk_add_f32 v[34:35], v[18:19], v[26:27]
  v_pk_add_f32 v[42:43], v[18:19], v[26:27] neg_lo:[0,1] neg_hi:[0,1]
  v_pk_add_f32 v[36:37], v[20:21], v[28:29]
  v_pk_add_f32 v[44:45], v[20:21], v[28:29] neg_lo:[0,1] neg_hi:[0,1]
  v_pk_add_f32 v[38:39], v[22:23], v[30:31]
  v_pk_add_f32 v[46:47], v[22:23], v[30:31] neg_lo:[0,1] neg_hi:[0,1]
  v_pk_add_f32 v[26:27], v[42:43], v[42:43] op_sel:[0,1] op_sel_hi:[1,0] neg_lo:[0,1]
  v_pk_add_f32 v[30:31], v[46:47], v[46:47] op_sel:[0,1] op_sel_hi:[1,0] neg_hi:[0,1]
  v_pk_add_f32 v[16:17], v[32:33], v[36:37]
  v_pk_add_f32 v[18:19], v[32:33], v[36:37] neg_lo:[0,1] neg_hi:[0,1]
  v_pk_mul_f32 v[26:27], v[26:27], s[20:21]
  v_pk_mul_f32 v[30:31], v[30:31], s[22:23]
  v_pk_add_f32 v[20:21], v[34:35], v[38:39]
  v_pk_add_f32 v[22:23], v[34:35], v[38:39] neg_lo:[0,1] neg_hi:[0,1]
  v_pk_add_f32 v[24:25], v[40:41], v[44:45] op_sel:[0,1] op_sel_hi:[1,0] neg_lo:[0,1]
  v_pk_add_f32 v[28:29], v[40:41], v[44:45] op_sel:[0,1] op_sel_hi:[1,0] neg_hi:[0,1]
  v_pk_add_f32 v[42:43], v[26:27], v[30:31]
  v_pk_add_f32 v[46:47], v[26:27], v[30:31] neg_lo:[0,1] neg_hi:[0,1]
  v_pk_add_f32 v[32:33], v[16:17], v[20:21]
  v_pk_add_f32 v[36:37], v[16:17], v[20:21] neg_lo:[0,1] neg_hi:[0,1]
  v_pk_add_f32 v[34:35], v[18:19], v[22:23] op_sel:[0,1] op_sel_hi:[1,0] neg_lo:[0,1]
  v_pk_add_f32 v[38:39], v[18:19], v[22:23] op_sel:[0,1] op_sel_hi:[1,0] neg_hi:[0,1]
  v_pk_add_f32 v[40:41], v[24:25], v[42:43]
  v_pk_add_f32 v[44:45], v[24:25], v[42:43] neg_lo:[0,1] neg_hi:[0,1]
  v_pk_add_f32 v[26:27], v[28:29], v[46:47] op_sel:[0,1] op_sel_hi:[1,0] neg_lo:[0,1]
  v_pk_add_f32 v[30:31], v[28:29], v[46:47] op_sel:[0,1] op_sel_hi:[1,0] neg_hi:[0,1]
  v_pk_mul_f32 v[18:19], v[40:41], v[64:65] op_sel:[0,0] op_sel_hi:[0,1]
  v_pk_fma_f32 v[40:41], v[40:41], v[64:65], v[18:19] op_sel:[1,1,0] op_sel_hi:[1,0,1] neg_lo:[1,0,0]
  v_pk_mul_f32 v[16:17], v[34:35], v[66:67] op_sel:[0,0] op_sel_hi:[0,1]
  v_pk_fma_f32 v[34:35], v[34:35], v[66:67], v[16:17] op_sel:[1,1,0] op_sel_hi:[1,0,1] neg_lo:[1,0,0]
  v_pk_mul_f32 v[18:19], v[26:27], v[68:69] op_sel:[0,0] op_sel_hi:[0,1]
  v_pk_fma_f32 v[26:27], v[26:27], v[68:69], v[18:19] op_sel:[1,1,0] op_sel_hi:[1,0,1] neg_lo:[1,0,0]
  v_pk_mul_f32 v[16:17], v[36:37], v[70:71] op_sel:[0,0] op_sel_hi:[0,1]
  v_pk_fma_f32 v[36:37], v[36:37], v[70:71], v[16:17] op_sel:[1,1,0] op_sel_hi:[1,0,1] neg_lo:[1,0,0]
  v_pk_mul_f32 v[18:19], v[44:45], v[72:73] op_sel:[0,0] op_sel_hi:[0,1]
  v_pk_fma_f32 v[44:45], v[44:45], v[72:73], v[18:19] op_sel:[1,1,0] op_sel_hi:[1,0,1] neg_lo:[1,0,0]
  v_pk_mul_f32 v[16:17], v[38:39], v[74:75] op_sel:[0,0] op_sel_hi:[0,1]
  v_pk_fma_f32 v[38:39], v[38:39], v[74:75], v[16:17] op_sel:[1,1,0] op_sel_hi:[1,0,1] neg_lo:[1,0,0]
  v_pk_mul_f32 v[18:19], v[30:31], v[76:77] op_sel:[0,0] op_sel_hi:[0,1]
  v_pk_fma_f32 v[30:31], v[30:31], v[76:77], v[18:19] op_sel:[1,1,0] op_sel_hi:[1,0,1] neg_lo:[1,0,0]
  ds_write_b64 v10, v[32:33] offset:0
  v_xor_b32 v13, 16, v10
  ds_write_b64 v13, v[40:41] offset:256
  v_xor_b32 v12, 32, v10
  ds_write_b64 v12, v[34:35] offset:512
  v_xor_b32 v13, 48, v10
  ds_write_b64 v13, v[26:27] offset:768
  v_xor_b32 v12, 64, v10
  ds_write_b64 v12, v[36:37] offset:1024
  v_xor_b32 v13, 80, v10
  ds_write_b64 v13, v[44:45] offset:1280
  v_xor_b32 v12, 96, v10
  ds_write_b64 v12, v[38:39] offset:1536
  v_xor_b32 v13, 112, v10
  ds_write_b64 v13, v[30:31] offset:1792
  s_waitcnt lgkmcnt(0)
  s_barrier
  ds_read_b64 v[16:17], v9 offset:0
  ds_read_b64 v[18:19], v9 offset:2048
  ds_read_b64 v[20:21], v9 offset:4096
  ds_read_b64 v[22:23], v9 offset:6144
  ds_read_b64 v[24:25], v9 offset:8192
  ds_read_b64 v[28:29], v9 offset:10240
  ds_read_b64 v[42:43], v9 offset:12288
  ds_read_b64 v[46:47], v9 offset:14336
  s_waitcnt lgkmcnt(0)
  v_pk_add_f32 v[32:33], v[16:17], v[24:25]
  v_pk_add_f32 v[36:37], v[16:17], v[24:25] neg_lo:[0,1] neg_hi:[0,1]
  v_pk_add_f32 v[40:41], v[18:19], v[28:29]
  v_pk_add_f32 v[44:45], v[18:19], v[28:29] neg_lo:[0,1] neg_hi:[0,1]
  v_pk_add_f32 v[34:35], v[20:21], v[42:43]
  v_pk_add_f32 v[38:39], v[20:21], v[42:43] neg_lo:[0,1] neg_hi:[0,1]
  v_pk_add_f32 v[26:27], v[22:23], v[46:47]
  v_pk_add_f32 v[30:31], v[22:23], v[46:47] neg_lo:[0,1] neg_hi:[0,1]
  v_pk_add_f32 v[28:29], v[44:45], v[44:45] op_sel:[0,1] op_sel_hi:[1,0] neg_lo:[0,1]
  v_pk_add_f32 v[46:47], v[30:31], v[30:31] op_sel:[0,1] op_sel_hi:[1,0] neg_hi:[0,1]
  v_pk_add_f32 v[16:17], v[32:33], v[34:35]
  v_pk_add_f32 v[18:19], v[32:33], v[34:35] neg_lo:[0,1] neg_hi:[0,1]
  v_pk_mul_f32 v[28:29], v[28:29], s[20:21]
  v_pk_mul_f32 v[46:47], v[46:47], s[22:23]
  v_pk_add_f32 v[20:21], v[40:41], v[26:27]
  v_pk_add_f32 v[22:23], v[40:41], v[26:27] neg_lo:[0,1] neg_hi:[0,1]
  v_pk_add_f32 v[24:25], v[36:37], v[38:39] op_sel:[0,1] op_sel_hi:[1,0] neg_lo:[0,1]
  v_pk_add_f32 v[42:43], v[36:37], v[38:39] op_sel:[0,1] op_sel_hi:[1,0] neg_hi:[0,1]
  v_pk_add_f32 v[44:45], v[28:29], v[46:47]
  v_pk_add_f32 v[30:31], v[28:29], v[46:47] neg_lo:[0,1] neg_hi:[0,1]
  v_pk_add_f32 v[32:33], v[16:17], v[20:21]
  v_pk_add_f32 v[34:35], v[16:17], v[20:21] neg_lo:[0,1] neg_hi:[0,1]
  v_pk_add_f32 v[40:41], v[18:19], v[22:23] op_sel:[0,1] op_sel_hi:[1,0] neg_lo:[0,1]
  v_pk_add_f32 v[26:27], v[18:19], v[22:23] op_sel:[0,1] op_sel_hi:[1,0] neg_hi:[0,1]
  v_pk_add_f32 v[36:37], v[24:25], v[44:45]
  v_pk_add_f32 v[38:39], v[24:25], v[44:45] neg_lo:[0,1] neg_hi:[0,1]
  v_pk_add_f32 v[28:29], v[42:43], v[30:31] op_sel:[0,1] op_sel_hi:[1,0] neg_lo:[0,1]
  v_pk_add_f32 v[46:47], v[42:43], v[30:31] op_sel:[0,1] op_sel_hi:[1,0] neg_hi:[0,1]
  v_pk_mul_f32 v[16:17], v[32:33], v[48:49] op_sel:[0,0] op_sel_hi:[0,1]
  v_pk_fma_f32 v[32:33], v[32:33], v[48:49], v[16:17] op_sel:[1,1,0] op_sel_hi:[1,0,1] neg_lo:[1,0,0]
  v_pk_mul_f32 v[18:19], v[36:37], v[50:51] op_sel:[0,0] op_sel_hi:[0,1]
  v_pk_fma_f32 v[36:37], v[36:37], v[50:51], v[18:19] op_sel:[1,1,0] op_sel_hi:[1,0,1] neg_lo:[1,0,0]
  v_pk_mul_f32 v[16:17], v[40:41], v[52:53] op_sel:[0,0] op_sel_hi:[0,1]
  v_pk_fma_f32 v[40:41], v[40:41], v[52:53], v[16:17] op_sel:[1,1,0] op_sel_hi:[1,0,1] neg_lo:[1,0,0]
  v_pk_mul_f32 v[18:19], v[28:29], v[54:55] op_sel:[0,0] op_sel_hi:[0,1]
  v_pk_fma_f32 v[28:29], v[28:29], v[54:55], v[18:19] op_sel:[1,1,0] op_sel_hi:[1,0,1] neg_lo:[1,0,0]
  v_pk_mul_f32 v[16:17], v[34:35], v[56:57] op_sel:[0,0] op_sel_hi:[0,1]
  v_pk_fma_f32 v[34:35], v[34:35], v[56:57], v[16:17] op_sel:[1,1,0] op_sel_hi:[1,0,1] neg_lo:[1,0,0]
  v_pk_mul_f32 v[18:19], v[38:39], v[58:59] op_sel:[0,0] op_sel_hi:[0,1]
  v_pk_fma_f32 v[38:39], v[38:39], v[58:59], v[18:19] op_sel:[1,1,0] op_sel_hi:[1,0,1] neg_lo:[1,0,0]
  v_pk_mul_f32 v[16:17], v[26:27], v[60:61] op_sel:[0,0] op_sel_hi:[0,1]
  v_pk_fma_f32 v[26:27], v[26:27], v[60:61], v[16:17] op_sel:[1,1,0] op_sel_hi:[1,0,1] neg_lo:[1,0,0]
  v_pk_mul_f32 v[18:19], v[46:47], v[62:63] op_sel:[0,0] op_sel_hi:[0,1]
  v_pk_fma_f32 v[46:47], v[46:47], v[62:63], v[18:19] op_sel:[1,1,0] op_sel_hi:[1,0,1] neg_lo:[1,0,0]
  ds_write_b64 v8, v[32:33]
  v_xor_b32 v13, 64, v8
  ds_write_b64 v13, v[36:37]
  v_xor_b32 v12, 128, v8
  ds_write_b64 v12, v[40:41]
  v_xor_b32 v13, 192, v8
  ds_write_b64 v13, v[28:29]
  v_xor_b32 v12, 256, v8
  ds_write_b64 v12, v[34:35]
  v_xor_b32 v13, 320, v8
  ds_write_b64 v13, v[38:39]
  v_xor_b32 v12, 384, v8
  ds_write_b64 v12, v[26:27]
  v_xor_b32 v13, 448, v8
  ds_write_b64 v13, v[46:47]
  ds_read_b64 v[16:17], v6 offset:0
  v_xor_b32 v13, 64, v6
  ds_read_b64 v[18:19], v13 offset:512
  v_xor_b32 v12, 128, v6
  ds_read_b64 v[20:21], v12 offset:1024
  v_xor_b32 v13, 192, v6
  ds_read_b64 v[22:23], v13 offset:1536
  v_xor_b32 v12, 256, v6
  ds_read_b64 v[24:25], v12 offset:2048
  v_xor_b32 v13, 320, v6
  ds_read_b64 v[42:43], v13 offset:2560
  v_xor_b32 v12, 384, v6
  ds_read_b64 v[44:45], v12 offset:3072
  v_xor_b32 v13, 448, v6
  ds_read_b64 v[30:31], v13 offset:3584
  s_waitcnt lgkmcnt(0)
  v_pk_add_f32 v[32:33], v[16:17], v[24:25]
  v_pk_add_f32 v[34:35], v[16:17], v[24:25] neg_lo:[0,1] neg_hi:[0,1]
  v_pk_add_f32 v[36:37], v[18:19], v[42:43]
  v_pk_add_f32 v[38:39], v[18:19], v[42:43] neg_lo:[0,1] neg_hi:[0,1]
  v_pk_add_f32 v[40:41], v[20:21], v[44:45]
  v_pk_add_f32 v[26:27], v[20:21], v[44:45] neg_lo:[0,1] neg_hi:[0,1]
  v_pk_add_f32 v[28:29], v[22:23], v[30:31]
  v_pk_add_f32 v[46:47], v[22:23], v[30:31] neg_lo:[0,1] neg_hi:[0,1]
  v_pk_add_f32 v[42:43], v[38:39], v[38:39] op_sel:[0,1] op_sel_hi:[1,0] neg_lo:[0,1]
  v_pk_add_f32 v[30:31], v[46:47], v[46:47] op_sel:[0,1] op_sel_hi:[1,0] neg_hi:[0,1]
  v_pk_add_f32 v[16:17], v[32:33], v[40:41]
  v_pk_add_f32 v[18:19], v[32:33], v[40:41] neg_lo:[0,1] neg_hi:[0,1]
  v_pk_mul_f32 v[42:43], v[42:43], s[20:21]
  v_pk_mul_f32 v[30:31], v[30:31], s[22:23]
  v_pk_add_f32 v[20:21], v[36:37], v[28:29]
  v_pk_add_f32 v[22:23], v[36:37], v[28:29] neg_lo:[0,1] neg_hi:[0,1]
  v_pk_add_f32 v[24:25], v[34:35], v[26:27] op_sel:[0,1] op_sel_hi:[1,0] neg_lo:[0,1]
  v_pk_add_f32 v[44:45], v[34:35], v[26:27] op_sel:[0,1] op_sel_hi:[1,0] neg_hi:[0,1]
  v_pk_add_f32 v[38:39], v[42:43], v[30:31]
  v_pk_add_f32 v[46:47], v[42:43], v[30:31] neg_lo:[0,1] neg_hi:[0,1]
  v_pk_add_f32 v[32:33], v[16:17], v[20:21]
  v_pk_add_f32 v[40:41], v[16:17], v[20:21] neg_lo:[0,1] neg_hi:[0,1]
  v_pk_add_f32 v[36:37], v[18:19], v[22:23] op_sel:[0,1] op_sel_hi:[1,0] neg_lo:[0,1]
  v_pk_add_f32 v[28:29], v[18:19], v[22:23] op_sel:[0,1] op_sel_hi:[1,0] neg_hi:[0,1]
  v_pk_add_f32 v[34:35], v[24:25], v[38:39]
  v_pk_add_f32 v[26:27], v[24:25], v[38:39] neg_lo:[0,1] neg_hi:[0,1]
  v_pk_add_f32 v[42:43], v[44:45], v[46:47] op_sel:[0,1] op_sel_hi:[1,0] neg_lo:[0,1]
  v_pk_add_f32 v[30:31], v[44:45], v[46:47] op_sel:[0,1] op_sel_hi:[1,0] neg_hi:[0,1]
  s_waitcnt vmcnt(0)
  v_pk_mul_f32 v[32:33], v[32:33], s[40:41]
  v_cvt_pk_bf16_f32 v16, v32, v33
  v_lshlrev_b32 v32, 16, v16
  v_and_b32 v33, 0xffff0000, v16
  v_pk_mul_f32 v[34:35], v[34:35], s[40:41]
  v_cvt_pk_bf16_f32 v18, v34, v35
  v_lshlrev_b32 v34, 16, v18
  v_and_b32 v35, 0xffff0000, v18
  v_pk_mul_f32 v[36:37], v[36:37], s[40:41]
  v_cvt_pk_bf16_f32 v20, v36, v37
  v_lshlrev_b32 v36, 16, v20
  v_and_b32 v37, 0xffff0000, v20
  v_pk_mul_f32 v[42:43], v[42:43], s[40:41]
  v_cvt_pk_bf16_f32 v22, v42, v43
  v_lshlrev_b32 v42, 16, v22
  v_and_b32 v43, 0xffff0000, v22
  v_pk_mul_f32 v[40:41], v[40:41], s[40:41]
  v_cvt_pk_bf16_f32 v24, v40, v41
  v_lshlrev_b32 v40, 16, v24
  v_and_b32 v41, 0xffff0000, v24
  v_pk_mul_f32 v[26:27], v[26:27], s[40:41]
  v_cvt_pk_bf16_f32 v44, v26, v27
  v_lshlrev_b32 v26, 16, v44
  v_and_b32 v27, 0xffff0000, v44
  v_pk_mul_f32 v[28:29], v[28:29], s[40:41]
  v_cvt_pk_bf16_f32 v38, v28, v29
  v_lshlrev_b32 v28, 16, v38
  v_and_b32 v29, 0xffff0000, v38
  v_pk_mul_f32 v[30:31], v[30:31], s[40:41]
  v_cvt_pk_bf16_f32 v46, v30, v31
  v_lshlrev_b32 v30, 16, v46
  v_and_b32 v31, 0xffff0000, v46
  v_pk_add_f32 v[32:33], v[32:33], v[80:81]
  v_cvt_pk_bf16_f32 v80, v32, v33
  v_lshlrev_b32 v32, 16, v80
  v_and_b32 v33, 0xffff0000, v80
  v_pk_add_f32 v[34:35], v[34:35], v[82:83]
  v_cvt_pk_bf16_f32 v82, v34, v35
  v_lshlrev_b32 v34, 16, v82
  v_and_b32 v35, 0xffff0000, v82
  v_pk_add_f32 v[36:37], v[36:37], v[84:85]
  v_cvt_pk_bf16_f32 v84, v36, v37
  v_lshlrev_b32 v36, 16, v84
  v_and_b32 v37, 0xffff0000, v84
  v_pk_add_f32 v[42:43], v[42:43], v[86:87]
  v_cvt_pk_bf16_f32 v86, v42, v43
  v_lshlrev_b32 v42, 16, v86
  v_and_b32 v43, 0xffff0000, v86
  v_pk_add_f32 v[40:41], v[40:41], v[88:89]
  v_cvt_pk_bf16_f32 v88, v40, v41
  v_lshlrev_b32 v40, 16, v88
  v_and_b32 v41, 0xffff0000, v88
  v_pk_add_f32 v[26:27], v[26:27], v[90:91]
  v_cvt_pk_bf16_f32 v90, v26, v27
  v_lshlrev_b32 v26, 16, v90
  v_and_b32 v27, 0xffff0000, v90
  v_pk_add_f32 v[28:29], v[28:29], v[92:93]
  v_cvt_pk_bf16_f32 v92, v28, v29
  v_lshlrev_b32 v28, 16, v92
  v_and_b32 v29, 0xffff0000, v92
  v_pk_add_f32 v[30:31], v[30:31], v[94:95]
  v_cvt_pk_bf16_f32 v94, v30, v31
  v_lshlrev_b32 v30, 16, v94
  v_and_b32 v31, 0xffff0000, v94
  buffer_store_short v80, v3, s[32:35], s16 offen offset:0 sc1
  buffer_store_short_d16_hi v80, v3, s[32:35], s17 offen offset:0 sc1
  buffer_store_short v82, v3, s[32:35], s16 offen offset:128 sc1
  buffer_store_short_d16_hi v82, v3, s[32:35], s17 offen offset:128 sc1
  buffer_store_short v84, v3, s[32:35], s16 offen offset:256 sc1
  buffer_store_short_d16_hi v84, v3, s[32:35], s17 offen offset:256 sc1
  buffer_store_short v86, v3, s[32:35], s16 offen offset:384 sc1
  buffer_store_short_d16_hi v86, v3, s[32:35], s17 offen offset:384 sc1
  buffer_store_short v88, v3, s[32:35], s16 offen offset:512 sc1
  buffer_store_short_d16_hi v88, v3, s[32:35], s17 offen offset:512 sc1
  buffer_store_short v90, v3, s[32:35], s16 offen offset:640 sc1
  buffer_store_short_d16_hi v90, v3, s[32:35], s17 offen offset:640 sc1
  buffer_store_short v92, v3, s[32:35], s16 offen offset:768 sc1
  buffer_store_short_d16_hi v92, v3, s[32:35], s17 offen offset:768 sc1
  buffer_store_short v94, v3, s[32:35], s16 offen offset:896 sc1
  buffer_store_short_d16_hi v94, v3, s[32:35], s17 offen offset:896 sc1
  v_pk_add_f32 v[16:17], v[32:33], v[34:35]
  v_pk_add_f32 v[18:19], v[36:37], v[42:43]
  v_pk_add_f32 v[20:21], v[40:41], v[26:27]
  v_pk_add_f32 v[22:23], v[28:29], v[30:31]
  v_pk_add_f32 v[16:17], v[16:17], v[18:19]
  v_pk_add_f32 v[20:21], v[20:21], v[22:23]
  v_pk_add_f32 v[16:17], v[16:17], v[20:21]
  s_nop 1
  v_add_f32_dpp v16, v16, v16 row_shr:1 row_mask:0xf bank_mask:0xf bound_ctrl:0
  v_add_f32_dpp v17, v17, v17 row_shr:1 row_mask:0xf bank_mask:0xf bound_ctrl:0
  s_nop 0
  v_add_f32_dpp v16, v16, v16 row_shr:2 row_mask:0xf bank_mask:0xf bound_ctrl:0
  v_add_f32_dpp v17, v17, v17 row_shr:2 row_mask:0xf bank_mask:0xf bound_ctrl:0
  s_nop 0
  v_add_f32_dpp v16, v16, v16 row_shr:4 row_mask:0xf bank_mask:0xf bound_ctrl:0
  v_add_f32_dpp v17, v17, v17 row_shr:4 row_mask:0xf bank_mask:0xf bound_ctrl:0
  s_nop 0
  v_add_f32_dpp v16, v16, v16 row_shr:8 row_mask:0xf bank_mask:0xf bound_ctrl:0
  v_add_f32_dpp v17, v17, v17 row_shr:8 row_mask:0xf bank_mask:0xf bound_ctrl:0
  s_nop 0
  v_add_f32_dpp v16, v16, v16 row_bcast:15 row_mask:0xa bank_mask:0xf
  v_add_f32_dpp v17, v17, v17 row_bcast:15 row_mask:0xa bank_mask:0xf
  s_nop 0
  v_add_f32_dpp v16, v16, v16 row_bcast:31 row_mask:0xc bank_mask:0xf
  v_add_f32_dpp v17, v17, v17 row_bcast:31 row_mask:0xc bank_mask:0xf
  s_nop 0
  v_mul_f32 v16, 0x3b000000, v16
  v_mul_f32 v17, 0x3b000000, v17
  v_cvt_pk_bf16_f32 v18, v16, v17
  v_and_b32 v19, 0xffff0000, v18
  v_lshlrev_b32 v18, 16, v18
  v_readlane_b32 s26, v16, 63
  v_readlane_b32 s27, v17, 63
  v_readlane_b32 s28, v18, 63
  v_readlane_b32 s29, v19, 63
  s_nop 1
  v_pk_add_f32 v[16:17], v[32:33], s[26:27] neg_lo:[0,1] neg_hi:[0,1]
  v_pk_add_f32 v[18:19], v[34:35], s[26:27] neg_lo:[0,1] neg_hi:[0,1]
  v_pk_add_f32 v[20:21], v[36:37], s[26:27] neg_lo:[0,1] neg_hi:[0,1]
  v_pk_add_f32 v[22:23], v[42:43], s[26:27] neg_lo:[0,1] neg_hi:[0,1]
  v_pk_add_f32 v[24:25], v[40:41], s[26:27] neg_lo:[0,1] neg_hi:[0,1]
  v_pk_add_f32 v[44:45], v[26:27], s[26:27] neg_lo:[0,1] neg_hi:[0,1]
  v_pk_add_f32 v[38:39], v[28:29], s[26:27] neg_lo:[0,1] neg_hi:[0,1]
  v_pk_add_f32 v[46:47], v[30:31], s[26:27] neg_lo:[0,1] neg_hi:[0,1]
  v_pk_mul_f32 v[16:17], v[16:17], v[16:17]
  v_pk_mul_f32 v[18:19], v[18:19], v[18:19]
  v_pk_fma_f32 v[16:17], v[20:21], v[20:21], v[16:17]
  v_pk_fma_f32 v[18:19], v[22:23], v[22:23], v[18:19]
  v_pk_fma_f32 v[16:17], v[24:25], v[24:25], v[16:17]
  v_pk_fma_f32 v[18:19], v[44:45], v[44:45], v[18:19]
  v_pk_fma_f32 v[16:17], v[38:39], v[38:39], v[16:17]
  v_pk_fma_f32 v[18:19], v[46:47], v[46:47], v[18:19]
  v_pk_add_f32 v[16:17], v[16:17], v[18:19]
  s_nop 1
  v_add_f32_dpp v16, v16, v16 row_shr:1 row_mask:0xf bank_mask:0xf bound_ctrl:0
  v_add_f32_dpp v17, v17, v17 row_shr:1 row_mask:0xf bank_mask:0xf bound_ctrl:0
  s_nop 0
  v_add_f32_dpp v16, v16, v16 row_shr:2 row_mask:0xf bank_mask:0xf bound_ctrl:0
  v_add_f32_dpp v17, v17, v17 row_shr:2 row_mask:0xf bank_mask:0xf bound_ctrl:0
  s_nop 0
  v_add_f32_dpp v16, v16, v16 row_shr:4 row_mask:0xf bank_mask:0xf bound_ctrl:0
  v_add_f32_dpp v17, v17, v17 row_shr:4 row_mask:0xf bank_mask:0xf bound_ctrl:0
  s_nop 0
  v_add_f32_dpp v16, v16, v16 row_shr:8 row_mask:0xf bank_mask:0xf bound_ctrl:0
  v_add_f32_dpp v17, v17, v17 row_shr:8 row_mask:0xf bank_mask:0xf bound_ctrl:0
  s_nop 0
  v_add_f32_dpp v16, v16, v16 row_bcast:15 row_mask:0xa bank_mask:0xf
  v_add_f32_dpp v17, v17, v17 row_bcast:15 row_mask:0xa bank_mask:0xf
  s_nop 0
  v_add_f32_dpp v16, v16, v16 row_bcast:31 row_mask:0xc bank_mask:0xf
  v_add_f32_dpp v17, v17, v17 row_bcast:31 row_mask:0xc bank_mask:0xf
  s_nop 0
  v_mul_f32 v16, 0x3b000000, v16
  v_mul_f32 v17, 0x3b000000, v17
  v_cvt_pk_bf16_f32 v18, v16, v17
  v_lshlrev_b32 v16, 16, v18
  v_and_b32 v17, 0xffff0000, v18
  v_add_f32 v16, 0x3727c5ac, v16
  v_add_f32 v17, 0x3727c5ac, v17
  v_cvt_pk_bf16_f32 v18, v16, v17
  v_lshlrev_b32 v16, 16, v18
  v_and_b32 v17, 0xffff0000, v18
  v_sqrt_f32 v16, v16
  v_sqrt_f32 v17, v17
  s_nop 0
  v_cvt_pk_bf16_f32 v18, v16, v17
  v_lshlrev_b32 v16, 16, v18
  v_and_b32 v17, 0xffff0000, v18
  v_rcp_f32 v16, v16
  v_rcp_f32 v17, v17
  s_nop 1
  v_readlane_b32 s30, v16, 63
  v_readlane_b32 s31, v17, 63
  v_pk_add_f32 v[32:33], v[32:33], s[28:29] neg_lo:[0,1] neg_hi:[0,1]
  v_cvt_pk_bf16_f32 v20, v32, v33
  v_lshlrev_b32 v32, 16, v20
  v_and_b32 v33, 0xffff0000, v20
  v_pk_add_f32 v[34:35], v[34:35], s[28:29] neg_lo:[0,1] neg_hi:[0,1]
  v_cvt_pk_bf16_f32 v22, v34, v35
  v_lshlrev_b32 v34, 16, v22
  v_and_b32 v35, 0xffff0000, v22
  v_pk_add_f32 v[36:37], v[36:37], s[28:29] neg_lo:[0,1] neg_hi:[0,1]
  v_cvt_pk_bf16_f32 v20, v36, v37
  v_lshlrev_b32 v36, 16, v20
  v_and_b32 v37, 0xffff0000, v20
  v_pk_add_f32 v[42:43], v[42:43], s[28:29] neg_lo:[0,1] neg_hi:[0,1]
  v_cvt_pk_bf16_f32 v22, v42, v43
  v_lshlrev_b32 v42, 16, v22
  v_and_b32 v43, 0xffff0000, v22
  v_pk_add_f32 v[40:41], v[40:41], s[28:29] neg_lo:[0,1] neg_hi:[0,1]
  v_cvt_pk_bf16_f32 v20, v40, v41
  v_lshlrev_b32 v40, 16, v20
  v_and_b32 v41, 0xffff0000, v20
  v_pk_add_f32 v[26:27], v[26:27], s[28:29] neg_lo:[0,1] neg_hi:[0,1]
  v_cvt_pk_bf16_f32 v22, v26, v27
  v_lshlrev_b32 v26, 16, v22
  v_and_b32 v27, 0xffff0000, v22
  v_pk_add_f32 v[28:29], v[28:29], s[28:29] neg_lo:[0,1] neg_hi:[0,1]
  v_cvt_pk_bf16_f32 v20, v28, v29
  v_lshlrev_b32 v28, 16, v20
  v_and_b32 v29, 0xffff0000, v20
  v_pk_add_f32 v[30:31], v[30:31], s[28:29] neg_lo:[0,1] neg_hi:[0,1]
  v_cvt_pk_bf16_f32 v22, v30, v31
  v_lshlrev_b32 v30, 16, v22
  v_and_b32 v31, 0xffff0000, v22
  v_pk_mul_f32 v[32:33], v[32:33], s[30:31]
  v_pk_mul_f32 v[34:35], v[34:35], s[30:31]
  v_pk_mul_f32 v[36:37], v[36:37], s[30:31]
  v_pk_mul_f32 v[42:43], v[42:43], s[30:31]
  v_pk_mul_f32 v[40:41], v[40:41], s[30:31]
  v_pk_mul_f32 v[26:27], v[26:27], s[30:31]
  v_pk_mul_f32 v[28:29], v[28:29], s[30:31]
  v_pk_mul_f32 v[30:31], v[30:31], s[30:31]
  v_cvt_pk_bf16_f32 v48, v32, v34
  v_cvt_pk_bf16_f32 v52, v33, v35
  v_cvt_pk_bf16_f32 v49, v36, v42
  v_cvt_pk_bf16_f32 v53, v37, v43
  v_cvt_pk_bf16_f32 v50, v40, v26
  v_cvt_pk_bf16_f32 v54, v41, v27
  v_cvt_pk_bf16_f32 v51, v28, v30
  v_cvt_pk_bf16_f32 v55, v29, v31
  v_lshlrev_b32 v4, 4, v1
  buffer_store_dwordx4 v[48:51], v4, s[36:39], s16 offen sc1
  buffer_store_dwordx4 v[52:55], v4, s[36:39], s17 offen sc1
  s_branch L_c0_kernel_p3d_2
L_c0_kernel_p3_end_1:
  s_branch L_c0_kernel_p3d_2
L_c0_kernel_p3s_3:
  s_barrier
L_c0_kernel_p3d_2:
  s_waitcnt vmcnt(0) lgkmcnt(0)
  s_barrier
  s_cmp_lg_u32 s93, 0
  s_cbranch_scc1 L_c0_kernel_pub_4
  s_lshl_b32 s18, s95, 2
  v_mov_b32 v1, 1
  v_mov_b32 v2, 0
  s_mov_b64 exec, 1
  buffer_store_dword v1, v2, s[84:87], s18 offen sc1
  s_mov_b64 exec, -1
L_c0_kernel_pub_4:
  v_mov_b32 v0, v255
  s_mov_b32 s2, s95
  s_mov_b32 s3, s93
  s_cmp_ge_u32 s2, 224
  s_cbranch_scc1 L_c0_kernel_g2_5
  s_load_dwordx2 s[6:7], s[0:1], 80
  s_load_dwordx2 s[4:5], s[0:1], 40
  v_lshrrev_b32 v2, 6, v0
  v_and_b32 v1, 63, v0
  v_readfirstlane_b32 s3, v2
  s_lshr_b32 s17, s2, 4
  s_and_b32 s16, s2, 7
  s_lshl_b32 s16, s16, 1
  s_bfe_u32 s18, s2, 0x10003
  s_add_u32 s16, s16, s18
  v_lshlrev_b32 v3, 4, v1
  v_lshrrev_b32 v4, 3, v1
  v_lshrrev_b32 v5, 4, v1
  v_and_b32 v6, 7, v1
  v_xor_b32 v7, v6, v5
  v_lshlrev_b32 v7, 4, v7
  v_lshl_add_u32 v7, v4, 10, v7
  v_xor_b32 v8, 64, v7
  s_and_b32 s18, s3, 1
  s_lshr_b32 s19, s3, 1
  s_lshl_b32 s34, s17, 2
  s_add_u32 s34, s34, s19
  s_lshl_b32 s34, s34, 15
  s_lshl_b32 s35, s18, 11
  s_add_u32 s34, s34, s35
  s_lshl_b32 s35, s16, 3
  s_add_u32 s35, s35, s3
  s_lshl_b32 s35, s35, 14
  s_lshl_b32 s36, s3, 11
  s_waitcnt lgkmcnt(0)
  s_add_u32 s8, s6, 25165824
  s_addc_u32 s9, s7, 0
  s_mov_b32 s10, 1835008
  s_mov_b32 s11, 0x00020000
  s_add_u32 s12, s6, 8388608
  s_addc_u32 s13, s7, 0
  s_mov_b32 s14, 2097152
  s_mov_b32 s15, 0x00020000
  s_add_u32 m0, s36, 0
  s_add_u32 s37, s34, 0
  buffer_load_dwordx4 v3, s[8:11], s37 offen lds
  buffer_load_dwordx4 v3, s[8:11], s37 offen offset:1024 lds
  s_add_u32 m0, s36, 32768
  s_add_u32 s37, s34, 4096
  buffer_load_dwordx4 v3, s[8:11], s37 offen lds
  buffer_load_dwordx4 v3, s[8:11], s37 offen offset:1024 lds
  s_add_u32 m0, s36, 65536
  s_add_u32 s37, s34, 8192
  buffer_load_dwordx4 v3, s[8:11], s37 offen lds
  buffer_load_dwordx4 v3, s[8:11], s37 offen offset:1024 lds
  s_cmp_lg_u32 s93, 0
  s_cbranch_scc1 L_c0_kernel_g1_hs_2
  s_and_b32 s50, s16, 7
  s_lshl_b32 s50, s50, 7
  v_lshlrev_b32 v24, 2, v1
  s_mov_b32 s51, 0
  s_mov_b32 exec_lo, 0xffffffff
  s_mov_b32 exec_hi, 0
L_c0_kernel_g1_hl_3:
  buffer_load_dword v25, v24, s[84:87], s50 offen sc1
  s_add_u32 s51, s51, 1
  s_waitcnt vmcnt(0)
  v_cmp_ne_u32 vcc, 1, v25
  s_cmp_ge_u32 s51, 400000
  s_cbranch_scc1 L_c0_kernel_g1_ho_4
  s_cbranch_vccz L_c0_kernel_g1_ho_4
  s_sleep 6
  s_branch L_c0_kernel_g1_hl_3
L_c0_kernel_g1_ho_4:
  s_mov_b64 exec, -1
L_c0_kernel_g1_hs_2:
  s_barrier
  s_add_u32 m0, s36, 16384
  s_add_u32 s37, s35, 0
  buffer_load_dwordx4 v7, s[12:15], s37 offen lds
  s_add_u32 s37, s35, 7168
  buffer_load_dwordx4 v8, s[12:15], s37 offen offset:1024 lds
  s_add_u32 m0, s36, 49152
  s_add_u32 s37, s35, 128
  buffer_load_dwordx4 v7, s[12:15], s37 offen lds
  s_add_u32 s37, s35, 7296
  buffer_load_dwordx4 v8, s[12:15], s37 offen offset:1024 lds
  s_add_u32 m0, s36, 81920
  s_add_u32 s37, s35, 256
  buffer_load_dwordx4 v7, s[12:15], s37 offen lds
  s_add_u32 s37, s35, 7424
  buffer_load_dwordx4 v8, s[12:15], s37 offen offset:1024 lds
  s_mov_b32 s24, s4
  s_mov_b32 s25, s5
  s_mov_b32 s26, 3584
  s_mov_b32 s27, 0x00020000
  s_add_u32 s28, s6, 16777216
  s_addc_u32 s29, s7, 0
  s_mov_b32 s30, 7340032
  s_mov_b32 s31, 0x00020000
  v_lshrrev_b32 v9, 5, v1
  v_lshlrev_b32 v10, 3, v9
  s_lshl_b32 s32, s17, 8
  s_lshl_b32 s33, s18, 7
  s_add_u32 s32, s32, s33
  s_lshl_b32 s38, s18, 13
  v_add_u32 v11, s38, v3
  v_add_u32 v12, 0x10000, v11
  v_and_b32 v13, 31, v1
  v_bfe_u32 v14, v1, 1, 3
  v_xor_b32 v14, v14, v9
  v_lshlrev_b32 v14, 4, v14
  v_lshl_add_u32 v13, v13, 7, v14
  s_lshl_b32 s38, s19, 12
  s_add_u32 s38, s38, 16384
  v_add_u32 v13, s38, v13
  v_xor_b32 v16, 0, v13
  v_add_u32 v20, 0x10000, v16
  v_xor_b32 v17, 32, v13
  v_add_u32 v21, 0x10000, v17
  v_xor_b32 v18, 64, v13
  v_add_u32 v22, 0x10000, v18
  v_xor_b32 v19, 96, v13
  v_add_u32 v23, 0x10000, v19
  v_mov_b32 v32, 0
  v_mov_b32 v33, 0
  v_mov_b32 v34, 0
  v_mov_b32 v35, 0
  v_mov_b32 v36, 0
  v_mov_b32 v37, 0
  v_mov_b32 v38, 0
  v_mov_b32 v39, 0
  v_mov_b32 v40, 0
  v_mov_b32 v41, 0
  v_mov_b32 v42, 0
  v_mov_b32 v43, 0
  v_mov_b32 v44, 0
  v_mov_b32 v45, 0
  v_mov_b32 v46, 0
  v_mov_b32 v47, 0
  v_mov_b32 v48, 0
  v_mov_b32 v49, 0
  v_mov_b32 v50, 0
  v_mov_b32 v51, 0
  v_mov_b32 v52, 0
  v_mov_b32 v53, 0
  v_mov_b32 v54, 0
  v_mov_b32 v55, 0
  v_mov_b32 v56, 0
  v_mov_b32 v57, 0
  v_mov_b32 v58, 0
  v_mov_b32 v59, 0
  v_mov_b32 v60, 0
  v_mov_b32 v61, 0
  v_mov_b32 v62, 0
  v_mov_b32 v63, 0
  s_waitcnt vmcnt(4)
  s_barrier
  ds_read_b128 v[64:67], v11 offset:0
  ds_read_b128 v[68:71], v11 offset:4096
  ds_read_b128 v[72:75], v16 offset:0
  s_waitcnt lgkmcnt(0)
  ds_read_b128 v[80:83], v11 offset:1024
  ds_read_b128 v[84:87], v11 offset:5120
  ds_read_b128 v[88:91], v17 offset:0
  v_mfma_f32_32x32x16_bf16 v[32:47], v[64:67], v[72:75], v[32:47]
  s_add_u32 m0, s36, 98304
  s_add_u32 s37, s34, 12288
  buffer_load_dwordx4 v3, s[8:11], s37 offen lds
  v_mfma_f32_32x32x16_bf16 v[48:63], v[68:71], v[72:75], v[48:63]
  buffer_load_dwordx4 v3, s[8:11], s37 offen offset:1024 lds
  s_waitcnt lgkmcnt(0)
  ds_read_b128 v[64:67], v11 offset:2048
  ds_read_b128 v[68:71], v11 offset:6144
  ds_read_b128 v[72:75], v18 offset:0
  v_mfma_f32_32x32x16_bf16 v[32:47], v[80:83], v[88:91], v[32:47]
  s_add_u32 m0, s36, 114688
  s_add_u32 s37, s35, 384
  buffer_load_dwordx4 v7, s[12:15], s37 offen lds
  v_mfma_f32_32x32x16_bf16 v[48:63], v[84:87], v[88:91], v[48:63]
  s_add_u32 s37, s35, 7552
  buffer_load_dwordx4 v8, s[12:15], s37 offen offset:1024 lds
  s_waitcnt lgkmcnt(0)
  ds_read_b128 v[80:83], v11 offset:3072
  ds_read_b128 v[84:87], v11 offset:7168
  ds_read_b128 v[88:91], v19 offset:0
  v_mfma_f32_32x32x16_bf16 v[32:47], v[64:67], v[72:75], v[32:47]
  v_mfma_f32_32x32x16_bf16 v[48:63], v[68:71], v[72:75], v[48:63]
  s_waitcnt lgkmcnt(0)
  s_waitcnt vmcnt(6)
  s_barrier
  ds_read_b128 v[64:67], v11 offset:32768
  ds_read_b128 v[68:71], v11 offset:36864
  ds_read_b128 v[72:75], v16 offset:32768
  v_mfma_f32_32x32x16_bf16 v[32:47], v[80:83], v[88:91], v[32:47]
  s_add_u32 m0, s36, 0
  s_add_u32 s37, s34, 16384
  buffer_load_dwordx4 v3, s[8:11], s37 offen lds
  v_mfma_f32_32x32x16_bf16 v[48:63], v[84:87], v[88:91], v[48:63]
  buffer_load_dwordx4 v3, s[8:11], s37 offen offset:1024 lds
  s_waitcnt lgkmcnt(0)
  ds_read_b128 v[80:83], v11 offset:33792
  ds_read_b128 v[84:87], v11 offset:37888
  ds_read_b128 v[88:91], v17 offset:32768
  v_mfma_f32_32x32x16_bf16 v[32:47], v[64:67], v[72:75], v[32:47]
  s_add_u32 m0, s36, 16384
  s_add_u32 s37, s35, 512
  buffer_load_dwordx4 v7, s[12:15], s37 offen lds
  v_mfma_f32_32x32x16_bf16 v[48:63], v[68:71], v[72:75], v[48:63]
  s_add_u32 s37, s35, 7680
  buffer_load_dwordx4 v8, s[12:15], s37 offen offset:1024 lds
  s_waitcnt lgkmcnt(0)
  ds_read_b128 v[64:67], v11 offset:34816
  ds_read_b128 v[68:71], v11 offset:38912
  ds_read_b128 v[72:75], v18 offset:32768
  v_mfma_f32_32x32x16_bf16 v[32:47], v[80:83], v[88:91], v[32:47]
  v_mfma_f32_32x32x16_bf16 v[48:63], v[84:87], v[88:91], v[48:63]
  s_waitcnt lgkmcnt(0)
  ds_read_b128 v[80:83], v11 offset:35840
  ds_read_b128 v[84:87], v11 offset:39936
  ds_read_b128 v[88:91], v19 offset:32768
  v_mfma_f32_32x32x16_bf16 v[32:47], v[64:67], v[72:75], v[32:47]
  v_mfma_f32_32x32x16_bf16 v[48:63], v[68:71], v[72:75], v[48:63]
  s_waitcnt lgkmcnt(0)
  s_waitcnt vmcnt(8)
  s_barrier
  ds_read_b128 v[64:67], v12 offset:0
  ds_read_b128 v[68:71], v12 offset:4096
  ds_read_b128 v[72:75], v20 offset:0
  v_mfma_f32_32x32x16_bf16 v[32:47], v[80:83], v[88:91], v[32:47]
  s_add_u32 m0, s36, 32768
  s_add_u32 s37, s34, 20480
  buffer_load_dwordx4 v3, s[8:11], s37 offen lds
  v_mfma_f32_32x32x16_bf16 v[48:63], v[84:87], v[88:91], v[48:63]
  buffer_load_dwordx4 v3, s[8:11], s37 offen offset:1024 lds
  s_waitcnt lgkmcnt(0)
  ds_read_b128 v[80:83], v12 offset:1024
  ds_read_b128 v[84:87], v12 offset:5120
  ds_read_b128 v[88:91], v21 offset:0
  v_mfma_f32_32x32x16_bf16 v[32:47], v[64:67], v[72:75], v[32:47]
  s_add_u32 m0, s36, 49152
  s_add_u32 s37, s35, 640
  buffer_load_dwordx4 v7, s[12:15], s37 offen lds
  v_mfma_f32_32x32x16_bf16 v[48:63], v[68:71], v[72:75], v[48:63]
  s_add_u32 s37, s35, 7808
  buffer_load_dwordx4 v8, s[12:15], s37 offen offset:1024 lds
  s_waitcnt lgkmcnt(0)
  ds_read_b128 v[64:67], v12 offset:2048
  ds_read_b128 v[68:71], v12 offset:6144
  ds_read_b128 v[72:75], v22 offset:0
  v_mfma_f32_32x32x16_bf16 v[32:47], v[80:83], v[88:91], v[32:47]
  v_mfma_f32_32x32x16_bf16 v[48:63], v[84:87], v[88:91], v[48:63]
  s_waitcnt lgkmcnt(0)
  ds_read_b128 v[80:83], v12 offset:3072
  ds_read_b128 v[84:87], v12 offset:7168
  ds_read_b128 v[88:91], v23 offset:0
  v_mfma_f32_32x32x16_bf16 v[32:47], v[64:67], v[72:75], v[32:47]
  v_mfma_f32_32x32x16_bf16 v[48:63], v[68:71], v[72:75], v[48:63]
  s_waitcnt lgkmcnt(0)
  s_waitcnt vmcnt(8)
  s_barrier
  ds_read_b128 v[64:67], v12 offset:32768
  ds_read_b128 v[68:71], v12 offset:36864
  ds_read_b128 v[72:75], v20 offset:32768
  v_mfma_f32_32x32x16_bf16 v[32:47], v[80:83], v[88:91], v[32:47]
  s_add_u32 m0, s36, 65536
  s_add_u32 s37, s34, 24576
  buffer_load_dwordx4 v3, s[8:11], s37 offen lds
  v_mfma_f32_32x32x16_bf16 v[48:63], v[84:87], v[88:91], v[48:63]
  buffer_load_dwordx4 v3, s[8:11], s37 offen offset:1024 lds
  s_waitcnt lgkmcnt(0)
  ds_read_b128 v[80:83], v12 offset:33792
  ds_read_b128 v[84:87], v12 offset:37888
  ds_read_b128 v[88:91], v21 offset:32768
  v_mfma_f32_32x32x16_bf16 v[32:47], v[64:67], v[72:75], v[32:47]
  s_add_u32 m0, s36, 81920
  s_add_u32 s37, s35, 768
  buffer_load_dwordx4 v7, s[12:15], s37 offen lds
  v_mfma_f32_32x32x16_bf16 v[48:63], v[68:71], v[72:75], v[48:63]
  s_add_u32 s37, s35, 7936
  buffer_load_dwordx4 v8, s[12:15], s37 offen offset:1024 lds
  s_waitcnt lgkmcnt(0)
  ds_read_b128 v[64:67], v12 offset:34816
  ds_read_b128 v[68:71], v12 offset:38912
  ds_read_b128 v[72:75], v22 offset:32768
  v_mfma_f32_32x32x16_bf16 v[32:47], v[80:83], v[88:91], v[32:47]
  v_mfma_f32_32x32x16_bf16 v[48:63], v[84:87], v[88:91], v[48:63]
  s_waitcnt lgkmcnt(0)
  ds_read_b128 v[80:83], v12 offset:35840
  ds_read_b128 v[84:87], v12 offset:39936
  ds_read_b128 v[88:91], v23 offset:32768
  v_mfma_f32_32x32x16_bf16 v[32:47], v[64:67], v[72:75], v[32:47]
  v_mfma_f32_32x32x16_bf16 v[48:63], v[68:71], v[72:75], v[48:63]
  s_waitcnt lgkmcnt(0)
  s_waitcnt vmcnt(8)
  s_barrier
  ds_read_b128 v[64:67], v11 offset:0
  ds_read_b128 v[68:71], v11 offset:4096
  ds_read_b128 v[72:75], v16 offset:0
  v_mfma_f32_32x32x16_bf16 v[32:47], v[80:83], v[88:91], v[32:47]
  s_add_u32 m0, s36, 98304
  s_add_u32 s37, s34, 28672
  buffer_load_dwordx4 v3, s[8:11], s37 offen lds
  v_mfma_f32_32x32x16_bf16 v[48:63], v[84:87], v[88:91], v[48:63]
  buffer_load_dwordx4 v3, s[8:11], s37 offen offset:1024 lds
  s_waitcnt lgkmcnt(0)
  ds_read_b128 v[80:83], v11 offset:1024
  ds_read_b128 v[84:87], v11 offset:5120
  ds_read_b128 v[88:91], v17 offset:0
  v_mfma_f32_32x32x16_bf16 v[32:47], v[64:67], v[72:75], v[32:47]
  s_add_u32 m0, s36, 114688
  s_add_u32 s37, s35, 896
  buffer_load_dwordx4 v7, s[12:15], s37 offen lds
  v_mfma_f32_32x32x16_bf16 v[48:63], v[68:71], v[72:75], v[48:63]
  s_add_u32 s37, s35, 8064
  buffer_load_dwordx4 v8, s[12:15], s37 offen offset:1024 lds
  s_waitcnt lgkmcnt(0)
  ds_read_b128 v[64:67], v11 offset:2048
  ds_read_b128 v[68:71], v11 offset:6144
  ds_read_b128 v[72:75], v18 offset:0
  v_mfma_f32_32x32x16_bf16 v[32:47], v[80:83], v[88:91], v[32:47]
  v_mfma_f32_32x32x16_bf16 v[48:63], v[84:87], v[88:91], v[48:63]
  s_waitcnt lgkmcnt(0)
  ds_read_b128 v[80:83], v11 offset:3072
  ds_read_b128 v[84:87], v11 offset:7168
  ds_read_b128 v[88:91], v19 offset:0
  v_mfma_f32_32x32x16_bf16 v[32:47], v[64:67], v[72:75], v[32:47]
  v_mfma_f32_32x32x16_bf16 v[48:63], v[68:71], v[72:75], v[48:63]
  s_waitcnt lgkmcnt(0)
  s_waitcnt vmcnt(8)
  s_barrier
  ds_read_b128 v[64:67], v11 offset:32768
  ds_read_b128 v[68:71], v11 offset:36864
  ds_read_b128 v[72:75], v16 offset:32768
  v_mfma_f32_32x32x16_bf16 v[32:47], v[80:83], v[88:91], v[32:47]
  buffer_load_dwordx2 v[96:97], v10, s[24:27], s32 offen offset:0
  v_mfma_f32_32x32x16_bf16 v[48:63], v[84:87], v[88:91], v[48:63]
  buffer_load_dwordx2 v[98:99], v10, s[24:27], s32 offen offset:16
  s_waitcnt lgkmcnt(0)
  ds_read_b128 v[80:83], v11 offset:33792
  ds_read_b128 v[84:87], v11 offset:37888
  ds_read_b128 v[88:91], v17 offset:32768
  v_mfma_f32_32x32x16_bf16 v[32:47], v[64:67], v[72:75], v[32:47]
  buffer_load_dwordx2 v[100:101], v10, s[24:27], s32 offen offset:32
  v_mfma_f32_32x32x16_bf16 v[48:63], v[68:71], v[72:75], v[48:63]
  buffer_load_dwordx2 v[102:103], v10, s[24:27], s32 offen offset:48
  s_waitcnt lgkmcnt(0)
  ds_read_b128 v[64:67], v11 offset:34816
  ds_read_b128 v[68:71], v11 offset:38912
  ds_read_b128 v[72:75], v18 offset:32768
  v_mfma_f32_32x32x16_bf16 v[32:47], v[80:83], v[88:91], v[32:47]
  buffer_load_dwordx2 v[104:105], v10, s[24:27], s32 offen offset:64
  v_mfma_f32_32x32x16_bf16 v[48:63], v[84:87], v[88:91], v[48:63]
  buffer_load_dwordx2 v[106:107], v10, s[24:27], s32 offen offset:80
  s_waitcnt lgkmcnt(0)
  ds_read_b128 v[80:83], v11 offset:35840
  ds_read_b128 v[84:87], v11 offset:39936
  ds_read_b128 v[88:91], v19 offset:32768
  v_mfma_f32_32x32x16_bf16 v[32:47], v[64:67], v[72:75], v[32:47]
  buffer_load_dwordx2 v[108:109], v10, s[24:27], s32 offen offset:96
  v_mfma_f32_32x32x16_bf16 v[48:63], v[68:71], v[72:75], v[48:63]
  buffer_load_dwordx2 v[110:111], v10, s[24:27], s32 offen offset:112
  s_waitcnt lgkmcnt(0)
  s_waitcnt vmcnt(12)
  s_barrier
  ds_read_b128 v[64:67], v12 offset:0
  ds_read_b128 v[68:71], v12 offset:4096
  ds_read_b128 v[72:75], v20 offset:0
  v_mfma_f32_32x32x16_bf16 v[32:47], v[80:83], v[88:91], v[32:47]
  v_mfma_f32_32x32x16_bf16 v[48:63], v[84:87], v[88:91], v[48:63]
  s_waitcnt lgkmcnt(0)
  ds_read_b128 v[80:83], v12 offset:1024
  ds_read_b128 v[84:87], v12 offset:5120
  ds_read_b128 v[88:91], v21 offset:0
  v_mfma_f32_32x32x16_bf16 v[32:47], v[64:67], v[72:75], v[32:47]
  v_mfma_f32_32x32x16_bf16 v[48:63], v[68:71], v[72:75], v[48:63]
  s_waitcnt lgkmcnt(0)
  ds_read_b128 v[64:67], v12 offset:2048
  ds_read_b128 v[68:71], v12 offset:6144
  ds_read_b128 v[72:75], v22 offset:0
  v_mfma_f32_32x32x16_bf16 v[32:47], v[80:83], v[88:91], v[32:47]
  v_mfma_f32_32x32x16_bf16 v[48:63], v[84:87], v[88:91], v[48:63]
  s_waitcnt lgkmcnt(0)
  ds_read_b128 v[80:83], v12 offset:3072
  ds_read_b128 v[84:87], v12 offset:7168
  ds_read_b128 v[88:91], v23 offset:0
  v_mfma_f32_32x32x16_bf16 v[32:47], v[64:67], v[72:75], v[32:47]
  v_mfma_f32_32x32x16_bf16 v[48:63], v[68:71], v[72:75], v[48:63]
  s_waitcnt lgkmcnt(0)
  s_waitcnt vmcnt(8)
  s_barrier
  ds_read_b128 v[64:67], v12 offset:32768
  ds_read_b128 v[68:71], v12 offset:36864
  ds_read_b128 v[72:75], v20 offset:32768
  v_mfma_f32_32x32x16_bf16 v[32:47], v[80:83], v[88:91], v[32:47]
  v_mfma_f32_32x32x16_bf16 v[48:63], v[84:87], v[88:91], v[48:63]
  s_waitcnt lgkmcnt(0)
  ds_read_b128 v[80:83], v12 offset:33792
  ds_read_b128 v[84:87], v12 offset:37888
  ds_read_b128 v[88:91], v21 offset:32768
  v_mfma_f32_32x32x16_bf16 v[32:47], v[64:67], v[72:75], v[32:47]
  v_mfma_f32_32x32x16_bf16 v[48:63], v[68:71], v[72:75], v[48:63]
  s_waitcnt lgkmcnt(0)
  ds_read_b128 v[64:67], v12 offset:34816
  ds_read_b128 v[68:71], v12 offset:38912
  ds_read_b128 v[72:75], v22 offset:32768
  v_mfma_f32_32x32x16_bf16 v[32:47], v[80:83], v[88:91], v[32:47]
  v_mfma_f32_32x32x16_bf16 v[48:63], v[84:87], v[88:91], v[48:63]
  s_waitcnt lgkmcnt(0)
  ds_read_b128 v[80:83], v12 offset:35840
  ds_read_b128 v[84:87], v12 offset:39936
  ds_read_b128 v[88:91], v23 offset:32768
  v_mfma_f32_32x32x16_bf16 v[32:47], v[64:67], v[72:75], v[32:47]
  v_mfma_f32_32x32x16_bf16 v[48:63], v[68:71], v[72:75], v[48:63]
  s_waitcnt lgkmcnt(0)
  v_mfma_f32_32x32x16_bf16 v[32:47], v[80:83], v[88:91], v[32:47]
  v_mfma_f32_32x32x16_bf16 v[48:63], v[84:87], v[88:91], v[48:63]
  v_mov_b32 v112, 0xc0135761
  v_mov_b32 v113, 0xc0135761
  s_mov_b32 s42, 0xbdd2d3e8
  s_mov_b32 s43, 0xbdd2d3e8
  s_mov_b32 s44, 1.0
  s_mov_b32 s45, 1.0
  s_lshl_b32 s46, s16, 2
  s_add_u32 s46, s46, s19
  s_mul_i32 s46, s46, 112
  s_lshl_b32 s47, s17, 3
  s_add_u32 s46, s46, s47
  s_lshl_b32 s47, s18, 2
  s_add_u32 s46, s46, s47
  s_lshl_b32 s46, s46, 10
  s_waitcnt vmcnt(0)
  s_nop 4
  v_lshlrev_b32 v64, 16, v96
  v_and_b32 v65, 0xffff0000, v96
  v_lshlrev_b32 v66, 16, v97
  v_and_b32 v67, 0xffff0000, v97
  v_lshlrev_b32 v68, 16, v98
  v_and_b32 v69, 0xffff0000, v98
  v_lshlrev_b32 v70, 16, v99
  v_and_b32 v71, 0xffff0000, v99
  v_lshlrev_b32 v72, 16, v100
  v_and_b32 v73, 0xffff0000, v100
  v_lshlrev_b32 v74, 16, v101
  v_and_b32 v75, 0xffff0000, v101
  v_lshlrev_b32 v76, 16, v102
  v_and_b32 v77, 0xffff0000, v102
  v_lshlrev_b32 v78, 16, v103
  v_and_b32 v79, 0xffff0000, v103
  v_lshlrev_b32 v80, 16, v104
  v_and_b32 v81, 0xffff0000, v104
  v_lshlrev_b32 v82, 16, v105
  v_and_b32 v83, 0xffff0000, v105
  v_lshlrev_b32 v84, 16, v106
  v_and_b32 v85, 0xffff0000, v106
  v_lshlrev_b32 v86, 16, v107
  v_and_b32 v87, 0xffff0000, v107
  v_lshlrev_b32 v88, 16, v108
  v_and_b32 v89, 0xffff0000, v108
  v_lshlrev_b32 v90, 16, v109
  v_and_b32 v91, 0xffff0000, v109
  v_lshlrev_b32 v92, 16, v110
  v_and_b32 v93, 0xffff0000, v110
  v_lshlrev_b32 v94, 16, v111
  v_and_b32 v95, 0xffff0000, v111
  v_cvt_pk_bf16_f32 v96, v32, v33
  v_cvt_pk_bf16_f32 v98, v34, v35
  v_cvt_pk_bf16_f32 v100, v36, v37
  v_cvt_pk_bf16_f32 v102, v38, v39
  v_lshlrev_b32 v32, 16, v96
  v_and_b32 v33, 0xffff0000, v96
  v_lshlrev_b32 v34, 16, v98
  v_and_b32 v35, 0xffff0000, v98
  v_lshlrev_b32 v36, 16, v100
  v_and_b32 v37, 0xffff0000, v100
  v_lshlrev_b32 v38, 16, v102
  v_and_b32 v39, 0xffff0000, v102
  v_pk_add_f32 v[32:33], v[32:33], v[64:65]
  v_pk_add_f32 v[34:35], v[34:35], v[66:67]
  v_pk_add_f32 v[36:37], v[36:37], v[68:69]
  v_pk_add_f32 v[38:39], v[38:39], v[70:71]
  v_cvt_pk_bf16_f32 v96, v32, v33
  v_cvt_pk_bf16_f32 v98, v34, v35
  v_cvt_pk_bf16_f32 v100, v36, v37
  v_cvt_pk_bf16_f32 v102, v38, v39
  v_lshlrev_b32 v32, 16, v96
  v_and_b32 v33, 0xffff0000, v96
  v_lshlrev_b32 v34, 16, v98
  v_and_b32 v35, 0xffff0000, v98
  v_lshlrev_b32 v36, 16, v100
  v_and_b32 v37, 0xffff0000, v100
  v_lshlrev_b32 v38, 16, v102
  v_and_b32 v39, 0xffff0000, v102
  v_pk_mul_f32 v[96:97], v[32:33], v[32:33]
  v_pk_mul_f32 v[98:99], v[34:35], v[34:35]
  v_pk_mul_f32 v[100:101], v[36:37], v[36:37]
  v_pk_mul_f32 v[102:103], v[38:39], v[38:39]
  v_pk_fma_f32 v[96:97], v[96:97], s[42:43], v[112:113]
  v_pk_fma_f32 v[98:99], v[98:99], s[42:43], v[112:113]
  v_pk_fma_f32 v[100:101], v[100:101], s[42:43], v[112:113]
  v_pk_fma_f32 v[102:103], v[102:103], s[42:43], v[112:113]
  v_pk_mul_f32 v[96:97], v[96:97], v[32:33]
  v_pk_mul_f32 v[98:99], v[98:99], v[34:35]
  v_pk_mul_f32 v[100:101], v[100:101], v[36:37]
  v_pk_mul_f32 v[102:103], v[102:103], v[38:39]
  v_exp_f32 v96, v96
  v_exp_f32 v97, v97
  v_exp_f32 v98, v98
  v_exp_f32 v99, v99
  v_exp_f32 v100, v100
  v_exp_f32 v101, v101
  v_exp_f32 v102, v102
  v_exp_f32 v103, v103
  s_nop 0
  v_pk_add_f32 v[96:97], v[96:97], s[44:45]
  v_pk_add_f32 v[98:99], v[98:99], s[44:45]
  v_pk_add_f32 v[100:101], v[100:101], s[44:45]
  v_pk_add_f32 v[102:103], v[102:103], s[44:45]
  v_rcp_f32 v96, v96
  v_rcp_f32 v97, v97
  v_rcp_f32 v98, v98
  v_rcp_f32 v99, v99
  v_rcp_f32 v100, v100
  v_rcp_f32 v101, v101
  v_rcp_f32 v102, v102
  v_rcp_f32 v103, v103
  s_nop 0
  v_pk_mul_f32 v[32:33], v[32:33], v[96:97]
  v_pk_mul_f32 v[34:35], v[34:35], v[98:99]
  v_pk_mul_f32 v[36:37], v[36:37], v[100:101]
  v_pk_mul_f32 v[38:39], v[38:39], v[102:103]
  v_cvt_pk_bf16_f32 v116, v32, v33
  v_cvt_pk_bf16_f32 v117, v34, v35
  v_cvt_pk_bf16_f32 v118, v36, v37
  v_cvt_pk_bf16_f32 v119, v38, v39
  buffer_store_dwordx4 v[116:119], v3, s[28:31], s46 offen offset:0 sc1
  v_cvt_pk_bf16_f32 v96, v40, v41
  v_cvt_pk_bf16_f32 v98, v42, v43
  v_cvt_pk_bf16_f32 v100, v44, v45
  v_cvt_pk_bf16_f32 v102, v46, v47
  v_lshlrev_b32 v40, 16, v96
  v_and_b32 v41, 0xffff0000, v96
  v_lshlrev_b32 v42, 16, v98
  v_and_b32 v43, 0xffff0000, v98
  v_lshlrev_b32 v44, 16, v100
  v_and_b32 v45, 0xffff0000, v100
  v_lshlrev_b32 v46, 16, v102
  v_and_b32 v47, 0xffff0000, v102
  v_pk_add_f32 v[40:41], v[40:41], v[72:73]
  v_pk_add_f32 v[42:43], v[42:43], v[74:75]
  v_pk_add_f32 v[44:45], v[44:45], v[76:77]
  v_pk_add_f32 v[46:47], v[46:47], v[78:79]
  v_cvt_pk_bf16_f32 v96, v40, v41
  v_cvt_pk_bf16_f32 v98, v42, v43
  v_cvt_pk_bf16_f32 v100, v44, v45
  v_cvt_pk_bf16_f32 v102, v46, v47
  v_lshlrev_b32 v40, 16, v96
  v_and_b32 v41, 0xffff0000, v96
  v_lshlrev_b32 v42, 16, v98
  v_and_b32 v43, 0xffff0000, v98
  v_lshlrev_b32 v44, 16, v100
  v_and_b32 v45, 0xffff0000, v100
  v_lshlrev_b32 v46, 16, v102
  v_and_b32 v47, 0xffff0000, v102
  v_pk_mul_f32 v[96:97], v[40:41], v[40:41]
  v_pk_mul_f32 v[98:99], v[42:43], v[42:43]
  v_pk_mul_f32 v[100:101], v[44:45], v[44:45]
  v_pk_mul_f32 v[102:103], v[46:47], v[46:47]
  v_pk_fma_f32 v[96:97], v[96:97], s[42:43], v[112:113]
  v_pk_fma_f32 v[98:99], v[98:99], s[42:43], v[112:113]
  v_pk_fma_f32 v[100:101], v[100:101], s[42:43], v[112:113]
  v_pk_fma_f32 v[102:103], v[102:103], s[42:43], v[112:113]
  v_pk_mul_f32 v[96:97], v[96:97], v[40:41]
  v_pk_mul_f32 v[98:99], v[98:99], v[42:43]
  v_pk_mul_f32 v[100:101], v[100:101], v[44:45]
  v_pk_mul_f32 v[102:103], v[102:103], v[46:47]
  v_exp_f32 v96, v96
  v_exp_f32 v97, v97
  v_exp_f32 v98, v98
  v_exp_f32 v99, v99
  v_exp_f32 v100, v100
  v_exp_f32 v101, v101
  v_exp_f32 v102, v102
  v_exp_f32 v103, v103
  s_nop 0
  v_pk_add_f32 v[96:97], v[96:97], s[44:45]
  v_pk_add_f32 v[98:99], v[98:99], s[44:45]
  v_pk_add_f32 v[100:101], v[100:101], s[44:45]
  v_pk_add_f32 v[102:103], v[102:103], s[44:45]
  v_rcp_f32 v96, v96
  v_rcp_f32 v97, v97
  v_rcp_f32 v98, v98
  v_rcp_f32 v99, v99
  v_rcp_f32 v100, v100
  v_rcp_f32 v101, v101
  v_rcp_f32 v102, v102
  v_rcp_f32 v103, v103
  s_nop 0
  v_pk_mul_f32 v[40:41], v[40:41], v[96:97]
  v_pk_mul_f32 v[42:43], v[42:43], v[98:99]
  v_pk_mul_f32 v[44:45], v[44:45], v[100:101]
  v_pk_mul_f32 v[46:47], v[46:47], v[102:103]
  v_cvt_pk_bf16_f32 v120, v40, v41
  v_cvt_pk_bf16_f32 v121, v42, v43
  v_cvt_pk_bf16_f32 v122, v44, v45
  v_cvt_pk_bf16_f32 v123, v46, v47
  buffer_store_dwordx4 v[120:123], v3, s[28:31], s46 offen offset:1024 sc1
  v_cvt_pk_bf16_f32 v96, v48, v49
  v_cvt_pk_bf16_f32 v98, v50, v51
  v_cvt_pk_bf16_f32 v100, v52, v53
  v_cvt_pk_bf16_f32 v102, v54, v55
  v_lshlrev_b32 v48, 16, v96
  v_and_b32 v49, 0xffff0000, v96
  v_lshlrev_b32 v50, 16, v98
  v_and_b32 v51, 0xffff0000, v98
  v_lshlrev_b32 v52, 16, v100
  v_and_b32 v53, 0xffff0000, v100
  v_lshlrev_b32 v54, 16, v102
  v_and_b32 v55, 0xffff0000, v102
  v_pk_add_f32 v[48:49], v[48:49], v[80:81]
  v_pk_add_f32 v[50:51], v[50:51], v[82:83]
  v_pk_add_f32 v[52:53], v[52:53], v[84:85]
  v_pk_add_f32 v[54:55], v[54:55], v[86:87]
  v_cvt_pk_bf16_f32 v96, v48, v49
  v_cvt_pk_bf16_f32 v98, v50, v51
  v_cvt_pk_bf16_f32 v100, v52, v53
  v_cvt_pk_bf16_f32 v102, v54, v55
  v_lshlrev_b32 v48, 16, v96
  v_and_b32 v49, 0xffff0000, v96
  v_lshlrev_b32 v50, 16, v98
  v_and_b32 v51, 0xffff0000, v98
  v_lshlrev_b32 v52, 16, v100
  v_and_b32 v53, 0xffff0000, v100
  v_lshlrev_b32 v54, 16, v102
  v_and_b32 v55, 0xffff0000, v102
  v_pk_mul_f32 v[96:97], v[48:49], v[48:49]
  v_pk_mul_f32 v[98:99], v[50:51], v[50:51]
  v_pk_mul_f32 v[100:101], v[52:53], v[52:53]
  v_pk_mul_f32 v[102:103], v[54:55], v[54:55]
  v_pk_fma_f32 v[96:97], v[96:97], s[42:43], v[112:113]
  v_pk_fma_f32 v[98:99], v[98:99], s[42:43], v[112:113]
  v_pk_fma_f32 v[100:101], v[100:101], s[42:43], v[112:113]
  v_pk_fma_f32 v[102:103], v[102:103], s[42:43], v[112:113]
  v_pk_mul_f32 v[96:97], v[96:97], v[48:49]
  v_pk_mul_f32 v[98:99], v[98:99], v[50:51]
  v_pk_mul_f32 v[100:101], v[100:101], v[52:53]
  v_pk_mul_f32 v[102:103], v[102:103], v[54:55]
  v_exp_f32 v96, v96
  v_exp_f32 v97, v97
  v_exp_f32 v98, v98
  v_exp_f32 v99, v99
  v_exp_f32 v100, v100
  v_exp_f32 v101, v101
  v_exp_f32 v102, v102
  v_exp_f32 v103, v103
  s_nop 0
  v_pk_add_f32 v[96:97], v[96:97], s[44:45]
  v_pk_add_f32 v[98:99], v[98:99], s[44:45]
  v_pk_add_f32 v[100:101], v[100:101], s[44:45]
  v_pk_add_f32 v[102:103], v[102:103], s[44:45]
  v_rcp_f32 v96, v96
  v_rcp_f32 v97, v97
  v_rcp_f32 v98, v98
  v_rcp_f32 v99, v99
  v_rcp_f32 v100, v100
  v_rcp_f32 v101, v101
  v_rcp_f32 v102, v102
  v_rcp_f32 v103, v103
  s_nop 0
  v_pk_mul_f32 v[48:49], v[48:49], v[96:97]
  v_pk_mul_f32 v[50:51], v[50:51], v[98:99]
  v_pk_mul_f32 v[52:53], v[52:53], v[100:101]
  v_pk_mul_f32 v[54:55], v[54:55], v[102:103]
  v_cvt_pk_bf16_f32 v124, v48, v49
  v_cvt_pk_bf16_f32 v125, v50, v51
  v_cvt_pk_bf16_f32 v126, v52, v53
  v_cvt_pk_bf16_f32 v127, v54, v55
  buffer_store_dwordx4 v[124:127], v3, s[28:31], s46 offen offset:2048 sc1
  v_cvt_pk_bf16_f32 v96, v56, v57
  v_cvt_pk_bf16_f32 v98, v58, v59
  v_cvt_pk_bf16_f32 v100, v60, v61
  v_cvt_pk_bf16_f32 v102, v62, v63
  v_lshlrev_b32 v56, 16, v96
  v_and_b32 v57, 0xffff0000, v96
  v_lshlrev_b32 v58, 16, v98
  v_and_b32 v59, 0xffff0000, v98
  v_lshlrev_b32 v60, 16, v100
  v_and_b32 v61, 0xffff0000, v100
  v_lshlrev_b32 v62, 16, v102
  v_and_b32 v63, 0xffff0000, v102
  v_pk_add_f32 v[56:57], v[56:57], v[88:89]
  v_pk_add_f32 v[58:59], v[58:59], v[90:91]
  v_pk_add_f32 v[60:61], v[60:61], v[92:93]
  v_pk_add_f32 v[62:63], v[62:63], v[94:95]
  v_cvt_pk_bf16_f32 v96, v56, v57
  v_cvt_pk_bf16_f32 v98, v58, v59
  v_cvt_pk_bf16_f32 v100, v60, v61
  v_cvt_pk_bf16_f32 v102, v62, v63
  v_lshlrev_b32 v56, 16, v96
  v_and_b32 v57, 0xffff0000, v96
  v_lshlrev_b32 v58, 16, v98
  v_and_b32 v59, 0xffff0000, v98
  v_lshlrev_b32 v60, 16, v100
  v_and_b32 v61, 0xffff0000, v100
  v_lshlrev_b32 v62, 16, v102
  v_and_b32 v63, 0xffff0000, v102
  v_pk_mul_f32 v[96:97], v[56:57], v[56:57]
  v_pk_mul_f32 v[98:99], v[58:59], v[58:59]
  v_pk_mul_f32 v[100:101], v[60:61], v[60:61]
  v_pk_mul_f32 v[102:103], v[62:63], v[62:63]
  v_pk_fma_f32 v[96:97], v[96:97], s[42:43], v[112:113]
  v_pk_fma_f32 v[98:99], v[98:99], s[42:43], v[112:113]
  v_pk_fma_f32 v[100:101], v[100:101], s[42:43], v[112:113]
  v_pk_fma_f32 v[102:103], v[102:103], s[42:43], v[112:113]
  v_pk_mul_f32 v[96:97], v[96:97], v[56:57]
  v_pk_mul_f32 v[98:99], v[98:99], v[58:59]
  v_pk_mul_f32 v[100:101], v[100:101], v[60:61]
  v_pk_mul_f32 v[102:103], v[102:103], v[62:63]
  v_exp_f32 v96, v96
  v_exp_f32 v97, v97
  v_exp_f32 v98, v98
  v_exp_f32 v99, v99
  v_exp_f32 v100, v100
  v_exp_f32 v101, v101
  v_exp_f32 v102, v102
  v_exp_f32 v103, v103
  s_nop 0
  v_pk_add_f32 v[96:97], v[96:97], s[44:45]
  v_pk_add_f32 v[98:99], v[98:99], s[44:45]
  v_pk_add_f32 v[100:101], v[100:101], s[44:45]
  v_pk_add_f32 v[102:103], v[102:103], s[44:45]
  v_rcp_f32 v96, v96
  v_rcp_f32 v97, v97
  v_rcp_f32 v98, v98
  v_rcp_f32 v99, v99
  v_rcp_f32 v100, v100
  v_rcp_f32 v101, v101
  v_rcp_f32 v102, v102
  v_rcp_f32 v103, v103
  s_nop 0
  v_pk_mul_f32 v[56:57], v[56:57], v[96:97]
  v_pk_mul_f32 v[58:59], v[58:59], v[98:99]
  v_pk_mul_f32 v[60:61], v[60:61], v[100:101]
  v_pk_mul_f32 v[62:63], v[62:63], v[102:103]
  v_cvt_pk_bf16_f32 v128, v56, v57
  v_cvt_pk_bf16_f32 v129, v58, v59
  v_cvt_pk_bf16_f32 v130, v60, v61
  v_cvt_pk_bf16_f32 v131, v62, v63
  buffer_store_dwordx4 v[128:131], v3, s[28:31], s46 offen offset:3072 sc1
L_c0_kernel_g1_end_1:
  s_branch L_c0_kernel_g1d_6
L_c0_kernel_g1d_6:
  s_waitcnt vmcnt(0) lgkmcnt(0)
  s_barrier
  s_cmp_lg_u32 s93, 0
  s_cbranch_scc1 L_c0_kernel_pub_7
  s_lshl_b32 s18, s16, 6
  s_lshl_b32 s19, s17, 2
  s_add_u32 s18, s18, s19
  s_add_u32 s18, s18, 1024
  v_mov_b32 v1, 1
  v_mov_b32 v2, 0
  s_mov_b64 exec, 1
  buffer_store_dword v1, v2, s[84:87], s18 offen sc1
  s_mov_b64 exec, -1
L_c0_kernel_pub_7:
L_c0_kernel_g2_5:
  v_mov_b32 v0, v255
  s_mov_b32 s2, s95
  s_mov_b32 s3, s93
  s_cmp_ge_u32 s3, 4
  s_cbranch_scc1 L_c0_kernel_g2s_9
  s_load_dwordx2 s[6:7], s[0:1], 80
  s_load_dwordx2 s[4:5], s[0:1], 56
  v_lshrrev_b32 v2, 6, v0
  v_and_b32 v1, 63, v0
  v_readfirstlane_b32 s3, v2
  s_bfe_u32 s17, s2, 0x30003
  s_lshr_b32 s16, s2, 6
  s_lshl_b32 s16, s16, 3
  s_and_b32 s18, s2, 7
  s_add_u32 s16, s16, s18
  v_lshlrev_b32 v3, 4, v1
  s_waitcnt lgkmcnt(0)
  s_add_u32 s8, s6, 27262976
  s_addc_u32 s9, s7, 0
  s_mov_b32 s10, 1835008
  s_mov_b32 s11, 0x00020000
  s_add_u32 s12, s6, 16777216
  s_addc_u32 s13, s7, 0
  s_mov_b32 s14, 7340032
  s_mov_b32 s15, 0x00020000
  s_mov_b32 s24, s4
  s_mov_b32 s25, s5
  s_mov_b32 s26, 1024
  s_mov_b32 s27, 0x00020000
  s_add_u32 s28, s6, 10485760
  s_addc_u32 s29, s7, 0
  s_mov_b32 s30, 2097152
  s_mov_b32 s31, 0x00020000
  s_add_u32 s32, s6, 12582912
  s_addc_u32 s33, s7, 0
  s_mov_b32 s34, 2097152
  s_mov_b32 s35, 0x00020000
  s_mul_i32 s36, s3, 28672
  s_mul_i32 s37, s17, 229376
  s_add_u32 s37, s37, s36
  s_add_u32 s38, s37, 114688
  s_mul_i32 s39, s16, 229376
  s_add_u32 s39, s39, s36
  s_add_u32 s40, s39, 114688
  buffer_load_dwordx4 v[80:83], v3, s[8:11], s37 offen offset:0
  buffer_load_dwordx4 v[84:87], v3, s[8:11], s38 offen offset:0
  buffer_load_dwordx4 v[96:99], v3, s[8:11], s37 offen offset:1024
  buffer_load_dwordx4 v[100:103], v3, s[8:11], s38 offen offset:1024
  buffer_load_dwordx4 v[112:115], v3, s[8:11], s37 offen offset:2048
  buffer_load_dwordx4 v[116:119], v3, s[8:11], s38 offen offset:2048
  buffer_load_dwordx4 v[128:131], v3, s[8:11], s37 offen offset:3072
  buffer_load_dwordx4 v[132:135], v3, s[8:11], s38 offen offset:3072
  s_add_u32 s37, s37, 4096
  s_add_u32 s38, s38, 4096
  buffer_load_dwordx4 v[144:147], v3, s[8:11], s37 offen offset:0
  buffer_load_dwordx4 v[148:151], v3, s[8:11], s38 offen offset:0
  buffer_load_dwordx4 v[160:163], v3, s[8:11], s37 offen offset:1024
  buffer_load_dwordx4 v[164:167], v3, s[8:11], s38 offen offset:1024
  buffer_load_dwordx4 v[176:179], v3, s[8:11], s37 offen offset:2048
  buffer_load_dwordx4 v[180:183], v3, s[8:11], s38 offen offset:2048
  buffer_load_dwordx4 v[192:195], v3, s[8:11], s37 offen offset:3072
  buffer_load_dwordx4 v[196:199], v3, s[8:11], s38 offen offset:3072
  s_add_u32 s37, s37, 4096
  s_add_u32 s38, s38, 4096
  s_cmp_lg_u32 s93, 0
  s_cbranch_scc1 L_c0_kernel_g2_hs_2
  s_lshr_b32 s50, s16, 1
  s_lshl_b32 s50, s50, 6
  s_add_u32 s50, s50, 1024
  v_lshlrev_b32 v8, 2, v1
  s_mov_b32 s51, 0
  s_mov_b32 exec_lo, 0x3fff
  s_mov_b32 exec_hi, 0
L_c0_kernel_g2_hl_3:
  buffer_load_dword v9, v8, s[84:87], s50 offen sc1
  s_add_u32 s51, s51, 1
  s_waitcnt vmcnt(0)
  v_cmp_ne_u32 vcc, 1, v9
  s_cmp_ge_u32 s51, 400000
  s_cbranch_scc1 L_c0_kernel_g2_ho_4
  s_cbranch_vccz L_c0_kernel_g2_ho_4
  s_sleep 6
  s_branch L_c0_kernel_g2_hl_3
L_c0_kernel_g2_ho_4:
  s_mov_b64 exec, -1
L_c0_kernel_g2_hs_2:
  s_barrier
  buffer_load_dwordx4 v[88:91], v3, s[12:15], s39 offen offset:0
  buffer_load_dwordx4 v[92:95], v3, s[12:15], s40 offen offset:0
  buffer_load_dwordx4 v[104:107], v3, s[12:15], s39 offen offset:1024
  buffer_load_dwordx4 v[108:111], v3, s[12:15], s40 offen offset:1024
  buffer_load_dwordx4 v[120:123], v3, s[12:15], s39 offen offset:2048
  buffer_load_dwordx4 v[124:127], v3, s[12:15], s40 offen offset:2048
  buffer_load_dwordx4 v[136:139], v3, s[12:15], s39 offen offset:3072
  buffer_load_dwordx4 v[140:143], v3, s[12:15], s40 offen offset:3072
  s_add_u32 s39, s39, 4096
  s_add_u32 s40, s40, 4096
  buffer_load_dwordx4 v[152:155], v3, s[12:15], s39 offen offset:0
  buffer_load_dwordx4 v[156:159], v3, s[12:15], s40 offen offset:0
  buffer_load_dwordx4 v[168:171], v3, s[12:15], s39 offen offset:1024
  buffer_load_dwordx4 v[172:175], v3, s[12:15], s40 offen offset:1024
  buffer_load_dwordx4 v[184:187], v3, s[12:15], s39 offen offset:2048
  buffer_load_dwordx4 v[188:191], v3, s[12:15], s40 offen offset:2048
  buffer_load_dwordx4 v[200:203], v3, s[12:15], s39 offen offset:3072
  buffer_load_dwordx4 v[204:207], v3, s[12:15], s40 offen offset:3072
  s_add_u32 s39, s39, 4096
  s_add_u32 s40, s40, 4096
  s_lshr_b32 s41, s3, 1
  s_and_b32 s42, s3, 1
  v_and_b32 v4, 31, v1
  v_lshrrev_b32 v5, 5, v1
  v_lshlrev_b32 v6, 4, v5
  v_lshl_add_u32 v7, v4, 10, v6
  s_lshl_b32 s43, s17, 1
  s_add_u32 s43, s43, s41
  s_lshl_b32 s43, s43, 6
  s_lshl_b32 s44, s16, 1
  s_add_u32 s44, s44, s42
  s_lshl_b32 s44, s44, 15
  s_add_u32 s44, s44, s43
  v_mov_b32 v16, 0
  v_mov_b32 v17, 0
  v_mov_b32 v18, 0
  v_mov_b32 v19, 0
  v_mov_b32 v20, 0
  v_mov_b32 v21, 0
  v_mov_b32 v22, 0
  v_mov_b32 v23, 0
  v_mov_b32 v24, 0
  v_mov_b32 v25, 0
  v_mov_b32 v26, 0
  v_mov_b32 v27, 0
  v_mov_b32 v28, 0
  v_mov_b32 v29, 0
  v_mov_b32 v30, 0
  v_mov_b32 v31, 0
  v_mov_b32 v32, 0
  v_mov_b32 v33, 0
  v_mov_b32 v34, 0
  v_mov_b32 v35, 0
  v_mov_b32 v36, 0
  v_mov_b32 v37, 0
  v_mov_b32 v38, 0
  v_mov_b32 v39, 0
  v_mov_b32 v40, 0
  v_mov_b32 v41, 0
  v_mov_b32 v42, 0
  v_mov_b32 v43, 0
  v_mov_b32 v44, 0
  v_mov_b32 v45, 0
  v_mov_b32 v46, 0
  v_mov_b32 v47, 0
  v_mov_b32 v48, 0
  v_mov_b32 v49, 0
  v_mov_b32 v50, 0
  v_mov_b32 v51, 0
  v_mov_b32 v52, 0
  v_mov_b32 v53, 0
  v_mov_b32 v54, 0
  v_mov_b32 v55, 0
  v_mov_b32 v56, 0
  v_mov_b32 v57, 0
  v_mov_b32 v58, 0
  v_mov_b32 v59, 0
  v_mov_b32 v60, 0
  v_mov_b32 v61, 0
  v_mov_b32 v62, 0
  v_mov_b32 v63, 0
  v_mov_b32 v64, 0
  v_mov_b32 v65, 0
  v_mov_b32 v66, 0
  v_mov_b32 v67, 0
  v_mov_b32 v68, 0
  v_mov_b32 v69, 0
  v_mov_b32 v70, 0
  v_mov_b32 v71, 0
  v_mov_b32 v72, 0
  v_mov_b32 v73, 0
  v_mov_b32 v74, 0
  v_mov_b32 v75, 0
  v_mov_b32 v76, 0
  v_mov_b32 v77, 0
  v_mov_b32 v78, 0
  v_mov_b32 v79, 0
  s_waitcnt vmcnt(14)
  v_mfma_f32_32x32x16_bf16 v[16:31], v[80:83], v[88:91], v[16:31]
  v_mfma_f32_32x32x16_bf16 v[32:47], v[80:83], v[92:95], v[32:47]
  v_mfma_f32_32x32x16_bf16 v[48:63], v[84:87], v[88:91], v[48:63]
  v_mfma_f32_32x32x16_bf16 v[64:79], v[84:87], v[92:95], v[64:79]
  buffer_load_dwordx4 v[80:83], v3, s[8:11], s37 offen offset:0
  buffer_load_dwordx4 v[84:87], v3, s[8:11], s38 offen offset:0
  buffer_load_dwordx4 v[88:91], v3, s[12:15], s39 offen offset:0
  buffer_load_dwordx4 v[92:95], v3, s[12:15], s40 offen offset:0
  s_waitcnt vmcnt(16)
  v_mfma_f32_32x32x16_bf16 v[16:31], v[96:99], v[104:107], v[16:31]
  v_mfma_f32_32x32x16_bf16 v[32:47], v[96:99], v[108:111], v[32:47]
  v_mfma_f32_32x32x16_bf16 v[48:63], v[100:103], v[104:107], v[48:63]
  v_mfma_f32_32x32x16_bf16 v[64:79], v[100:103], v[108:111], v[64:79]
  buffer_load_dwordx4 v[96:99], v3, s[8:11], s37 offen offset:1024
  buffer_load_dwordx4 v[100:103], v3, s[8:11], s38 offen offset:1024
  buffer_load_dwordx4 v[104:107], v3, s[12:15], s39 offen offset:1024
  buffer_load_dwordx4 v[108:111], v3, s[12:15], s40 offen offset:1024
  s_waitcnt vmcnt(18)
  v_mfma_f32_32x32x16_bf16 v[16:31], v[112:115], v[120:123], v[16:31]
  v_mfma_f32_32x32x16_bf16 v[32:47], v[112:115], v[124:127], v[32:47]
  v_mfma_f32_32x32x16_bf16 v[48:63], v[116:119], v[120:123], v[48:63]
  v_mfma_f32_32x32x16_bf16 v[64:79], v[116:119], v[124:127], v[64:79]
  buffer_load_dwordx4 v[112:115], v3, s[8:11], s37 offen offset:2048
  buffer_load_dwordx4 v[116:119], v3, s[8:11], s38 offen offset:2048
  buffer_load_dwordx4 v[120:123], v3, s[12:15], s39 offen offset:2048
  buffer_load_dwordx4 v[124:127], v3, s[12:15], s40 offen offset:2048
  s_waitcnt vmcnt(20)
  v_mfma_f32_32x32x16_bf16 v[16:31], v[128:131], v[136:139], v[16:31]
  v_mfma_f32_32x32x16_bf16 v[32:47], v[128:131], v[140:143], v[32:47]
  v_mfma_f32_32x32x16_bf16 v[48:63], v[132:135], v[136:139], v[48:63]
  v_mfma_f32_32x32x16_bf16 v[64:79], v[132:135], v[140:143], v[64:79]
  buffer_load_dwordx4 v[128:131], v3, s[8:11], s37 offen offset:3072
  buffer_load_dwordx4 v[132:135], v3, s[8:11], s38 offen offset:3072
  buffer_load_dwordx4 v[136:139], v3, s[12:15], s39 offen offset:3072
  buffer_load_dwordx4 v[140:143], v3, s[12:15], s40 offen offset:3072
  s_add_u32 s37, s37, 4096
  s_add_u32 s38, s38, 4096
  s_add_u32 s39, s39, 4096
  s_add_u32 s40, s40, 4096
  s_waitcnt vmcnt(22)
  v_mfma_f32_32x32x16_bf16 v[16:31], v[144:147], v[152:155], v[16:31]
  v_mfma_f32_32x32x16_bf16 v[32:47], v[144:147], v[156:159], v[32:47]
  v_mfma_f32_32x32x16_bf16 v[48:63], v[148:151], v[152:155], v[48:63]
  v_mfma_f32_32x32x16_bf16 v[64:79], v[148:151], v[156:159], v[64:79]
  buffer_load_dwordx4 v[144:147], v3, s[8:11], s37 offen offset:0
  buffer_load_dwordx4 v[148:151], v3, s[8:11], s38 offen offset:0
  buffer_load_dwordx4 v[152:155], v3, s[12:15], s39 offen offset:0
  buffer_load_dwordx4 v[156:159], v3, s[12:15], s40 offen offset:0
  s_waitcnt vmcnt(24)
  v_mfma_f32_32x32x16_bf16 v[16:31], v[160:163], v[168:171], v[16:31]
  v_mfma_f32_32x32x16_bf16 v[32:47], v[160:163], v[172:175], v[32:47]
  v_mfma_f32_32x32x16_bf16 v[48:63], v[164:167], v[168:171], v[48:63]
  v_mfma_f32_32x32x16_bf16 v[64:79], v[164:167], v[172:175], v[64:79]
  buffer_load_dwordx4 v[160:163], v3, s[8:11], s37 offen offset:1024
  buffer_load_dwordx4 v[164:167], v3, s[8:11], s38 offen offset:1024
  buffer_load_dwordx4 v[168:171], v3, s[12:15], s39 offen offset:1024
  buffer_load_dwordx4 v[172:175], v3, s[12:15], s40 offen offset:1024
  s_waitcnt vmcnt(26)
  v_mfma_f32_32x32x16_bf16 v[16:31], v[176:179], v[184:187], v[16:31]
  v_mfma_f32_32x32x16_bf16 v[32:47], v[176:179], v[188:191], v[32:47]
  v_mfma_f32_32x32x16_bf16 v[48:63], v[180:183], v[184:187], v[48:63]
  v_mfma_f32_32x32x16_bf16 v[64:79], v[180:183], v[188:191], v[64:79]
  buffer_load_dwordx4 v[176:179], v3, s[8:11], s37 offen offset:2048
  buffer_load_dwordx4 v[180:183], v3, s[8:11], s38 offen offset:2048
  buffer_load_dwordx4 v[184:187], v3, s[12:15], s39 offen offset:2048
  buffer_load_dwordx4 v[188:191], v3, s[12:15], s40 offen offset:2048
  s_waitcnt vmcnt(28)
  v_mfma_f32_32x32x16_bf16 v[16:31], v[192:195], v[200:203], v[16:31]
  v_mfma_f32_32x32x16_bf16 v[32:47], v[192:195], v[204:207], v[32:47]
  v_mfma_f32_32x32x16_bf16 v[48:63], v[196:199], v[200:203], v[48:63]
  v_mfma_f32_32x32x16_bf16 v[64:79], v[196:199], v[204:207], v[64:79]
  buffer_load_dwordx4 v[192:195], v3, s[8:11], s37 offen offset:3072
  buffer_load_dwordx4 v[196:199], v3, s[8:11], s38 offen offset:3072
  buffer_load_dwordx4 v[200:203], v3, s[12:15], s39 offen offset:3072
  buffer_load_dwordx4 v[204:207], v3, s[12:15], s40 offen offset:3072
  s_add_u32 s37, s37, 4096
  s_add_u32 s38, s38, 4096
  s_add_u32 s39, s39, 4096
  s_add_u32 s40, s40, 4096
  s_waitcnt vmcnt(28)
  v_mfma_f32_32x32x16_bf16 v[16:31], v[80:83], v[88:91], v[16:31]
  v_mfma_f32_32x32x16_bf16 v[32:47], v[80:83], v[92:95], v[32:47]
  v_mfma_f32_32x32x16_bf16 v[48:63], v[84:87], v[88:91], v[48:63]
  v_mfma_f32_32x32x16_bf16 v[64:79], v[84:87], v[92:95], v[64:79]
  buffer_load_dwordx4 v[80:83], v3, s[8:11], s37 offen offset:0
  buffer_load_dwordx4 v[84:87], v3, s[8:11], s38 offen offset:0
  buffer_load_dwordx4 v[88:91], v3, s[12:15], s39 offen offset:0
  buffer_load_dwordx4 v[92:95], v3, s[12:15], s40 offen offset:0
  s_waitcnt vmcnt(28)
  v_mfma_f32_32x32x16_bf16 v[16:31], v[96:99], v[104:107], v[16:31]
  v_mfma_f32_32x32x16_bf16 v[32:47], v[96:99], v[108:111], v[32:47]
  v_mfma_f32_32x32x16_bf16 v[48:63], v[100:103], v[104:107], v[48:63]
  v_mfma_f32_32x32x16_bf16 v[64:79], v[100:103], v[108:111], v[64:79]
  buffer_load_dwordx4 v[96:99], v3, s[8:11], s37 offen offset:1024
  buffer_load_dwordx4 v[100:103], v3, s[8:11], s38 offen offset:1024
  buffer_load_dwordx4 v[104:107], v3, s[12:15], s39 offen offset:1024
  buffer_load_dwordx4 v[108:111], v3, s[12:15], s40 offen offset:1024
  s_waitcnt vmcnt(28)
  v_mfma_f32_32x32x16_bf16 v[16:31], v[112:115], v[120:123], v[16:31]
  v_mfma_f32_32x32x16_bf16 v[32:47], v[112:115], v[124:127], v[32:47]
  v_mfma_f32_32x32x16_bf16 v[48:63], v[116:119], v[120:123], v[48:63]
  v_mfma_f32_32x32x16_bf16 v[64:79], v[116:119], v[124:127], v[64:79]
  buffer_load_dwordx4 v[112:115], v3, s[8:11], s37 offen offset:2048
  buffer_load_dwordx4 v[116:119], v3, s[8:11], s38 offen offset:2048
  buffer_load_dwordx4 v[120:123], v3, s[12:15], s39 offen offset:2048
  buffer_load_dwordx4 v[124:127], v3, s[12:15], s40 offen offset:2048
  s_waitcnt vmcnt(28)
  v_mfma_f32_32x32x16_bf16 v[16:31], v[128:131], v[136:139], v[16:31]
  v_mfma_f32_32x32x16_bf16 v[32:47], v[128:131], v[140:143], v[32:47]
  v_mfma_f32_32x32x16_bf16 v[48:63], v[132:135], v[136:139], v[48:63]
  v_mfma_f32_32x32x16_bf16 v[64:79], v[132:135], v[140:143], v[64:79]
  buffer_load_dwordx4 v[128:131], v3, s[8:11], s37 offen offset:3072
  buffer_load_dwordx4 v[132:135], v3, s[8:11], s38 offen offset:3072
  buffer_load_dwordx4 v[136:139], v3, s[12:15], s39 offen offset:3072
  buffer_load_dwordx4 v[140:143], v3, s[12:15], s40 offen offset:3072
  s_add_u32 s37, s37, 4096
  s_add_u32 s38, s38, 4096
  s_add_u32 s39, s39, 4096
  s_add_u32 s40, s40, 4096
  s_waitcnt vmcnt(28)
  v_mfma_f32_32x32x16_bf16 v[16:31], v[144:147], v[152:155], v[16:31]
  v_mfma_f32_32x32x16_bf16 v[32:47], v[144:147], v[156:159], v[32:47]
  v_mfma_f32_32x32x16_bf16 v[48:63], v[148:151], v[152:155], v[48:63]
  v_mfma_f32_32x32x16_bf16 v[64:79], v[148:151], v[156:159], v[64:79]
  buffer_load_dwordx4 v[144:147], v3, s[8:11], s37 offen offset:0
  buffer_load_dwordx4 v[148:151], v3, s[8:11], s38 offen offset:0
  buffer_load_dwordx4 v[152:155], v3, s[12:15], s39 offen offset:0
  buffer_load_dwordx4 v[156:159], v3, s[12:15], s40 offen offset:0
  s_waitcnt vmcnt(28)
  v_mfma_f32_32x32x16_bf16 v[16:31], v[160:163], v[168:171], v[16:31]
  v_mfma_f32_32x32x16_bf16 v[32:47], v[160:163], v[172:175], v[32:47]
  v_mfma_f32_32x32x16_bf16 v[48:63], v[164:167], v[168:171], v[48:63]
  v_mfma_f32_32x32x16_bf16 v[64:79], v[164:167], v[172:175], v[64:79]
  buffer_load_dwordx4 v[160:163], v3, s[8:11], s37 offen offset:1024
  buffer_load_dwordx4 v[164:167], v3, s[8:11], s38 offen offset:1024
  buffer_load_dwordx4 v[168:171], v3, s[12:15], s39 offen offset:1024
  buffer_load_dwordx4 v[172:175], v3, s[12:15], s40 offen offset:1024
  s_waitcnt vmcnt(28)
  v_mfma_f32_32x32x16_bf16 v[16:31], v[176:179], v[184:187], v[16:31]
  v_mfma_f32_32x32x16_bf16 v[32:47], v[176:179], v[188:191], v[32:47]
  v_mfma_f32_32x32x16_bf16 v[48:63], v[180:183], v[184:187], v[48:63]
  v_mfma_f32_32x32x16_bf16 v[64:79], v[180:183], v[188:191], v[64:79]
  buffer_load_dwordx4 v[176:179], v3, s[8:11], s37 offen offset:2048
  buffer_load_dwordx4 v[180:183], v3, s[8:11], s38 offen offset:2048
  buffer_load_dwordx4 v[184:187], v3, s[12:15], s39 offen offset:2048
  buffer_load_dwordx4 v[188:191], v3, s[12:15], s40 offen offset:2048
  s_waitcnt vmcnt(28)
  v_mfma_f32_32x32x16_bf16 v[16:31], v[192:195], v[200:203], v[16:31]
  v_mfma_f32_32x32x16_bf16 v[32:47], v[192:195], v[204:207], v[32:47]
  v_mfma_f32_32x32x16_bf16 v[48:63], v[196:199], v[200:203], v[48:63]
  v_mfma_f32_32x32x16_bf16 v[64:79], v[196:199], v[204:207], v[64:79]
  buffer_load_dwordx4 v[192:195], v3, s[8:11], s37 offen offset:3072
  buffer_load_dwordx4 v[196:199], v3, s[8:11], s38 offen offset:3072
  buffer_load_dwordx4 v[200:203], v3, s[12:15], s39 offen offset:3072
  buffer_load_dwordx4 v[204:207], v3, s[12:15], s40 offen offset:3072
  s_add_u32 s37, s37, 4096
  s_add_u32 s38, s38, 4096
  s_add_u32 s39, s39, 4096
  s_add_u32 s40, s40, 4096
  s_waitcnt vmcnt(28)
  v_mfma_f32_32x32x16_bf16 v[16:31], v[80:83], v[88:91], v[16:31]
  v_mfma_f32_32x32x16_bf16 v[32:47], v[80:83], v[92:95], v[32:47]
  v_mfma_f32_32x32x16_bf16 v[48:63], v[84:87], v[88:91], v[48:63]
  v_mfma_f32_32x32x16_bf16 v[64:79], v[84:87], v[92:95], v[64:79]
  buffer_load_dwordx4 v[80:83], v3, s[8:11], s37 offen offset:0
  buffer_load_dwordx4 v[84:87], v3, s[8:11], s38 offen offset:0
  buffer_load_dwordx4 v[88:91], v3, s[12:15], s39 offen offset:0
  buffer_load_dwordx4 v[92:95], v3, s[12:15], s40 offen offset:0
  s_waitcnt vmcnt(28)
  v_mfma_f32_32x32x16_bf16 v[16:31], v[96:99], v[104:107], v[16:31]
  v_mfma_f32_32x32x16_bf16 v[32:47], v[96:99], v[108:111], v[32:47]
  v_mfma_f32_32x32x16_bf16 v[48:63], v[100:103], v[104:107], v[48:63]
  v_mfma_f32_32x32x16_bf16 v[64:79], v[100:103], v[108:111], v[64:79]
  buffer_load_dwordx4 v[96:99], v3, s[8:11], s37 offen offset:1024
  buffer_load_dwordx4 v[100:103], v3, s[8:11], s38 offen offset:1024
  buffer_load_dwordx4 v[104:107], v3, s[12:15], s39 offen offset:1024
  buffer_load_dwordx4 v[108:111], v3, s[12:15], s40 offen offset:1024
  s_waitcnt vmcnt(28)
  v_mfma_f32_32x32x16_bf16 v[16:31], v[112:115], v[120:123], v[16:31]
  v_mfma_f32_32x32x16_bf16 v[32:47], v[112:115], v[124:127], v[32:47]
  v_mfma_f32_32x32x16_bf16 v[48:63], v[116:119], v[120:123], v[48:63]
  v_mfma_f32_32x32x16_bf16 v[64:79], v[116:119], v[124:127], v[64:79]
  buffer_load_dwordx4 v[112:115], v3, s[8:11], s37 offen offset:2048
  buffer_load_dwordx4 v[116:119], v3, s[8:11], s38 offen offset:2048
  buffer_load_dwordx4 v[120:123], v3, s[12:15], s39 offen offset:2048
  buffer_load_dwordx4 v[124:127], v3, s[12:15], s40 offen offset:2048
  s_waitcnt vmcnt(28)
  v_mfma_f32_32x32x16_bf16 v[16:31], v[128:131], v[136:139], v[16:31]
  v_mfma_f32_32x32x16_bf16 v[32:47], v[128:131], v[140:143], v[32:47]
  v_mfma_f32_32x32x16_bf16 v[48:63], v[132:135], v[136:139], v[48:63]
  v_mfma_f32_32x32x16_bf16 v[64:79], v[132:135], v[140:143], v[64:79]
  buffer_load_dwordx4 v[128:131], v3, s[8:11], s37 offen offset:3072
  buffer_load_dwordx4 v[132:135], v3, s[8:11], s38 offen offset:3072
  buffer_load_dwordx4 v[136:139], v3, s[12:15], s39 offen offset:3072
  buffer_load_dwordx4 v[140:143], v3, s[12:15], s40 offen offset:3072
  s_add_u32 s37, s37, 4096
  s_add_u32 s38, s38, 4096
  s_add_u32 s39, s39, 4096
  s_add_u32 s40, s40, 4096
  s_waitcnt vmcnt(28)
  v_mfma_f32_32x32x16_bf16 v[16:31], v[144:147], v[152:155], v[16:31]
  v_mfma_f32_32x32x16_bf16 v[32:47], v[144:147], v[156:159], v[32:47]
  v_mfma_f32_32x32x16_bf16 v[48:63], v[148:151], v[152:155], v[48:63]
  v_mfma_f32_32x32x16_bf16 v[64:79], v[148:151], v[156:159], v[64:79]
  buffer_load_dwordx4 v[208:211], v7, s[28:31], s44 offen
  buffer_load_dwordx4 v[212:215], v7, s[28:31], s44 offen offset:32
  buffer_load_dwordx4 v[216:219], v6, s[24:27], s43 offen
  buffer_load_dwordx4 v[220:223], v6, s[24:27], s43 offen offset:32
  s_waitcnt vmcnt(28)
  v_mfma_f32_32x32x16_bf16 v[16:31], v[160:163], v[168:171], v[16:31]
  v_mfma_f32_32x32x16_bf16 v[32:47], v[160:163], v[172:175], v[32:47]
  v_mfma_f32_32x32x16_bf16 v[48:63], v[164:167], v[168:171], v[48:63]
  v_mfma_f32_32x32x16_bf16 v[64:79], v[164:167], v[172:175], v[64:79]
  s_waitcnt vmcnt(24)
  v_mfma_f32_32x32x16_bf16 v[16:31], v[176:179], v[184:187], v[16:31]
  v_mfma_f32_32x32x16_bf16 v[32:47], v[176:179], v[188:191], v[32:47]
  v_mfma_f32_32x32x16_bf16 v[48:63], v[180:183], v[184:187], v[48:63]
  v_mfma_f32_32x32x16_bf16 v[64:79], v[180:183], v[188:191], v[64:79]
  s_waitcnt vmcnt(20)
  v_mfma_f32_32x32x16_bf16 v[16:31], v[192:195], v[200:203], v[16:31]
  v_mfma_f32_32x32x16_bf16 v[32:47], v[192:195], v[204:207], v[32:47]
  v_mfma_f32_32x32x16_bf16 v[48:63], v[196:199], v[200:203], v[48:63]
  v_mfma_f32_32x32x16_bf16 v[64:79], v[196:199], v[204:207], v[64:79]
  s_waitcnt vmcnt(16)
  v_mfma_f32_32x32x16_bf16 v[16:31], v[80:83], v[88:91], v[16:31]
  v_mfma_f32_32x32x16_bf16 v[32:47], v[80:83], v[92:95], v[32:47]
  v_mfma_f32_32x32x16_bf16 v[48:63], v[84:87], v[88:91], v[48:63]
  v_mfma_f32_32x32x16_bf16 v[64:79], v[84:87], v[92:95], v[64:79]
  s_waitcnt vmcnt(12)
  v_mfma_f32_32x32x16_bf16 v[16:31], v[96:99], v[104:107], v[16:31]
  v_mfma_f32_32x32x16_bf16 v[32:47], v[96:99], v[108:111], v[32:47]
  v_mfma_f32_32x32x16_bf16 v[48:63], v[100:103], v[104:107], v[48:63]
  v_mfma_f32_32x32x16_bf16 v[64:79], v[100:103], v[108:111], v[64:79]
  s_waitcnt vmcnt(8)
  v_mfma_f32_32x32x16_bf16 v[16:31], v[112:115], v[120:123], v[16:31]
  v_mfma_f32_32x32x16_bf16 v[32:47], v[112:115], v[124:127], v[32:47]
  v_mfma_f32_32x32x16_bf16 v[48:63], v[116:119], v[120:123], v[48:63]
  v_mfma_f32_32x32x16_bf16 v[64:79], v[116:119], v[124:127], v[64:79]
  s_waitcnt vmcnt(4)
  v_mfma_f32_32x32x16_bf16 v[16:31], v[128:131], v[136:139], v[16:31]
  v_mfma_f32_32x32x16_bf16 v[32:47], v[128:131], v[140:143], v[32:47]
  v_mfma_f32_32x32x16_bf16 v[48:63], v[132:135], v[136:139], v[48:63]
  v_mfma_f32_32x32x16_bf16 v[64:79], v[132:135], v[140:143], v[64:79]
  s_lshl_b32 s45, s3, 14
  v_add_u32 v8, s45, v3
  s_lshl_b32 s45, s3, 12
  v_add_u32 v9, s45, v3
  s_nop 7
  s_nop 3
  ds_write_b128 v8, v[16:19] offset:0
  ds_write_b128 v8, v[20:23] offset:1024
  ds_write_b128 v8, v[24:27] offset:2048
  ds_write_b128 v8, v[28:31] offset:3072
  ds_write_b128 v8, v[32:35] offset:4096
  ds_write_b128 v8, v[36:39] offset:5120
  ds_write_b128 v8, v[40:43] offset:6144
  ds_write_b128 v8, v[44:47] offset:7168
  ds_write_b128 v8, v[48:51] offset:8192
  ds_write_b128 v8, v[52:55] offset:9216
  ds_write_b128 v8, v[56:59] offset:10240
  ds_write_b128 v8, v[60:63] offset:11264
  ds_write_b128 v8, v[64:67] offset:12288
  ds_write_b128 v8, v[68:71] offset:13312
  ds_write_b128 v8, v[72:75] offset:14336
  ds_write_b128 v8, v[76:79] offset:15360
  s_waitcnt lgkmcnt(0)
  s_barrier
  ds_read_b128 v[80:83], v9 offset:0
  ds_read_b128 v[84:87], v9 offset:1024
  ds_read_b128 v[88:91], v9 offset:2048
  ds_read_b128 v[92:95], v9 offset:3072
  ds_read_b128 v[96:99], v9 offset:16384
  ds_read_b128 v[100:103], v9 offset:17408
  ds_read_b128 v[104:107], v9 offset:18432
  ds_read_b128 v[108:111], v9 offset:19456
  ds_read_b128 v[112:115], v9 offset:32768
  ds_read_b128 v[116:119], v9 offset:33792
  ds_read_b128 v[120:123], v9 offset:34816
  ds_read_b128 v[124:127], v9 offset:35840
  ds_read_b128 v[128:131], v9 offset:49152
  ds_read_b128 v[132:135], v9 offset:50176
  ds_read_b128 v[136:139], v9 offset:51200
  ds_read_b128 v[140:143], v9 offset:52224
  s_waitcnt lgkmcnt(0)
  v_pk_add_f32 v[80:81], v[80:81], v[96:97]
  v_pk_add_f32 v[112:113], v[112:113], v[128:129]
  v_pk_add_f32 v[82:83], v[82:83], v[98:99]
  v_pk_add_f32 v[114:115], v[114:115], v[130:131]
  v_pk_add_f32 v[84:85], v[84:85], v[100:101]
  v_pk_add_f32 v[116:117], v[116:117], v[132:133]
  v_pk_add_f32 v[86:87], v[86:87], v[102:103]
  v_pk_add_f32 v[118:119], v[118:119], v[134:135]
  v_pk_add_f32 v[88:89], v[88:89], v[104:105]
  v_pk_add_f32 v[120:121], v[120:121], v[136:137]
  v_pk_add_f32 v[90:91], v[90:91], v[106:107]
  v_pk_add_f32 v[122:123], v[122:123], v[138:139]
  v_pk_add_f32 v[92:93], v[92:93], v[108:109]
  v_pk_add_f32 v[124:125], v[124:125], v[140:141]
  v_pk_add_f32 v[94:95], v[94:95], v[110:111]
  v_pk_add_f32 v[126:127], v[126:127], v[142:143]
  v_pk_add_f32 v[80:81], v[80:81], v[112:113]
  v_pk_add_f32 v[82:83], v[82:83], v[114:115]
  v_pk_add_f32 v[84:85], v[84:85], v[116:117]
  v_pk_add_f32 v[86:87], v[86:87], v[118:119]
  v_pk_add_f32 v[88:89], v[88:89], v[120:121]
  v_pk_add_f32 v[90:91], v[90:91], v[122:123]
  v_pk_add_f32 v[92:93], v[92:93], v[124:125]
  v_pk_add_f32 v[94:95], v[94:95], v[126:127]
  s_waitcnt vmcnt(0)
  v_cvt_pk_bf16_f32 v16, v80, v81
  v_lshlrev_b32 v80, 16, v16
  v_and_b32 v81, 0xffff0000, v16
  v_lshlrev_b32 v18, 16, v216
  v_and_b32 v19, 0xffff0000, v216
  v_pk_add_f32 v[80:81], v[80:81], v[18:19]
  v_cvt_pk_bf16_f32 v16, v80, v81
  v_lshlrev_b32 v80, 16, v16
  v_and_b32 v81, 0xffff0000, v16
  v_lshlrev_b32 v18, 16, v208
  v_and_b32 v19, 0xffff0000, v208
  v_pk_add_f32 v[80:81], v[80:81], v[18:19]
  v_cvt_pk_bf16_f32 v24, v80, v81
  v_cvt_pk_bf16_f32 v16, v82, v83
  v_lshlrev_b32 v82, 16, v16
  v_and_b32 v83, 0xffff0000, v16
  v_lshlrev_b32 v18, 16, v217
  v_and_b32 v19, 0xffff0000, v217
  v_pk_add_f32 v[82:83], v[82:83], v[18:19]
  v_cvt_pk_bf16_f32 v16, v82, v83
  v_lshlrev_b32 v82, 16, v16
  v_and_b32 v83, 0xffff0000, v16
  v_lshlrev_b32 v18, 16, v209
  v_and_b32 v19, 0xffff0000, v209
  v_pk_add_f32 v[82:83], v[82:83], v[18:19]
  v_cvt_pk_bf16_f32 v25, v82, v83
  v_cvt_pk_bf16_f32 v16, v84, v85
  v_lshlrev_b32 v84, 16, v16
  v_and_b32 v85, 0xffff0000, v16
  v_lshlrev_b32 v18, 16, v218
  v_and_b32 v19, 0xffff0000, v218
  v_pk_add_f32 v[84:85], v[84:85], v[18:19]
  v_cvt_pk_bf16_f32 v16, v84, v85
  v_lshlrev_b32 v84, 16, v16
  v_and_b32 v85, 0xffff0000, v16
  v_lshlrev_b32 v18, 16, v210
  v_and_b32 v19, 0xffff0000, v210
  v_pk_add_f32 v[84:85], v[84:85], v[18:19]
  v_cvt_pk_bf16_f32 v26, v84, v85
  v_cvt_pk_bf16_f32 v16, v86, v87
  v_lshlrev_b32 v86, 16, v16
  v_and_b32 v87, 0xffff0000, v16
  v_lshlrev_b32 v18, 16, v219
  v_and_b32 v19, 0xffff0000, v219
  v_pk_add_f32 v[86:87], v[86:87], v[18:19]
  v_cvt_pk_bf16_f32 v16, v86, v87
  v_lshlrev_b32 v86, 16, v16
  v_and_b32 v87, 0xffff0000, v16
  v_lshlrev_b32 v18, 16, v211
  v_and_b32 v19, 0xffff0000, v211
  v_pk_add_f32 v[86:87], v[86:87], v[18:19]
  v_cvt_pk_bf16_f32 v27, v86, v87
  v_cvt_pk_bf16_f32 v16, v88, v89
  v_lshlrev_b32 v88, 16, v16
  v_and_b32 v89, 0xffff0000, v16
  v_lshlrev_b32 v18, 16, v220
  v_and_b32 v19, 0xffff0000, v220
  v_pk_add_f32 v[88:89], v[88:89], v[18:19]
  v_cvt_pk_bf16_f32 v16, v88, v89
  v_lshlrev_b32 v88, 16, v16
  v_and_b32 v89, 0xffff0000, v16
  v_lshlrev_b32 v18, 16, v212
  v_and_b32 v19, 0xffff0000, v212
  v_pk_add_f32 v[88:89], v[88:89], v[18:19]
  v_cvt_pk_bf16_f32 v28, v88, v89
  v_cvt_pk_bf16_f32 v16, v90, v91
  v_lshlrev_b32 v90, 16, v16
  v_and_b32 v91, 0xffff0000, v16
  v_lshlrev_b32 v18, 16, v221
  v_and_b32 v19, 0xffff0000, v221
  v_pk_add_f32 v[90:91], v[90:91], v[18:19]
  v_cvt_pk_bf16_f32 v16, v90, v91
  v_lshlrev_b32 v90, 16, v16
  v_and_b32 v91, 0xffff0000, v16
  v_lshlrev_b32 v18, 16, v213
  v_and_b32 v19, 0xffff0000, v213
  v_pk_add_f32 v[90:91], v[90:91], v[18:19]
  v_cvt_pk_bf16_f32 v29, v90, v91
  v_cvt_pk_bf16_f32 v16, v92, v93
  v_lshlrev_b32 v92, 16, v16
  v_and_b32 v93, 0xffff0000, v16
  v_lshlrev_b32 v18, 16, v222
  v_and_b32 v19, 0xffff0000, v222
  v_pk_add_f32 v[92:93], v[92:93], v[18:19]
  v_cvt_pk_bf16_f32 v16, v92, v93
  v_lshlrev_b32 v92, 16, v16
  v_and_b32 v93, 0xffff0000, v16
  v_lshlrev_b32 v18, 16, v214
  v_and_b32 v19, 0xffff0000, v214
  v_pk_add_f32 v[92:93], v[92:93], v[18:19]
  v_cvt_pk_bf16_f32 v30, v92, v93
  v_cvt_pk_bf16_f32 v16, v94, v95
  v_lshlrev_b32 v94, 16, v16
  v_and_b32 v95, 0xffff0000, v16
  v_lshlrev_b32 v18, 16, v223
  v_and_b32 v19, 0xffff0000, v223
  v_pk_add_f32 v[94:95], v[94:95], v[18:19]
  v_cvt_pk_bf16_f32 v16, v94, v95
  v_lshlrev_b32 v94, 16, v16
  v_and_b32 v95, 0xffff0000, v16
  v_lshlrev_b32 v18, 16, v215
  v_and_b32 v19, 0xffff0000, v215
  v_pk_add_f32 v[94:95], v[94:95], v[18:19]
  v_cvt_pk_bf16_f32 v31, v94, v95
  buffer_store_dwordx4 v[24:27], v7, s[32:35], s44 offen sc1
  buffer_store_dwordx4 v[28:31], v7, s[32:35], s44 offen offset:32 sc1
L_c0_kernel_g2_end_1:
  s_branch L_c0_kernel_g2d_8
L_c0_kernel_g2s_9:
  s_barrier
  s_barrier
L_c0_kernel_g2d_8:
  s_waitcnt vmcnt(0) lgkmcnt(0)
  s_barrier
  s_cmp_lg_u32 s93, 0
  s_cbranch_scc1 L_c0_kernel_pub_10
  s_lshl_b32 s18, s16, 5
  s_lshl_b32 s19, s17, 2
  s_add_u32 s18, s18, s19
  s_add_u32 s18, s18, 2048
  v_mov_b32 v1, 1
  v_mov_b32 v2, 0
  s_mov_b64 exec, 1
  buffer_store_dword v1, v2, s[84:87], s18 offen sc1
  s_mov_b64 exec, -1
L_c0_kernel_pub_10:
  v_mov_b32 v0, v255
  s_mov_b32 s2, s95
  s_mov_b32 s3, s93
  s_cmp_ge_u32 s2, 128
  s_cbranch_scc1 L_c0_kernel_end_1
  s_cmp_lg_u32 s93, 0
  s_cbranch_scc1 L_c0_kernel_hs_11
  s_lshr_b32 s50, s95, 3
  s_lshl_b32 s50, s50, 5
  s_add_u32 s50, s50, 2048
  v_and_b32 v8, 7, v0
  v_lshlrev_b32 v8, 2, v8
  v_bfe_u32 v9, v0, 3, 1
  v_lshl_add_u32 v8, v9, 9, v8
  s_mov_b32 s51, 0
  s_mov_b32 exec_lo, 0xffff
  s_mov_b32 exec_hi, 0
L_c0_kernel_hl_12:
  buffer_load_dword v9, v8, s[84:87], s50 offen sc1
  s_add_u32 s51, s51, 1
  s_waitcnt vmcnt(0)
  v_cmp_ne_u32 vcc, 1, v9
  s_cmp_ge_u32 s51, 400000
  s_cbranch_scc1 L_c0_kernel_ho_13
  s_cbranch_vccz L_c0_kernel_ho_13
  s_sleep 6
  s_branch L_c0_kernel_hl_12
L_c0_kernel_ho_13:
  s_mov_b64 exec, -1
L_c0_kernel_hs_11:
  s_barrier
  s_load_dwordx2 s[6:7], s[0:1], 80
  v_lshrrev_b32 v2, 6, v0
  v_and_b32 v1, 63, v0
  v_readfirstlane_b32 s3, v2
  v_mov_b32 v16, 0
  v_mov_b32 v17, 0
  v_mov_b32 v18, 0
  v_mov_b32 v19, 0
  v_mov_b32 v20, 0
  v_mov_b32 v21, 0
  v_mov_b32 v22, 0
  v_mov_b32 v23, 0
  v_mov_b32 v24, 0
  v_mov_b32 v25, 0
  v_mov_b32 v26, 0
  v_mov_b32 v27, 0
  v_mov_b32 v28, 0
  v_mov_b32 v29, 0
  v_mov_b32 v30, 0
  v_mov_b32 v31, 0
  s_mov_b32 s20, 0x3f3504f3
  s_mov_b32 s21, 0x3f3504f3
  s_mov_b32 s22, 0xbf3504f3
  s_mov_b32 s23, 0xbf3504f3
  s_waitcnt lgkmcnt(0)
  s_add_u32 s8, s6, 12582912
  s_addc_u32 s9, s7, 0
  s_mov_b32 s10, 2097152
  s_mov_b32 s11, 0x00020000
  s_mov_b32 s12, s6
  s_mov_b32 s13, s7
  s_mov_b32 s14, 4194304
  s_mov_b32 s15, 0x00020000
  s_lshl_b32 s16, s2, 3
  s_add_u32 s16, s16, s3
  s_lshl_b32 s16, s16, 10
  s_add_u32 s17, s16, 1048576
  v_lshlrev_b32 v3, 1, v1
  buffer_load_short_d16_hi v16, v3, s[8:11], s16 offen offset:0
  buffer_load_short_d16_hi v17, v3, s[8:11], s17 offen offset:0
  buffer_load_short_d16_hi v18, v3, s[8:11], s16 offen offset:128
  buffer_load_short_d16_hi v19, v3, s[8:11], s17 offen offset:128
  buffer_load_short_d16_hi v20, v3, s[8:11], s16 offen offset:256
  buffer_load_short_d16_hi v21, v3, s[8:11], s17 offen offset:256
  buffer_load_short_d16_hi v22, v3, s[8:11], s16 offen offset:384
  buffer_load_short_d16_hi v23, v3, s[8:11], s17 offen offset:384
  buffer_load_short_d16_hi v24, v3, s[8:11], s16 offen offset:512
  buffer_load_short_d16_hi v25, v3, s[8:11], s17 offen offset:512
  buffer_load_short_d16_hi v26, v3, s[8:11], s16 offen offset:640
  buffer_load_short_d16_hi v27, v3, s[8:11], s17 offen offset:640
  buffer_load_short_d16_hi v28, v3, s[8:11], s16 offen offset:768
  buffer_load_short_d16_hi v29, v3, s[8:11], s17 offen offset:768
  buffer_load_short_d16_hi v30, v3, s[8:11], s16 offen offset:896
  buffer_load_short_d16_hi v31, v3, s[8:11], s17 offen offset:896
  v_cvt_f32_u32 v4, v1
  v_and_b32 v5, 7, v1
  v_cvt_f32_u32 v5, v5
  v_mul_f32 v6, 0x3b000000, v4
  v_cos_f32 v48, v6
  v_sin_f32 v49, v6
  v_mul_f32 v6, 0x3b800000, v4
  v_cos_f32 v50, v6
  v_sin_f32 v51, v6
  v_mul_f32 v6, 0x3bc00000, v4
  v_cos_f32 v52, v6
  v_sin_f32 v53, v6
  v_mul_f32 v6, 0x3c000000, v4
  v_cos_f32 v54, v6
  v_sin_f32 v55, v6
  v_mul_f32 v6, 0x3c200000, v4
  v_cos_f32 v56, v6
  v_sin_f32 v57, v6
  v_mul_f32 v6, 0x3c400000, v4
  v_cos_f32 v58, v6
  v_sin_f32 v59, v6
  v_mul_f32 v6, 0x3c600000, v4
  v_cos_f32 v60, v6
  v_sin_f32 v61, v6
  v_mul_f32 v6, 0x3c800000, v5
  v_cos_f32 v62, v6
  v_sin_f32 v63, v6
  v_mul_f32 v6, 0x3d000000, v5
  v_cos_f32 v64, v6
  v_sin_f32 v65, v6
  v_mul_f32 v6, 0x3d400000, v5
  v_cos_f32 v66, v6
  v_sin_f32 v67, v6
  v_mul_f32 v6, 0x3d800000, v5
  v_cos_f32 v68, v6
  v_sin_f32 v69, v6
  v_mul_f32 v6, 0x3da00000, v5
  v_cos_f32 v70, v6
  v_sin_f32 v71, v6
  v_mul_f32 v6, 0x3dc00000, v5
  v_cos_f32 v72, v6
  v_sin_f32 v73, v6
  v_mul_f32 v6, 0x3de00000, v5
  v_cos_f32 v74, v6
  v_sin_f32 v75, v6
  s_lshl_b32 s18, s3, 12
  v_lshlrev_b32 v6, 3, v1
  v_add_u32 v6, s18, v6
  v_lshrrev_b32 v7, 3, v1
  v_lshl_add_u32 v8, v7, 9, v6
  v_and_b32 v9, 7, v1
  v_xor_b32 v9, s3, v9
  v_lshlrev_b32 v9, 3, v9
  v_lshl_add_u32 v9, v7, 6, v9
  v_add_u32 v9, s18, v9
  v_add_u32 v9, 0x8000, v9
  v_and_b32 v10, 7, v1
  v_mul_u32_u24 v10, 4104, v10
  v_lshl_add_u32 v10, v7, 6, v10
  s_lshl_b32 s19, s3, 9
  s_add_u32 s19, s19, 0x8000
  v_add_u32 v10, s19, v10
  v_and_b32 v11, 7, v1
  v_lshlrev_b32 v11, 3, v11
  v_lshl_add_u32 v11, v7, 13, v11
  s_lshl_b32 s24, s3, 16
  s_lshl_b32 s25, s2, 6
  s_add_u32 s24, s24, s25
  s_waitcnt vmcnt(0)
  v_pk_add_f32 v[32:33], v[16:17], v[18:19]
  v_pk_add_f32 v[34:35], v[20:21], v[22:23]
  v_pk_add_f32 v[36:37], v[24:25], v[26:27]
  v_pk_add_f32 v[38:39], v[28:29], v[30:31]
  v_pk_add_f32 v[32:33], v[32:33], v[34:35]
  v_pk_add_f32 v[36:37], v[36:37], v[38:39]
  v_pk_add_f32 v[32:33], v[32:33], v[36:37]
  s_nop 1
  v_add_f32_dpp v32, v32, v32 row_shr:1 row_mask:0xf bank_mask:0xf bound_ctrl:0
  v_add_f32_dpp v33, v33, v33 row_shr:1 row_mask:0xf bank_mask:0xf bound_ctrl:0
  s_nop 0
  v_add_f32_dpp v32, v32, v32 row_shr:2 row_mask:0xf bank_mask:0xf bound_ctrl:0
  v_add_f32_dpp v33, v33, v33 row_shr:2 row_mask:0xf bank_mask:0xf bound_ctrl:0
  s_nop 0
  v_add_f32_dpp v32, v32, v32 row_shr:4 row_mask:0xf bank_mask:0xf bound_ctrl:0
  v_add_f32_dpp v33, v33, v33 row_shr:4 row_mask:0xf bank_mask:0xf bound_ctrl:0
  s_nop 0
  v_add_f32_dpp v32, v32, v32 row_shr:8 row_mask:0xf bank_mask:0xf bound_ctrl:0
  v_add_f32_dpp v33, v33, v33 row_shr:8 row_mask:0xf bank_mask:0xf bound_ctrl:0
  s_nop 0
  v_add_f32_dpp v32, v32, v32 row_bcast:15 row_mask:0xa bank_mask:0xf
  v_add_f32_dpp v33, v33, v33 row_bcast:15 row_mask:0xa bank_mask:0xf
  s_nop 0
  v_add_f32_dpp v32, v32, v32 row_bcast:31 row_mask:0xc bank_mask:0xf
  v_add_f32_dpp v33, v33, v33 row_bcast:31 row_mask:0xc bank_mask:0xf
  s_nop 0
  v_mul_f32 v32, 0x3b000000, v32
  v_mul_f32 v33, 0x3b000000, v33
  v_cvt_pk_bf16_f32 v34, v32, v33
  v_and_b32 v35, 0xffff0000, v34
  v_lshlrev_b32 v34, 16, v34
  v_readlane_b32 s26, v32, 63
  v_readlane_b32 s27, v33, 63
  v_readlane_b32 s28, v34, 63
  v_readlane_b32 s29, v35, 63
  s_nop 1
  v_pk_add_f32 v[32:33], v[16:17], s[26:27] neg_lo:[0,1] neg_hi:[0,1]
  v_pk_add_f32 v[34:35], v[18:19], s[26:27] neg_lo:[0,1] neg_hi:[0,1]
  v_pk_add_f32 v[36:37], v[20:21], s[26:27] neg_lo:[0,1] neg_hi:[0,1]
  v_pk_add_f32 v[38:39], v[22:23], s[26:27] neg_lo:[0,1] neg_hi:[0,1]
  v_pk_add_f32 v[40:41], v[24:25], s[26:27] neg_lo:[0,1] neg_hi:[0,1]
  v_pk_add_f32 v[42:43], v[26:27], s[26:27] neg_lo:[0,1] neg_hi:[0,1]
  v_pk_add_f32 v[44:45], v[28:29], s[26:27] neg_lo:[0,1] neg_hi:[0,1]
  v_pk_add_f32 v[46:47], v[30:31], s[26:27] neg_lo:[0,1] neg_hi:[0,1]
  v_pk_mul_f32 v[32:33], v[32:33], v[32:33]
  v_pk_mul_f32 v[34:35], v[34:35], v[34:35]
  v_pk_fma_f32 v[32:33], v[36:37], v[36:37], v[32:33]
  v_pk_fma_f32 v[34:35], v[38:39], v[38:39], v[34:35]
  v_pk_fma_f32 v[32:33], v[40:41], v[40:41], v[32:33]
  v_pk_fma_f32 v[34:35], v[42:43], v[42:43], v[34:35]
  v_pk_fma_f32 v[32:33], v[44:45], v[44:45], v[32:33]
  v_pk_fma_f32 v[34:35], v[46:47], v[46:47], v[34:35]
  v_pk_add_f32 v[32:33], v[32:33], v[34:35]
  s_nop 1
  v_add_f32_dpp v32, v32, v32 row_shr:1 row_mask:0xf bank_mask:0xf bound_ctrl:0
  v_add_f32_dpp v33, v33, v33 row_shr:1 row_mask:0xf bank_mask:0xf bound_ctrl:0
  s_nop 0
  v_add_f32_dpp v32, v32, v32 row_shr:2 row_mask:0xf bank_mask:0xf bound_ctrl:0
  v_add_f32_dpp v33, v33, v33 row_shr:2 row_mask:0xf bank_mask:0xf bound_ctrl:0
  s_nop 0
  v_add_f32_dpp v32, v32, v32 row_shr:4 row_mask:0xf bank_mask:0xf bound_ctrl:0
  v_add_f32_dpp v33, v33, v33 row_shr:4 row_mask:0xf bank_mask:0xf bound_ctrl:0
  s_nop 0
  v_add_f32_dpp v32, v32, v32 row_shr:8 row_mask:0xf bank_mask:0xf bound_ctrl:0
  v_add_f32_dpp v33, v33, v33 row_shr:8 row_mask:0xf bank_mask:0xf bound_ctrl:0
  s_nop 0
  v_add_f32_dpp v32, v32, v32 row_bcast:15 row_mask:0xa bank_mask:0xf
  v_add_f32_dpp v33, v33, v33 row_bcast:15 row_mask:0xa bank_mask:0xf
  s_nop 0
  v_add_f32_dpp v32, v32, v32 row_bcast:31 row_mask:0xc bank_mask:0xf
  v_add_f32_dpp v33, v33, v33 row_bcast:31 row_mask:0xc bank_mask:0xf
  s_nop 0
  v_mul_f32 v32, 0x3b000000, v32
  v_mul_f32 v33, 0x3b000000, v33
  v_cvt_pk_bf16_f32 v34, v32, v33
  v_lshlrev_b32 v32, 16, v34
  v_and_b32 v33, 0xffff0000, v34
  v_add_f32 v32, 0x3727c5ac, v32
  v_add_f32 v33, 0x3727c5ac, v33
  v_cvt_pk_bf16_f32 v34, v32, v33
  v_lshlrev_b32 v32, 16, v34
  v_and_b32 v33, 0xffff0000, v34
  v_sqrt_f32 v32, v32
  v_sqrt_f32 v33, v33
  s_nop 0
  v_cvt_pk_bf16_f32 v34, v32, v33
  v_lshlrev_b32 v32, 16, v34
  v_and_b32 v33, 0xffff0000, v34
  v_rcp_f32 v32, v32
  v_rcp_f32 v33, v33
  s_nop 1
  v_readlane_b32 s30, v32, 63
  v_readlane_b32 s31, v33, 63
  v_pk_add_f32 v[16:17], v[16:17], s[28:29] neg_lo:[0,1] neg_hi:[0,1]
  v_cvt_pk_bf16_f32 v36, v16, v17
  v_lshlrev_b32 v16, 16, v36
  v_and_b32 v17, 0xffff0000, v36
  v_pk_add_f32 v[18:19], v[18:19], s[28:29] neg_lo:[0,1] neg_hi:[0,1]
  v_cvt_pk_bf16_f32 v38, v18, v19
  v_lshlrev_b32 v18, 16, v38
  v_and_b32 v19, 0xffff0000, v38
  v_pk_add_f32 v[20:21], v[20:21], s[28:29] neg_lo:[0,1] neg_hi:[0,1]
  v_cvt_pk_bf16_f32 v36, v20, v21
  v_lshlrev_b32 v20, 16, v36
  v_and_b32 v21, 0xffff0000, v36
  v_pk_add_f32 v[22:23], v[22:23], s[28:29] neg_lo:[0,1] neg_hi:[0,1]
  v_cvt_pk_bf16_f32 v38, v22, v23
  v_lshlrev_b32 v22, 16, v38
  v_and_b32 v23, 0xffff0000, v38
  v_pk_add_f32 v[24:25], v[24:25], s[28:29] neg_lo:[0,1] neg_hi:[0,1]
  v_cvt_pk_bf16_f32 v36, v24, v25
  v_lshlrev_b32 v24, 16, v36
  v_and_b32 v25, 0xffff0000, v36
  v_pk_add_f32 v[26:27], v[26:27], s[28:29] neg_lo:[0,1] neg_hi:[0,1]
  v_cvt_pk_bf16_f32 v38, v26, v27
  v_lshlrev_b32 v26, 16, v38
  v_and_b32 v27, 0xffff0000, v38
  v_pk_add_f32 v[28:29], v[28:29], s[28:29] neg_lo:[0,1] neg_hi:[0,1]
  v_cvt_pk_bf16_f32 v36, v28, v29
  v_lshlrev_b32 v28, 16, v36
  v_and_b32 v29, 0xffff0000, v36
  v_pk_add_f32 v[30:31], v[30:31], s[28:29] neg_lo:[0,1] neg_hi:[0,1]
  v_cvt_pk_bf16_f32 v38, v30, v31
  v_lshlrev_b32 v30, 16, v38
  v_and_b32 v31, 0xffff0000, v38
  v_pk_mul_f32 v[16:17], v[16:17], s[30:31]
  v_pk_mul_f32 v[18:19], v[18:19], s[30:31]
  v_pk_mul_f32 v[20:21], v[20:21], s[30:31]
  v_pk_mul_f32 v[22:23], v[22:23], s[30:31]
  v_pk_mul_f32 v[24:25], v[24:25], s[30:31]
  v_pk_mul_f32 v[26:27], v[26:27], s[30:31]
  v_pk_mul_f32 v[28:29], v[28:29], s[30:31]
  v_pk_mul_f32 v[30:31], v[30:31], s[30:31]
  v_cvt_pk_bf16_f32 v32, v16, v17
  v_lshlrev_b32 v16, 16, v32
  v_and_b32 v17, 0xffff0000, v32
  v_cvt_pk_bf16_f32 v34, v18, v19
  v_lshlrev_b32 v18, 16, v34
  v_and_b32 v19, 0xffff0000, v34
  v_cvt_pk_bf16_f32 v36, v20, v21
  v_lshlrev_b32 v20, 16, v36
  v_and_b32 v21, 0xffff0000, v36
  v_cvt_pk_bf16_f32 v38, v22, v23
  v_lshlrev_b32 v22, 16, v38
  v_and_b32 v23, 0xffff0000, v38
  v_cvt_pk_bf16_f32 v40, v24, v25
  v_lshlrev_b32 v24, 16, v40
  v_and_b32 v25, 0xffff0000, v40
  v_cvt_pk_bf16_f32 v42, v26, v27
  v_lshlrev_b32 v26, 16, v42
  v_and_b32 v27, 0xffff0000, v42
  v_cvt_pk_bf16_f32 v44, v28, v29
  v_lshlrev_b32 v28, 16, v44
  v_and_b32 v29, 0xffff0000, v44
  v_cvt_pk_bf16_f32 v46, v30, v31
  v_lshlrev_b32 v30, 16, v46
  v_and_b32 v31, 0xffff0000, v46
  v_pk_add_f32 v[32:33], v[16:17], v[24:25]
  v_pk_add_f32 v[40:41], v[16:17], v[24:25] neg_lo:[0,1] neg_hi:[0,1]
  v_pk_add_f32 v[34:35], v[18:19], v[26:27]
  v_pk_add_f32 v[42:43], v[18:19], v[26:27] neg_lo:[0,1] neg_hi:[0,1]
  v_pk_add_f32 v[36:37], v[20:21], v[28:29]
  v_pk_add_f32 v[44:45], v[20:21], v[28:29] neg_lo:[0,1] neg_hi:[0,1]
  v_pk_add_f32 v[38:39], v[22:23], v[30:31]
  v_pk_add_f32 v[46:47], v[22:23], v[30:31] neg_lo:[0,1] neg_hi:[0,1]
  v_pk_add_f32 v[26:27], v[42:43], v[42:43] op_sel:[0,1] op_sel_hi:[1,0] neg_hi:[0,1]
  v_pk_add_f32 v[30:31], v[46:47], v[46:47] op_sel:[0,1] op_sel_hi:[1,0] neg_lo:[0,1]
  v_pk_add_f32 v[16:17], v[32:33], v[36:37]
  v_pk_add_f32 v[18:19], v[32:33], v[36:37] neg_lo:[0,1] neg_hi:[0,1]
  v_pk_mul_f32 v[26:27], v[26:27], s[20:21]
  v_pk_mul_f32 v[30:31], v[30:31], s[22:23]
  v_pk_add_f32 v[20:21], v[34:35], v[38:39]
  v_pk_add_f32 v[22:23], v[34:35], v[38:39] neg_lo:[0,1] neg_hi:[0,1]
  v_pk_add_f32 v[24:25], v[40:41], v[44:45] op_sel:[0,1] op_sel_hi:[1,0] neg_hi:[0,1]
  v_pk_add_f32 v[28:29], v[40:41], v[44:45] op_sel:[0,1] op_sel_hi:[1,0] neg_lo:[0,1]
  v_pk_add_f32 v[42:43], v[26:27], v[30:31]
  v_pk_add_f32 v[46:47], v[26:27], v[30:31] neg_lo:[0,1] neg_hi:[0,1]
  v_pk_add_f32 v[32:33], v[16:17], v[20:21]
  v_pk_add_f32 v[36:37], v[16:17], v[20:21] neg_lo:[0,1] neg_hi:[0,1]
  v_pk_add_f32 v[34:35], v[18:19], v[22:23] op_sel:[0,1] op_sel_hi:[1,0] neg_hi:[0,1]
  v_pk_add_f32 v[38:39], v[18:19], v[22:23] op_sel:[0,1] op_sel_hi:[1,0] neg_lo:[0,1]
  v_pk_add_f32 v[40:41], v[24:25], v[42:43]
  v_pk_add_f32 v[44:45], v[24:25], v[42:43] neg_lo:[0,1] neg_hi:[0,1]
  v_pk_add_f32 v[26:27], v[28:29], v[46:47] op_sel:[0,1] op_sel_hi:[1,0] neg_hi:[0,1]
  v_pk_add_f32 v[30:31], v[28:29], v[46:47] op_sel:[0,1] op_sel_hi:[1,0] neg_lo:[0,1]
  v_pk_mul_f32 v[18:19], v[40:41], v[48:49] op_sel:[0,0] op_sel_hi:[1,0]
  v_pk_fma_f32 v[40:41], v[40:41], v[48:49], v[18:19] op_sel:[1,1,0] op_sel_hi:[0,1,1] neg_hi:[1,0,0]
  v_pk_mul_f32 v[16:17], v[34:35], v[50:51] op_sel:[0,0] op_sel_hi:[1,0]
  v_pk_fma_f32 v[34:35], v[34:35], v[50:51], v[16:17] op_sel:[1,1,0] op_sel_hi:[0,1,1] neg_hi:[1,0,0]
  v_pk_mul_f32 v[18:19], v[26:27], v[52:53] op_sel:[0,0] op_sel_hi:[1,0]
  v_pk_fma_f32 v[26:27], v[26:27], v[52:53], v[18:19] op_sel:[1,1,0] op_sel_hi:[0,1,1] neg_hi:[1,0,0]
  v_pk_mul_f32 v[16:17], v[36:37], v[54:55] op_sel:[0,0] op_sel_hi:[1,0]
  v_pk_fma_f32 v[36:37], v[36:37], v[54:55], v[16:17] op_sel:[1,1,0] op_sel_hi:[0,1,1] neg_hi:[1,0,0]
  v_pk_mul_f32 v[18:19], v[44:45], v[56:57] op_sel:[0,0] op_sel_hi:[1,0]
  v_pk_fma_f32 v[44:45], v[44:45], v[56:57], v[18:19] op_sel:[1,1,0] op_sel_hi:[0,1,1] neg_hi:[1,0,0]
  v_pk_mul_f32 v[16:17], v[38:39], v[58:59] op_sel:[0,0] op_sel_hi:[1,0]
  v_pk_fma_f32 v[38:39], v[38:39], v[58:59], v[16:17] op_sel:[1,1,0] op_sel_hi:[0,1,1] neg_hi:[1,0,0]
  v_pk_mul_f32 v[18:19], v[30:31], v[60:61] op_sel:[0,0] op_sel_hi:[1,0]
  v_pk_fma_f32 v[30:31], v[30:31], v[60:61], v[18:19] op_sel:[1,1,0] op_sel_hi:[0,1,1] neg_hi:[1,0,0]
  ds_write_b64 v6, v[32:33] offset:0
  v_xor_b32 v13, 64, v6
  ds_write_b64 v13, v[40:41] offset:512
  v_xor_b32 v12, 128, v6
  ds_write_b64 v12, v[34:35] offset:1024
  v_xor_b32 v13, 192, v6
  ds_write_b64 v13, v[26:27] offset:1536
  v_xor_b32 v12, 256, v6
  ds_write_b64 v12, v[36:37] offset:2048
  v_xor_b32 v13, 320, v6
  ds_write_b64 v13, v[44:45] offset:2560
  v_xor_b32 v12, 384, v6
  ds_write_b64 v12, v[38:39] offset:3072
  v_xor_b32 v13, 448, v6
  ds_write_b64 v13, v[30:31] offset:3584
  ds_read_b64 v[16:17], v8
  v_xor_b32 v13, 64, v8
  ds_read_b64 v[18:19], v13
  v_xor_b32 v12, 128, v8
  ds_read_b64 v[20:21], v12
  v_xor_b32 v13, 192, v8
  ds_read_b64 v[22:23], v13
  v_xor_b32 v12, 256, v8
  ds_read_b64 v[24:25], v12
  v_xor_b32 v13, 320, v8
  ds_read_b64 v[28:29], v13
  v_xor_b32 v12, 384, v8
  ds_read_b64 v[42:43], v12
  v_xor_b32 v13, 448, v8
  ds_read_b64 v[46:47], v13
  s_waitcnt lgkmcnt(0)
  v_pk_add_f32 v[32:33], v[16:17], v[24:25]
  v_pk_add_f32 v[36:37], v[16:17], v[24:25] neg_lo:[0,1] neg_hi:[0,1]
  v_pk_add_f32 v[40:41], v[18:19], v[28:29]
  v_pk_add_f32 v[44:45], v[18:19], v[28:29] neg_lo:[0,1] neg_hi:[0,1]
  v_pk_add_f32 v[34:35], v[20:21], v[42:43]
  v_pk_add_f32 v[38:39], v[20:21], v[42:43] neg_lo:[0,1] neg_hi:[0,1]
  v_pk_add_f32 v[26:27], v[22:23], v[46:47]
  v_pk_add_f32 v[30:31], v[22:23], v[46:47] neg_lo:[0,1] neg_hi:[0,1]
  v_pk_add_f32 v[28:29], v[44:45], v[44:45] op_sel:[0,1] op_sel_hi:[1,0] neg_hi:[0,1]
  v_pk_add_f32 v[46:47], v[30:31], v[30:31] op_sel:[0,1] op_sel_hi:[1,0] neg_lo:[0,1]
  v_pk_add_f32 v[16:17], v[32:33], v[34:35]
  v_pk_add_f32 v[18:19], v[32:33], v[34:35] neg_lo:[0,1] neg_hi:[0,1]
  v_pk_mul_f32 v[28:29], v[28:29], s[20:21]
  v_pk_mul_f32 v[46:47], v[46:47], s[22:23]
  v_pk_add_f32 v[20:21], v[40:41], v[26:27]
  v_pk_add_f32 v[22:23], v[40:41], v[26:27] neg_lo:[0,1] neg_hi:[0,1]
  v_pk_add_f32 v[24:25], v[36:37], v[38:39] op_sel:[0,1] op_sel_hi:[1,0] neg_hi:[0,1]
  v_pk_add_f32 v[42:43], v[36:37], v[38:39] op_sel:[0,1] op_sel_hi:[1,0] neg_lo:[0,1]
  v_pk_add_f32 v[44:45], v[28:29], v[46:47]
  v_pk_add_f32 v[30:31], v[28:29], v[46:47] neg_lo:[0,1] neg_hi:[0,1]
  v_pk_add_f32 v[32:33], v[16:17], v[20:21]
  v_pk_add_f32 v[34:35], v[16:17], v[20:21] neg_lo:[0,1] neg_hi:[0,1]
  v_pk_add_f32 v[40:41], v[18:19], v[22:23] op_sel:[0,1] op_sel_hi:[1,0] neg_hi:[0,1]
  v_pk_add_f32 v[26:27], v[18:19], v[22:23] op_sel:[0,1] op_sel_hi:[1,0] neg_lo:[0,1]
  v_pk_add_f32 v[36:37], v[24:25], v[44:45]
  v_pk_add_f32 v[38:39], v[24:25], v[44:45] neg_lo:[0,1] neg_hi:[0,1]
  v_pk_add_f32 v[28:29], v[42:43], v[30:31] op_sel:[0,1] op_sel_hi:[1,0] neg_hi:[0,1]
  v_pk_add_f32 v[46:47], v[42:43], v[30:31] op_sel:[0,1] op_sel_hi:[1,0] neg_lo:[0,1]
  v_pk_mul_f32 v[18:19], v[36:37], v[62:63] op_sel:[0,0] op_sel_hi:[1,0]
  v_pk_fma_f32 v[36:37], v[36:37], v[62:63], v[18:19] op_sel:[1,1,0] op_sel_hi:[0,1,1] neg_hi:[1,0,0]
  v_pk_mul_f32 v[16:17], v[40:41], v[64:65] op_sel:[0,0] op_sel_hi:[1,0]
  v_pk_fma_f32 v[40:41], v[40:41], v[64:65], v[16:17] op_sel:[1,1,0] op_sel_hi:[0,1,1] neg_hi:[1,0,0]
  v_pk_mul_f32 v[18:19], v[28:29], v[66:67] op_sel:[0,0] op_sel_hi:[1,0]
  v_pk_fma_f32 v[28:29], v[28:29], v[66:67], v[18:19] op_sel:[1,1,0] op_sel_hi:[0,1,1] neg_hi:[1,0,0]
  v_pk_mul_f32 v[16:17], v[34:35], v[68:69] op_sel:[0,0] op_sel_hi:[1,0]
  v_pk_fma_f32 v[34:35], v[34:35], v[68:69], v[16:17] op_sel:[1,1,0] op_sel_hi:[0,1,1] neg_hi:[1,0,0]
  v_pk_mul_f32 v[18:19], v[38:39], v[70:71] op_sel:[0,0] op_sel_hi:[1,0]
  v_pk_fma_f32 v[38:39], v[38:39], v[70:71], v[18:19] op_sel:[1,1,0] op_sel_hi:[0,1,1] neg_hi:[1,0,0]
  v_pk_mul_f32 v[16:17], v[26:27], v[72:73] op_sel:[0,0] op_sel_hi:[1,0]
  v_pk_fma_f32 v[26:27], v[26:27], v[72:73], v[16:17] op_sel:[1,1,0] op_sel_hi:[0,1,1] neg_hi:[1,0,0]
  v_pk_mul_f32 v[18:19], v[46:47], v[74:75] op_sel:[0,0] op_sel_hi:[1,0]
  v_pk_fma_f32 v[46:47], v[46:47], v[74:75], v[18:19] op_sel:[1,1,0] op_sel_hi:[0,1,1] neg_hi:[1,0,0]
  ds_write_b64 v9, v[32:33] offset:0
  ds_write_b64 v9, v[36:37] offset:512
  ds_write_b64 v9, v[40:41] offset:1024
  ds_write_b64 v9, v[28:29] offset:1536
  ds_write_b64 v9, v[34:35] offset:2048
  ds_write_b64 v9, v[38:39] offset:2560
  ds_write_b64 v9, v[26:27] offset:3072
  ds_write_b64 v9, v[46:47] offset:3584
  s_waitcnt lgkmcnt(0)
  s_barrier
  ds_read_b64 v[16:17], v10
  v_xor_b32 v13, 8, v10
  ds_read_b64 v[18:19], v13
  v_xor_b32 v12, 16, v10
  ds_read_b64 v[20:21], v12
  v_xor_b32 v13, 24, v10
  ds_read_b64 v[22:23], v13
  v_xor_b32 v12, 32, v10
  ds_read_b64 v[24:25], v12
  v_xor_b32 v13, 40, v10
  ds_read_b64 v[42:43], v13
  v_xor_b32 v12, 48, v10
  ds_read_b64 v[44:45], v12
  v_xor_b32 v13, 56, v10
  ds_read_b64 v[30:31], v13
  s_waitcnt lgkmcnt(0)
  v_pk_add_f32 v[32:33], v[16:17], v[24:25]
  v_pk_add_f32 v[34:35], v[16:17], v[24:25] neg_lo:[0,1] neg_hi:[0,1]
  v_pk_add_f32 v[36:37], v[18:19], v[42:43]
  v_pk_add_f32 v[38:39], v[18:19], v[42:43] neg_lo:[0,1] neg_hi:[0,1]
  v_pk_add_f32 v[40:41], v[20:21], v[44:45]
  v_pk_add_f32 v[26:27], v[20:21], v[44:45] neg_lo:[0,1] neg_hi:[0,1]
  v_pk_add_f32 v[28:29], v[22:23], v[30:31]
  v_pk_add_f32 v[46:47], v[22:23], v[30:31] neg_lo:[0,1] neg_hi:[0,1]
  v_pk_add_f32 v[42:43], v[38:39], v[38:39] op_sel:[0,1] op_sel_hi:[1,0] neg_hi:[0,1]
  v_pk_add_f32 v[30:31], v[46:47], v[46:47] op_sel:[0,1] op_sel_hi:[1,0] neg_lo:[0,1]
  v_pk_add_f32 v[16:17], v[32:33], v[40:41]
  v_pk_add_f32 v[18:19], v[32:33], v[40:41] neg_lo:[0,1] neg_hi:[0,1]
  v_pk_mul_f32 v[42:43], v[42:43], s[20:21]
  v_pk_mul_f32 v[30:31], v[30:31], s[22:23]
  v_pk_add_f32 v[20:21], v[36:37], v[28:29]
  v_pk_add_f32 v[22:23], v[36:37], v[28:29] neg_lo:[0,1] neg_hi:[0,1]
  v_pk_add_f32 v[24:25], v[34:35], v[26:27] op_sel:[0,1] op_sel_hi:[1,0] neg_hi:[0,1]
  v_pk_add_f32 v[44:45], v[34:35], v[26:27] op_sel:[0,1] op_sel_hi:[1,0] neg_lo:[0,1]
  v_pk_add_f32 v[38:39], v[42:43], v[30:31]
  v_pk_add_f32 v[46:47], v[42:43], v[30:31] neg_lo:[0,1] neg_hi:[0,1]
  v_pk_add_f32 v[32:33], v[16:17], v[20:21]
  v_pk_add_f32 v[40:41], v[16:17], v[20:21] neg_lo:[0,1] neg_hi:[0,1]
  v_pk_add_f32 v[36:37], v[18:19], v[22:23] op_sel:[0,1] op_sel_hi:[1,0] neg_hi:[0,1]
  v_pk_add_f32 v[28:29], v[18:19], v[22:23] op_sel:[0,1] op_sel_hi:[1,0] neg_lo:[0,1]
  v_pk_add_f32 v[34:35], v[24:25], v[38:39]
  v_pk_add_f32 v[26:27], v[24:25], v[38:39] neg_lo:[0,1] neg_hi:[0,1]
  v_pk_add_f32 v[42:43], v[44:45], v[46:47] op_sel:[0,1] op_sel_hi:[1,0] neg_hi:[0,1]
  v_pk_add_f32 v[30:31], v[44:45], v[46:47] op_sel:[0,1] op_sel_hi:[1,0] neg_lo:[0,1]
  buffer_store_dwordx2 v[32:33], v11, s[12:15], s24 offen
  s_add_u32 s24, s24, 524288
  buffer_store_dwordx2 v[34:35], v11, s[12:15], s24 offen
  s_add_u32 s24, s24, 524288
  buffer_store_dwordx2 v[36:37], v11, s[12:15], s24 offen
  s_add_u32 s24, s24, 524288
  buffer_store_dwordx2 v[42:43], v11, s[12:15], s24 offen
  s_add_u32 s24, s24, 524288
  buffer_store_dwordx2 v[40:41], v11, s[12:15], s24 offen
  s_add_u32 s24, s24, 524288
  buffer_store_dwordx2 v[26:27], v11, s[12:15], s24 offen
  s_add_u32 s24, s24, 524288
  buffer_store_dwordx2 v[28:29], v11, s[12:15], s24 offen
  s_add_u32 s24, s24, 524288
  buffer_store_dwordx2 v[30:31], v11, s[12:15], s24 offen
  s_branch L_c0_kernel_end_1
L_c0_kernel_p1_end_1:
  s_branch L_c0_kernel_end_1
L_c0_kernel_end_1:
  s_endpgm
.globl c1_kernel
.p2align 8
.type c1_kernel,@function
c1_kernel:
  s_cmp_ge_u32 s2, 256
  s_cbranch_scc1 L_c1_kernel_end_1
  s_load_dwordx2 s[72:73], s[0:1], 80
  v_mov_b32 v255, v0
  s_mov_b32 s95, s2
  v_lshrrev_b32 v2, 6, v0
  s_nop 0
  v_readfirstlane_b32 s3, v2
  s_nop 3
  s_mov_b32 s93, s3
  s_waitcnt lgkmcnt(0)
  s_add_u32 s84, s72, 41947136
  s_addc_u32 s85, s73, 0
  s_mov_b32 s86, 3072
  s_mov_b32 s87, 0x00020000
  s_cmp_ge_u32 s3, 4
  s_cbranch_scc1 L_c1_kernel_p3s_3
  s_load_dwordx2 s[6:7], s[0:1], 80
  v_lshrrev_b32 v2, 6, v0
  v_and_b32 v1, 63, v0
  v_readfirstlane_b32 s3, v2
  v_mov_b32 v80, 0
  v_mov_b32 v81, 0
  v_mov_b32 v82, 0
  v_mov_b32 v83, 0
  v_mov_b32 v84, 0
  v_mov_b32 v85, 0
  v_mov_b32 v86, 0
  v_mov_b32 v87, 0
  v_mov_b32 v88, 0
  v_mov_b32 v89, 0
  v_mov_b32 v90, 0
  v_mov_b32 v91, 0
  v_mov_b32 v92, 0
  v_mov_b32 v93, 0
  v_mov_b32 v94, 0
  v_mov_b32 v95, 0
  s_mov_b32 s20, 0x3f3504f3
  s_mov_b32 s21, 0x3f3504f3
  s_mov_b32 s22, 0xbf3504f3
  s_mov_b32 s23, 0xbf3504f3
  s_waitcnt lgkmcnt(0)
  s_add_u32 s8, s6, 12582912
  s_addc_u32 s9, s7, 0
  s_mov_b32 s10, 2097152
  s_mov_b32 s11, 0x00020000
  s_add_u32 s12, s6, 4194304
  s_addc_u32 s13, s7, 0
  s_mov_b32 s14, 4194304
  s_mov_b32 s15, 0x00020000
  s_add_u32 s32, s6, 14680064
  s_addc_u32 s33, s7, 0
  s_mov_b32 s34, 2097152
  s_mov_b32 s35, 0x00020000
  s_add_u32 s36, s6, 8388608
  s_addc_u32 s37, s7, 0
  s_mov_b32 s38, 2097152
  s_mov_b32 s39, 0x00020000
  v_lshrrev_b32 v7, 3, v1
  v_lshrrev_b32 v11, 2, v1
  v_and_b32 v12, 3, v1
  v_lshlrev_b32 v12, 3, v12
  v_lshl_add_u32 v11, v11, 6, v12
  s_lshl_b32 s24, s3, 10
  s_lshr_b32 s25, s2, 1
  s_lshl_b32 s25, s25, 15
  s_add_u32 s24, s24, s25
  s_and_b32 s25, s2, 1
  s_lshl_b32 s25, s25, 5
  s_add_u32 s24, s24, s25
  buffer_load_dwordx2 v[16:17], v11, s[12:15], s24 offen
  s_add_u32 s24, s24, 4096
  buffer_load_dwordx2 v[18:19], v11, s[12:15], s24 offen
  s_add_u32 s24, s24, 4096
  buffer_load_dwordx2 v[20:21], v11, s[12:15], s24 offen
  s_add_u32 s24, s24, 4096
  buffer_load_dwordx2 v[22:23], v11, s[12:15], s24 offen
  s_add_u32 s24, s24, 4096
  buffer_load_dwordx2 v[24:25], v11, s[12:15], s24 offen
  s_add_u32 s24, s24, 4096
  buffer_load_dwordx2 v[26:27], v11, s[12:15], s24 offen
  s_add_u32 s24, s24, 4096
  buffer_load_dwordx2 v[28:29], v11, s[12:15], s24 offen
  s_add_u32 s24, s24, 4096
  buffer_load_dwordx2 v[30:31], v11, s[12:15], s24 offen
  s_lshl_b32 s16, s2, 2
  s_add_u32 s16, s16, s3
  s_lshl_b32 s16, s16, 10
  s_add_u32 s17, s16, 1048576
  v_lshlrev_b32 v3, 1, v1
  buffer_load_short_d16_hi v80, v3, s[8:11], s16 offen offset:0
  buffer_load_short_d16_hi v81, v3, s[8:11], s17 offen offset:0
  buffer_load_short_d16_hi v82, v3, s[8:11], s16 offen offset:128
  buffer_load_short_d16_hi v83, v3, s[8:11], s17 offen offset:128
  buffer_load_short_d16_hi v84, v3, s[8:11], s16 offen offset:256
  buffer_load_short_d16_hi v85, v3, s[8:11], s17 offen offset:256
  buffer_load_short_d16_hi v86, v3, s[8:11], s16 offen offset:384
  buffer_load_short_d16_hi v87, v3, s[8:11], s17 offen offset:384
  buffer_load_short_d16_hi v88, v3, s[8:11], s16 offen offset:512
  buffer_load_short_d16_hi v89, v3, s[8:11], s17 offen offset:512
  buffer_load_short_d16_hi v90, v3, s[8:11], s16 offen offset:640
  buffer_load_short_d16_hi v91, v3, s[8:11], s17 offen offset:640
  buffer_load_short_d16_hi v92, v3, s[8:11], s16 offen offset:768
  buffer_load_short_d16_hi v93, v3, s[8:11], s17 offen offset:768
  buffer_load_short_d16_hi v94, v3, s[8:11], s16 offen offset:896
  buffer_load_short_d16_hi v95, v3, s[8:11], s17 offen offset:896
  v_lshrrev_b32 v5, 5, v0
  v_cvt_f32_u32 v5, v5
  v_mul_f32 v6, 0x3c800000, v5
  v_cos_f32 v64, v6
  v_sin_f32 v65, v6
  v_mul_f32 v6, 0x3d000000, v5
  v_cos_f32 v66, v6
  v_sin_f32 v67, v6
  v_mul_f32 v6, 0x3d400000, v5
  v_cos_f32 v68, v6
  v_sin_f32 v69, v6
  v_mul_f32 v6, 0x3d800000, v5
  v_cos_f32 v70, v6
  v_sin_f32 v71, v6
  v_mul_f32 v6, 0x3da00000, v5
  v_cos_f32 v72, v6
  v_sin_f32 v73, v6
  v_mul_f32 v6, 0x3dc00000, v5
  v_cos_f32 v74, v6
  v_sin_f32 v75, v6
  v_mul_f32 v6, 0x3de00000, v5
  v_cos_f32 v76, v6
  v_sin_f32 v77, v6
  v_and_b32 v4, 7, v1
  v_add_u32 v5, 0, v4
  v_mul_u32_u24 v5, v5, v7
  v_cvt_f32_u32 v5, v5
  v_mul_f32 v6, 0x3b000000, v5
  v_cos_f32 v48, v6
  v_sin_f32 v49, v6
  v_add_u32 v5, 8, v4
  v_mul_u32_u24 v5, v5, v7
  v_cvt_f32_u32 v5, v5
  v_mul_f32 v6, 0x3b000000, v5
  v_cos_f32 v50, v6
  v_sin_f32 v51, v6
  v_add_u32 v5, 16, v4
  v_mul_u32_u24 v5, v5, v7
  v_cvt_f32_u32 v5, v5
  v_mul_f32 v6, 0x3b000000, v5
  v_cos_f32 v52, v6
  v_sin_f32 v53, v6
  v_add_u32 v5, 24, v4
  v_mul_u32_u24 v5, v5, v7
  v_cvt_f32_u32 v5, v5
  v_mul_f32 v6, 0x3b000000, v5
  v_cos_f32 v54, v6
  v_sin_f32 v55, v6
  v_add_u32 v5, 32, v4
  v_mul_u32_u24 v5, v5, v7
  v_cvt_f32_u32 v5, v5
  v_mul_f32 v6, 0x3b000000, v5
  v_cos_f32 v56, v6
  v_sin_f32 v57, v6
  v_add_u32 v5, 40, v4
  v_mul_u32_u24 v5, v5, v7
  v_cvt_f32_u32 v5, v5
  v_mul_f32 v6, 0x3b000000, v5
  v_cos_f32 v58, v6
  v_sin_f32 v59, v6
  v_add_u32 v5, 48, v4
  v_mul_u32_u24 v5, v5, v7
  v_cvt_f32_u32 v5, v5
  v_mul_f32 v6, 0x3b000000, v5
  v_cos_f32 v60, v6
  v_sin_f32 v61, v6
  v_add_u32 v5, 56, v4
  v_mul_u32_u24 v5, v5, v7
  v_cvt_f32_u32 v5, v5
  v_mul_f32 v6, 0x3b000000, v5
  v_cos_f32 v62, v6
  v_sin_f32 v63, v6
  s_lshl_b32 s18, s3, 12
  v_lshlrev_b32 v6, 3, v1
  v_add_u32 v6, s18, v6
  v_lshl_add_u32 v8, v7, 9, v6
  v_and_b32 v9, 7, v1
  s_lshl_b32 s19, s3, 3
  v_add_u32 v10, s19, v7
  v_lshlrev_b32 v11, 1, v9
  v_xor_b32 v10, v10, v11
  v_lshl_add_u32 v9, v9, 5, v10
  v_lshlrev_b32 v9, 3, v9
  v_add_u32 v9, 0x4000, v9
  v_and_b32 v10, 3, v1
  v_bfe_u32 v11, v1, 2, 3
  v_lshrrev_b32 v12, 5, v1
  v_lshl_add_u32 v10, v10, 3, v11
  v_lshl_add_u32 v10, v12, 8, v10
  v_lshlrev_b32 v10, 3, v10
  s_lshl_b32 s19, s3, 12
  s_add_u32 s19, s19, 0x4000
  v_add_u32 v10, s19, v10
  s_mov_b32 s40, 0x35000000
  s_mov_b32 s41, 0x35000000
  s_waitcnt vmcnt(16)
  v_pk_add_f32 v[32:33], v[16:17], v[24:25]
  v_pk_add_f32 v[40:41], v[16:17], v[24:25] neg_lo:[0,1] neg_hi:[0,1]
  v_pk_add_f32 v[34:35], v[18:19], v[26:27]
  v_pk_add_f32 v[42:43], v[18:19], v[26:27] neg_lo:[0,1] neg_hi:[0,1]
  v_pk_add_f32 v[36:37], v[20:21], v[28:29]
  v_pk_add_f32 v[44:45], v[20:21], v[28:29] neg_lo:[0,1] neg_hi:[0,1]
  v_pk_add_f32 v[38:39], v[22:23], v[30:31]
  v_pk_add_f32 v[46:47], v[22:23], v[30:31] neg_lo:[0,1] neg_hi:[0,1]
  v_pk_add_f32 v[26:27], v[42:43], v[42:43] op_sel:[0,1] op_sel_hi:[1,0] neg_lo:[0,1]
  v_pk_add_f32 v[30:31], v[46:47], v[46:47] op_sel:[0,1] op_sel_hi:[1,0] neg_hi:[0,1]
  v_pk_add_f32 v[16:17], v[32:33], v[36:37]
  v_pk_add_f32 v[18:19], v[32:33], v[36:37] neg_lo:[0,1] neg_hi:[0,1]
  v_pk_mul_f32 v[26:27], v[26:27], s[20:21]
  v_pk_mul_f32 v[30:31], v[30:31], s[22:23]
  v_pk_add_f32 v[20:21], v[34:35], v[38:39]
  v_pk_add_f32 v[22:23], v[34:35], v[38:39] neg_lo:[0,1] neg_hi:[0,1]
  v_pk_add_f32 v[24:25], v[40:41], v[44:45] op_sel:[0,1] op_sel_hi:[1,0] neg_lo:[0,1]
  v_pk_add_f32 v[28:29], v[40:41], v[44:45] op_sel:[0,1] op_sel_hi:[1,0] neg_hi:[0,1]
  v_pk_add_f32 v[42:43], v[26:27], v[30:31]
  v_pk_add_f32 v[46:47], v[26:27], v[30:31] neg_lo:[0,1] neg_hi:[0,1]
  v_pk_add_f32 v[32:33], v[16:17], v[20:21]
  v_pk_add_f32 v[36:37], v[16:17], v[20:21] neg_lo:[0,1] neg_hi:[0,1]
  v_pk_add_f32 v[34:35], v[18:19], v[22:23] op_sel:[0,1] op_sel_hi:[1,0] neg_lo:[0,1]
  v_pk_add_f32 v[38:39], v[18:19], v[22:23] op_sel:[0,1] op_sel_hi:[1,0] neg_hi:[0,1]
  v_pk_add_f32 v[40:41], v[24:25], v[42:43]
  v_pk_add_f32 v[44:45], v[24:25], v[42:43] neg_lo:[0,1] neg_hi:[0,1]
  v_pk_add_f32 v[26:27], v[28:29], v[46:47] op_sel:[0,1] op_sel_hi:[1,0] neg_lo:[0,1]
  v_pk_add_f32 v[30:31], v[28:29], v[46:47] op_sel:[0,1] op_sel_hi:[1,0] neg_hi:[0,1]
  v_pk_mul_f32 v[18:19], v[40:41], v[64:65] op_sel:[0,0] op_sel_hi:[0,1]
  v_pk_fma_f32 v[40:41], v[40:41], v[64:65], v[18:19] op_sel:[1,1,0] op_sel_hi:[1,0,1] neg_lo:[1,0,0]
  v_pk_mul_f32 v[16:17], v[34:35], v[66:67] op_sel:[0,0] op_sel_hi:[0,1]
  v_pk_fma_f32 v[34:35], v[34:35], v[66:67], v[16:17] op_sel:[1,1,0] op_sel_hi:[1,0,1] neg_lo:[1,0,0]
  v_pk_mul_f32 v[18:19], v[26:27], v[68:69] op_sel:[0,0] op_sel_hi:[0,1]
  v_pk_fma_f32 v[26:27], v[26:27], v[68:69], v[18:19] op_sel:[1,1,0] op_sel_hi:[1,0,1] neg_lo:[1,0,0]
  v_pk_mul_f32 v[16:17], v[36:37], v[70:71] op_sel:[0,0] op_sel_hi:[0,1]
  v_pk_fma_f32 v[36:37], v[36:37], v[70:71], v[16:17] op_sel:[1,1,0] op_sel_hi:[1,0,1] neg_lo:[1,0,0]
  v_pk_mul_f32 v[18:19], v[44:45], v[72:73] op_sel:[0,0] op_sel_hi:[0,1]
  v_pk_fma_f32 v[44:45], v[44:45], v[72:73], v[18:19] op_sel:[1,1,0] op_sel_hi:[1,0,1] neg_lo:[1,0,0]
  v_pk_mul_f32 v[16:17], v[38:39], v[74:75] op_sel:[0,0] op_sel_hi:[0,1]
  v_pk_fma_f32 v[38:39], v[38:39], v[74:75], v[16:17] op_sel:[1,1,0] op_sel_hi:[1,0,1] neg_lo:[1,0,0]
  v_pk_mul_f32 v[18:19], v[30:31], v[76:77] op_sel:[0,0] op_sel_hi:[0,1]
  v_pk_fma_f32 v[30:31], v[30:31], v[76:77], v[18:19] op_sel:[1,1,0] op_sel_hi:[1,0,1] neg_lo:[1,0,0]
  ds_write_b64 v10, v[32:33] offset:0
  v_xor_b32 v13, 16, v10
  ds_write_b64 v13, v[40:41] offset:256
  v_xor_b32 v12, 32, v10
  ds_write_b64 v12, v[34:35] offset:512
  v_xor_b32 v13, 48, v10
  ds_write_b64 v13, v[26:27] offset:768
  v_xor_b32 v12, 64, v10
  ds_write_b64 v12, v[36:37] offset:1024
  v_xor_b32 v13, 80, v10
  ds_write_b64 v13, v[44:45] offset:1280
  v_xor_b32 v12, 96, v10
  ds_write_b64 v12, v[38:39] offset:1536
  v_xor_b32 v13, 112, v10
  ds_write_b64 v13, v[30:31] offset:1792
  s_waitcnt lgkmcnt(0)
  s_barrier
  ds_read_b64 v[16:17], v9 offset:0
  ds_read_b64 v[18:19], v9 offset:2048
  ds_read_b64 v[20:21], v9 offset:4096
  ds_read_b64 v[22:23], v9 offset:6144
  ds_read_b64 v[24:25], v9 offset:8192
  ds_read_b64 v[28:29], v9 offset:10240
  ds_read_b64 v[42:43], v9 offset:12288
  ds_read_b64 v[46:47], v9 offset:14336
  s_waitcnt lgkmcnt(0)
  v_pk_add_f32 v[32:33], v[16:17], v[24:25]
  v_pk_add_f32 v[36:37], v[16:17], v[24:25] neg_lo:[0,1] neg_hi:[0,1]
  v_pk_add_f32 v[40:41], v[18:19], v[28:29]
  v_pk_add_f32 v[44:45], v[18:19], v[28:29] neg_lo:[0,1] neg_hi:[0,1]
  v_pk_add_f32 v[34:35], v[20:21], v[42:43]
  v_pk_add_f32 v[38:39], v[20:21], v[42:43] neg_lo:[0,1] neg_hi:[0,1]
  v_pk_add_f32 v[26:27], v[22:23], v[46:47]
  v_pk_add_f32 v[30:31], v[22:23], v[46:47] neg_lo:[0,1] neg_hi:[0,1]
  v_pk_add_f32 v[28:29], v[44:45], v[44:45] op_sel:[0,1] op_sel_hi:[1,0] neg_lo:[0,1]
  v_pk_add_f32 v[46:47], v[30:31], v[30:31] op_sel:[0,1] op_sel_hi:[1,0] neg_hi:[0,1]
  v_pk_add_f32 v[16:17], v[32:33], v[34:35]
  v_pk_add_f32 v[18:19], v[32:33], v[34:35] neg_lo:[0,1] neg_hi:[0,1]
  v_pk_mul_f32 v[28:29], v[28:29], s[20:21]
  v_pk_mul_f32 v[46:47], v[46:47], s[22:23]
  v_pk_add_f32 v[20:21], v[40:41], v[26:27]
  v_pk_add_f32 v[22:23], v[40:41], v[26:27] neg_lo:[0,1] neg_hi:[0,1]
  v_pk_add_f32 v[24:25], v[36:37], v[38:39] op_sel:[0,1] op_sel_hi:[1,0] neg_lo:[0,1]
  v_pk_add_f32 v[42:43], v[36:37], v[38:39] op_sel:[0,1] op_sel_hi:[1,0] neg_hi:[0,1]
  v_pk_add_f32 v[44:45], v[28:29], v[46:47]
  v_pk_add_f32 v[30:31], v[28:29], v[46:47] neg_lo:[0,1] neg_hi:[0,1]
  v_pk_add_f32 v[32:33], v[16:17], v[20:21]
  v_pk_add_f32 v[34:35], v[16:17], v[20:21] neg_lo:[0,1] neg_hi:[0,1]
  v_pk_add_f32 v[40:41], v[18:19], v[22:23] op_sel:[0,1] op_sel_hi:[1,0] neg_lo:[0,1]
  v_pk_add_f32 v[26:27], v[18:19], v[22:23] op_sel:[0,1] op_sel_hi:[1,0] neg_hi:[0,1]
  v_pk_add_f32 v[36:37], v[24:25], v[44:45]
  v_pk_add_f32 v[38:39], v[24:25], v[44:45] neg_lo:[0,1] neg_hi:[0,1]
  v_pk_add_f32 v[28:29], v[42:43], v[30:31] op_sel:[0,1] op_sel_hi:[1,0] neg_lo:[0,1]
  v_pk_add_f32 v[46:47], v[42:43], v[30:31] op_sel:[0,1] op_sel_hi:[1,0] neg_hi:[0,1]
  v_pk_mul_f32 v[16:17], v[32:33], v[48:49] op_sel:[0,0] op_sel_hi:[0,1]
  v_pk_fma_f32 v[32:33], v[32:33], v[48:49], v[16:17] op_sel:[1,1,0] op_sel_hi:[1,0,1] neg_lo:[1,0,0]
  v_pk_mul_f32 v[18:19], v[36:37], v[50:51] op_sel:[0,0] op_sel_hi:[0,1]
  v_pk_fma_f32 v[36:37], v[36:37], v[50:51], v[18:19] op_sel:[1,1,0] op_sel_hi:[1,0,1] neg_lo:[1,0,0]
  v_pk_mul_f32 v[16:17], v[40:41], v[52:53] op_sel:[0,0] op_sel_hi:[0,1]
  v_pk_fma_f32 v[40:41], v[40:41], v[52:53], v[16:17] op_sel:[1,1,0] op_sel_hi:[1,0,1] neg_lo:[1,0,0]
  v_pk_mul_f32 v[18:19], v[28:29], v[54:55] op_sel:[0,0] op_sel_hi:[0,1]
  v_pk_fma_f32 v[28:29], v[28:29], v[54:55], v[18:19] op_sel:[1,1,0] op_sel_hi:[1,0,1] neg_lo:[1,0,0]
  v_pk_mul_f32 v[16:17], v[34:35], v[56:57] op_sel:[0,0] op_sel_hi:[0,1]
  v_pk_fma_f32 v[34:35], v[34:35], v[56:57], v[16:17] op_sel:[1,1,0] op_sel_hi:[1,0,1] neg_lo:[1,0,0]
  v_pk_mul_f32 v[18:19], v[38:39], v[58:59] op_sel:[0,0] op_sel_hi:[0,1]
  v_pk_fma_f32 v[38:39], v[38:39], v[58:59], v[18:19] op_sel:[1,1,0] op_sel_hi:[1,0,1] neg_lo:[1,0,0]
  v_pk_mul_f32 v[16:17], v[26:27], v[60:61] op_sel:[0,0] op_sel_hi:[0,1]
  v_pk_fma_f32 v[26:27], v[26:27], v[60:61], v[16:17] op_sel:[1,1,0] op_sel_hi:[1,0,1] neg_lo:[1,0,0]
  v_pk_mul_f32 v[18:19], v[46:47], v[62:63] op_sel:[0,0] op_sel_hi:[0,1]
  v_pk_fma_f32 v[46:47], v[46:47], v[62:63], v[18:19] op_sel:[1,1,0] op_sel_hi:[1,0,1] neg_lo:[1,0,0]
  ds_write_b64 v8, v[32:33]
  v_xor_b32 v13, 64, v8
  ds_write_b64 v13, v[36:37]
  v_xor_b32 v12, 128, v8
  ds_write_b64 v12, v[40:41]
  v_xor_b32 v13, 192, v8
  ds_write_b64 v13, v[28:29]
  v_xor_b32 v12, 256, v8
  ds_write_b64 v12, v[34:35]
  v_xor_b32 v13, 320, v8
  ds_write_b64 v13, v[38:39]
  v_xor_b32 v12, 384, v8
  ds_write_b64 v12, v[26:27]
  v_xor_b32 v13, 448, v8
  ds_write_b64 v13, v[46:47]
  ds_read_b64 v[16:17], v6 offset:0
  v_xor_b32 v13, 64, v6
  ds_read_b64 v[18:19], v13 offset:512
  v_xor_b32 v12, 128, v6
  ds_read_b64 v[20:21], v12 offset:1024
  v_xor_b32 v13, 192, v6
  ds_read_b64 v[22:23], v13 offset:1536
  v_xor_b32 v12, 256, v6
  ds_read_b64 v[24:25], v12 offset:2048
  v_xor_b32 v13, 320, v6
  ds_read_b64 v[42:43], v13 offset:2560
  v_xor_b32 v12, 384, v6
  ds_read_b64 v[44:45], v12 offset:3072
  v_xor_b32 v13, 448, v6
  ds_read_b64 v[30:31], v13 offset:3584
  s_waitcnt lgkmcnt(0)
  v_pk_add_f32 v[32:33], v[16:17], v[24:25]
  v_pk_add_f32 v[34:35], v[16:17], v[24:25] neg_lo:[0,1] neg_hi:[0,1]
  v_pk_add_f32 v[36:37], v[18:19], v[42:43]
  v_pk_add_f32 v[38:39], v[18:19], v[42:43] neg_lo:[0,1] neg_hi:[0,1]
  v_pk_add_f32 v[40:41], v[20:21], v[44:45]
  v_pk_add_f32 v[26:27], v[20:21], v[44:45] neg_lo:[0,1] neg_hi:[0,1]
  v_pk_add_f32 v[28:29], v[22:23], v[30:31]
  v_pk_add_f32 v[46:47], v[22:23], v[30:31] neg_lo:[0,1] neg_hi:[0,1]
  v_pk_add_f32 v[42:43], v[38:39], v[38:39] op_sel:[0,1] op_sel_hi:[1,0] neg_lo:[0,1]
  v_pk_add_f32 v[30:31], v[46:47], v[46:47] op_sel:[0,1] op_sel_hi:[1,0] neg_hi:[0,1]
  v_pk_add_f32 v[16:17], v[32:33], v[40:41]
  v_pk_add_f32 v[18:19], v[32:33], v[40:41] neg_lo:[0,1] neg_hi:[0,1]
  v_pk_mul_f32 v[42:43], v[42:43], s[20:21]
  v_pk_mul_f32 v[30:31], v[30:31], s[22:23]
  v_pk_add_f32 v[20:21], v[36:37], v[28:29]
  v_pk_add_f32 v[22:23], v[36:37], v[28:29] neg_lo:[0,1] neg_hi:[0,1]
  v_pk_add_f32 v[24:25], v[34:35], v[26:27] op_sel:[0,1] op_sel_hi:[1,0] neg_lo:[0,1]
  v_pk_add_f32 v[44:45], v[34:35], v[26:27] op_sel:[0,1] op_sel_hi:[1,0] neg_hi:[0,1]
  v_pk_add_f32 v[38:39], v[42:43], v[30:31]
  v_pk_add_f32 v[46:47], v[42:43], v[30:31] neg_lo:[0,1] neg_hi:[0,1]
  v_pk_add_f32 v[32:33], v[16:17], v[20:21]
  v_pk_add_f32 v[40:41], v[16:17], v[20:21] neg_lo:[0,1] neg_hi:[0,1]
  v_pk_add_f32 v[36:37], v[18:19], v[22:23] op_sel:[0,1] op_sel_hi:[1,0] neg_lo:[0,1]
  v_pk_add_f32 v[28:29], v[18:19], v[22:23] op_sel:[0,1] op_sel_hi:[1,0] neg_hi:[0,1]
  v_pk_add_f32 v[34:35], v[24:25], v[38:39]
  v_pk_add_f32 v[26:27], v[24:25], v[38:39] neg_lo:[0,1] neg_hi:[0,1]
  v_pk_add_f32 v[42:43], v[44:45], v[46:47] op_sel:[0,1] op_sel_hi:[1,0] neg_lo:[0,1]
  v_pk_add_f32 v[30:31], v[44:45], v[46:47] op_sel:[0,1] op_sel_hi:[1,0] neg_hi:[0,1]
  s_waitcnt vmcnt(0)
  v_pk_mul_f32 v[32:33], v[32:33], s[40:41]
  v_cvt_pk_bf16_f32 v16, v32, v33
  v_lshlrev_b32 v32, 16, v16
  v_and_b32 v33, 0xffff0000, v16
  v_pk_mul_f32 v[34:35], v[34:35], s[40:41]
  v_cvt_pk_bf16_f32 v18, v34, v35
  v_lshlrev_b32 v34, 16, v18
  v_and_b32 v35, 0xffff0000, v18
  v_pk_mul_f32 v[36:37], v[36:37], s[40:41]
  v_cvt_pk_bf16_f32 v20, v36, v37
  v_lshlrev_b32 v36, 16, v20
  v_and_b32 v37, 0xffff0000, v20
  v_pk_mul_f32 v[42:43], v[42:43], s[40:41]
  v_cvt_pk_bf16_f32 v22, v42, v43
  v_lshlrev_b32 v42, 16, v22
  v_and_b32 v43, 0xffff0000, v22
  v_pk_mul_f32 v[40:41], v[40:41], s[40:41]
  v_cvt_pk_bf16_f32 v24, v40, v41
  v_lshlrev_b32 v40, 16, v24
  v_and_b32 v41, 0xffff0000, v24
  v_pk_mul_f32 v[26:27], v[26:27], s[40:41]
  v_cvt_pk_bf16_f32 v44, v26, v27
  v_lshlrev_b32 v26, 16, v44
  v_and_b32 v27, 0xffff0000, v44
  v_pk_mul_f32 v[28:29], v[28:29], s[40:41]
  v_cvt_pk_bf16_f32 v38, v28, v29
  v_lshlrev_b32 v28, 16, v38
  v_and_b32 v29, 0xffff0000, v38
  v_pk_mul_f32 v[30:31], v[30:31], s[40:41]
  v_cvt_pk_bf16_f32 v46, v30, v31
  v_lshlrev_b32 v30, 16, v46
  v_and_b32 v31, 0xffff0000, v46
  v_pk_add_f32 v[32:33], v[32:33], v[80:81]
  v_cvt_pk_bf16_f32 v80, v32, v33
  v_lshlrev_b32 v32, 16, v80
  v_and_b32 v33, 0xffff0000, v80
  v_pk_add_f32 v[34:35], v[34:35], v[82:83]
  v_cvt_pk_bf16_f32 v82, v34, v35
  v_lshlrev_b32 v34, 16, v82
  v_and_b32 v35, 0xffff0000, v82
  v_pk_add_f32 v[36:37], v[36:37], v[84:85]
  v_cvt_pk_bf16_f32 v84, v36, v37
  v_lshlrev_b32 v36, 16, v84
  v_and_b32 v37, 0xffff0000, v84
  v_pk_add_f32 v[42:43], v[42:43], v[86:87]
  v_cvt_pk_bf16_f32 v86, v42, v43
  v_lshlrev_b32 v42, 16, v86
  v_and_b32 v43, 0xffff0000, v86
  v_pk_add_f32 v[40:41], v[40:41], v[88:89]
  v_cvt_pk_bf16_f32 v88, v40, v41
  v_lshlrev_b32 v40, 16, v88
  v_and_b32 v41, 0xffff0000, v88
  v_pk_add_f32 v[26:27], v[26:27], v[90:91]
  v_cvt_pk_bf16_f32 v90, v26, v27
  v_lshlrev_b32 v26, 16, v90
  v_and_b32 v27, 0xffff0000, v90
  v_pk_add_f32 v[28:29], v[28:29], v[92:93]
  v_cvt_pk_bf16_f32 v92, v28, v29
  v_lshlrev_b32 v28, 16, v92
  v_and_b32 v29, 0xffff0000, v92
  v_pk_add_f32 v[30:31], v[30:31], v[94:95]
  v_cvt_pk_bf16_f32 v94, v30, v31
  v_lshlrev_b32 v30, 16, v94
  v_and_b32 v31, 0xffff0000, v94
  buffer_store_short v80, v3, s[32:35], s16 offen offset:0 sc1
  buffer_store_short_d16_hi v80, v3, s[32:35], s17 offen offset:0 sc1
  buffer_store_short v82, v3, s[32:35], s16 offen offset:128 sc1
  buffer_store_short_d16_hi v82, v3, s[32:35], s17 offen offset:128 sc1
  buffer_store_short v84, v3, s[32:35], s16 offen offset:256 sc1
  buffer_store_short_d16_hi v84, v3, s[32:35], s17 offen offset:256 sc1
  buffer_store_short v86, v3, s[32:35], s16 offen offset:384 sc1
  buffer_store_short_d16_hi v86, v3, s[32:35], s17 offen offset:384 sc1
  buffer_store_short v88, v3, s[32:35], s16 offen offset:512 sc1
  buffer_store_short_d16_hi v88, v3, s[32:35], s17 offen offset:512 sc1
  buffer_store_short v90, v3, s[32:35], s16 offen offset:640 sc1
  buffer_store_short_d16_hi v90, v3, s[32:35], s17 offen offset:640 sc1
  buffer_store_short v92, v3, s[32:35], s16 offen offset:768 sc1
  buffer_store_short_d16_hi v92, v3, s[32:35], s17 offen offset:768 sc1
  buffer_store_short v94, v3, s[32:35], s16 offen offset:896 sc1
  buffer_store_short_d16_hi v94, v3, s[32:35], s17 offen offset:896 sc1
  v_pk_add_f32 v[16:17], v[32:33], v[34:35]
  v_pk_add_f32 v[18:19], v[36:37], v[42:43]
  v_pk_add_f32 v[20:21], v[40:41], v[26:27]
  v_pk_add_f32 v[22:23], v[28:29], v[30:31]
  v_pk_add_f32 v[16:17], v[16:17], v[18:19]
  v_pk_add_f32 v[20:21], v[20:21], v[22:23]
  v_pk_add_f32 v[16:17], v[16:17], v[20:21]
  s_nop 1
  v_add_f32_dpp v16, v16, v16 row_shr:1 row_mask:0xf bank_mask:0xf bound_ctrl:0
  v_add_f32_dpp v17, v17, v17 row_shr:1 row_mask:0xf bank_mask:0xf bound_ctrl:0
  s_nop 0
  v_add_f32_dpp v16, v16, v16 row_shr:2 row_mask:0xf bank_mask:0xf bound_ctrl:0
  v_add_f32_dpp v17, v17, v17 row_shr:2 row_mask:0xf bank_mask:0xf bound_ctrl:0
  s_nop 0
  v_add_f32_dpp v16, v16, v16 row_shr:4 row_mask:0xf bank_mask:0xf bound_ctrl:0
  v_add_f32_dpp v17, v17, v17 row_shr:4 row_mask:0xf bank_mask:0xf bound_ctrl:0
  s_nop 0
  v_add_f32_dpp v16, v16, v16 row_shr:8 row_mask:0xf bank_mask:0xf bound_ctrl:0
  v_add_f32_dpp v17, v17, v17 row_shr:8 row_mask:0xf bank_mask:0xf bound_ctrl:0
  s_nop 0
  v_add_f32_dpp v16, v16, v16 row_bcast:15 row_mask:0xa bank_mask:0xf
  v_add_f32_dpp v17, v17, v17 row_bcast:15 row_mask:0xa bank_mask:0xf
  s_nop 0
  v_add_f32_dpp v16, v16, v16 row_bcast:31 row_mask:0xc bank_mask:0xf
  v_add_f32_dpp v17, v17, v17 row_bcast:31 row_mask:0xc bank_mask:0xf
  s_nop 0
  v_mul_f32 v16, 0x3b000000, v16
  v_mul_f32 v17, 0x3b000000, v17
  v_cvt_pk_bf16_f32 v18, v16, v17
  v_and_b32 v19, 0xffff0000, v18
  v_lshlrev_b32 v18, 16, v18
  v_readlane_b32 s26, v16, 63
  v_readlane_b32 s27, v17, 63
  v_readlane_b32 s28, v18, 63
  v_readlane_b32 s29, v19, 63
  s_nop 1
  v_pk_add_f32 v[16:17], v[32:33], s[26:27] neg_lo:[0,1] neg_hi:[0,1]
  v_pk_add_f32 v[18:19], v[34:35], s[26:27] neg_lo:[0,1] neg_hi:[0,1]
  v_pk_add_f32 v[20:21], v[36:37], s[26:27] neg_lo:[0,1] neg_hi:[0,1]
  v_pk_add_f32 v[22:23], v[42:43], s[26:27] neg_lo:[0,1] neg_hi:[0,1]
  v_pk_add_f32 v[24:25], v[40:41], s[26:27] neg_lo:[0,1] neg_hi:[0,1]
  v_pk_add_f32 v[44:45], v[26:27], s[26:27] neg_lo:[0,1] neg_hi:[0,1]
  v_pk_add_f32 v[38:39], v[28:29], s[26:27] neg_lo:[0,1] neg_hi:[0,1]
  v_pk_add_f32 v[46:47], v[30:31], s[26:27] neg_lo:[0,1] neg_hi:[0,1]
  v_pk_mul_f32 v[16:17], v[16:17], v[16:17]
  v_pk_mul_f32 v[18:19], v[18:19], v[18:19]
  v_pk_fma_f32 v[16:17], v[20:21], v[20:21], v[16:17]
  v_pk_fma_f32 v[18:19], v[22:23], v[22:23], v[18:19]
  v_pk_fma_f32 v[16:17], v[24:25], v[24:25], v[16:17]
  v_pk_fma_f32 v[18:19], v[44:45], v[44:45], v[18:19]
  v_pk_fma_f32 v[16:17], v[38:39], v[38:39], v[16:17]
  v_pk_fma_f32 v[18:19], v[46:47], v[46:47], v[18:19]
  v_pk_add_f32 v[16:17], v[16:17], v[18:19]
  s_nop 1
  v_add_f32_dpp v16, v16, v16 row_shr:1 row_mask:0xf bank_mask:0xf bound_ctrl:0
  v_add_f32_dpp v17, v17, v17 row_shr:1 row_mask:0xf bank_mask:0xf bound_ctrl:0
  s_nop 0
  v_add_f32_dpp v16, v16, v16 row_shr:2 row_mask:0xf bank_mask:0xf bound_ctrl:0
  v_add_f32_dpp v17, v17, v17 row_shr:2 row_mask:0xf bank_mask:0xf bound_ctrl:0
  s_nop 0
  v_add_f32_dpp v16, v16, v16 row_shr:4 row_mask:0xf bank_mask:0xf bound_ctrl:0
  v_add_f32_dpp v17, v17, v17 row_shr:4 row_mask:0xf bank_mask:0xf bound_ctrl:0
  s_nop 0
  v_add_f32_dpp v16, v16, v16 row_shr:8 row_mask:0xf bank_mask:0xf bound_ctrl:0
  v_add_f32_dpp v17, v17, v17 row_shr:8 row_mask:0xf bank_mask:0xf bound_ctrl:0
  s_nop 0
  v_add_f32_dpp v16, v16, v16 row_bcast:15 row_mask:0xa bank_mask:0xf
  v_add_f32_dpp v17, v17, v17 row_bcast:15 row_mask:0xa bank_mask:0xf
  s_nop 0
  v_add_f32_dpp v16, v16, v16 row_bcast:31 row_mask:0xc bank_mask:0xf
  v_add_f32_dpp v17, v17, v17 row_bcast:31 row_mask:0xc bank_mask:0xf
  s_nop 0
  v_mul_f32 v16, 0x3b000000, v16
  v_mul_f32 v17, 0x3b000000, v17
  v_cvt_pk_bf16_f32 v18, v16, v17
  v_lshlrev_b32 v16, 16, v18
  v_and_b32 v17, 0xffff0000, v18
  v_add_f32 v16, 0x3727c5ac, v16
  v_add_f32 v17, 0x3727c5ac, v17
  v_cvt_pk_bf16_f32 v18, v16, v17
  v_lshlrev_b32 v16, 16, v18
  v_and_b32 v17, 0xffff0000, v18
  v_sqrt_f32 v16, v16
  v_sqrt_f32 v17, v17
  s_nop 0
  v_cvt_pk_bf16_f32 v18, v16, v17
  v_lshlrev_b32 v16, 16, v18
  v_and_b32 v17, 0xffff0000, v18
  v_rcp_f32 v16, v16
  v_rcp_f32 v17, v17
  s_nop 1
  v_readlane_b32 s30, v16, 63
  v_readlane_b32 s31, v17, 63
  v_pk_add_f32 v[32:33], v[32:33], s[28:29] neg_lo:[0,1] neg_hi:[0,1]
  v_cvt_pk_bf16_f32 v20, v32, v33
  v_lshlrev_b32 v32, 16, v20
  v_and_b32 v33, 0xffff0000, v20
  v_pk_add_f32 v[34:35], v[34:35], s[28:29] neg_lo:[0,1] neg_hi:[0,1]
  v_cvt_pk_bf16_f32 v22, v34, v35
  v_lshlrev_b32 v34, 16, v22
  v_and_b32 v35, 0xffff0000, v22
  v_pk_add_f32 v[36:37], v[36:37], s[28:29] neg_lo:[0,1] neg_hi:[0,1]
  v_cvt_pk_bf16_f32 v20, v36, v37
  v_lshlrev_b32 v36, 16, v20
  v_and_b32 v37, 0xffff0000, v20
  v_pk_add_f32 v[42:43], v[42:43], s[28:29] neg_lo:[0,1] neg_hi:[0,1]
  v_cvt_pk_bf16_f32 v22, v42, v43
  v_lshlrev_b32 v42, 16, v22
  v_and_b32 v43, 0xffff0000, v22
  v_pk_add_f32 v[40:41], v[40:41], s[28:29] neg_lo:[0,1] neg_hi:[0,1]
  v_cvt_pk_bf16_f32 v20, v40, v41
  v_lshlrev_b32 v40, 16, v20
  v_and_b32 v41, 0xffff0000, v20
  v_pk_add_f32 v[26:27], v[26:27], s[28:29] neg_lo:[0,1] neg_hi:[0,1]
  v_cvt_pk_bf16_f32 v22, v26, v27
  v_lshlrev_b32 v26, 16, v22
  v_and_b32 v27, 0xffff0000, v22
  v_pk_add_f32 v[28:29], v[28:29], s[28:29] neg_lo:[0,1] neg_hi:[0,1]
  v_cvt_pk_bf16_f32 v20, v28, v29
  v_lshlrev_b32 v28, 16, v20
  v_and_b32 v29, 0xffff0000, v20
  v_pk_add_f32 v[30:31], v[30:31], s[28:29] neg_lo:[0,1] neg_hi:[0,1]
  v_cvt_pk_bf16_f32 v22, v30, v31
  v_lshlrev_b32 v30, 16, v22
  v_and_b32 v31, 0xffff0000, v22
  v_pk_mul_f32 v[32:33], v[32:33], s[30:31]
  v_pk_mul_f32 v[34:35], v[34:35], s[30:31]
  v_pk_mul_f32 v[36:37], v[36:37], s[30:31]
  v_pk_mul_f32 v[42:43], v[42:43], s[30:31]
  v_pk_mul_f32 v[40:41], v[40:41], s[30:31]
  v_pk_mul_f32 v[26:27], v[26:27], s[30:31]
  v_pk_mul_f32 v[28:29], v[28:29], s[30:31]
  v_pk_mul_f32 v[30:31], v[30:31], s[30:31]
  v_cvt_pk_bf16_f32 v48, v32, v34
  v_cvt_pk_bf16_f32 v52, v33, v35
  v_cvt_pk_bf16_f32 v49, v36, v42
  v_cvt_pk_bf16_f32 v53, v37, v43
  v_cvt_pk_bf16_f32 v50, v40, v26
  v_cvt_pk_bf16_f32 v54, v41, v27
  v_cvt_pk_bf16_f32 v51, v28, v30
  v_cvt_pk_bf16_f32 v55, v29, v31
  v_lshlrev_b32 v4, 4, v1
  buffer_store_dwordx4 v[48:51], v4, s[36:39], s16 offen sc1
  buffer_store_dwordx4 v[52:55], v4, s[36:39], s17 offen sc1
  s_branch L_c1_kernel_p3d_2
L_c1_kernel_p3_end_1:
  s_branch L_c1_kernel_p3d_2
L_c1_kernel_p3s_3:
  s_barrier
L_c1_kernel_p3d_2:
  s_waitcnt vmcnt(0) lgkmcnt(0)
  s_barrier
  s_cmp_lg_u32 s93, 0
  s_cbranch_scc1 L_c1_kernel_pub_4
  s_lshl_b32 s18, s95, 2
  v_mov_b32 v1, 1
  v_mov_b32 v2, 0
  s_mov_b64 exec, 1
  buffer_store_dword v1, v2, s[84:87], s18 offen sc1
  s_mov_b64 exec, -1
L_c1_kernel_pub_4:
  v_mov_b32 v0, v255
  s_mov_b32 s2, s95
  s_mov_b32 s3, s93
  s_cmp_ge_u32 s2, 224
  s_cbranch_scc1 L_c1_kernel_g2_5
  s_load_dwordx2 s[6:7], s[0:1], 80
  s_load_dwordx2 s[4:5], s[0:1], 40
  v_lshrrev_b32 v2, 6, v0
  v_and_b32 v1, 63, v0
  v_readfirstlane_b32 s3, v2
  s_lshr_b32 s17, s2, 4
  s_and_b32 s16, s2, 7
  s_lshl_b32 s16, s16, 1
  s_bfe_u32 s18, s2, 0x10003
  s_add_u32 s16, s16, s18
  v_lshlrev_b32 v3, 4, v1
  v_lshrrev_b32 v4, 3, v1
  v_lshrrev_b32 v5, 4, v1
  v_and_b32 v6, 7, v1
  v_xor_b32 v7, v6, v5
  v_lshlrev_b32 v7, 4, v7
  v_lshl_add_u32 v7, v4, 10, v7
  v_xor_b32 v8, 64, v7
  s_and_b32 s18, s3, 1
  s_lshr_b32 s19, s3, 1
  s_lshl_b32 s34, s17, 2
  s_add_u32 s34, s34, s19
  s_lshl_b32 s34, s34, 15
  s_lshl_b32 s35, s18, 11
  s_add_u32 s34, s34, s35
  s_lshl_b32 s35, s16, 3
  s_add_u32 s35, s35, s3
  s_lshl_b32 s35, s35, 14
  s_lshl_b32 s36, s3, 11
  s_waitcnt lgkmcnt(0)
  s_add_u32 s8, s6, 25165824
  s_addc_u32 s9, s7, 0
  s_mov_b32 s10, 1835008
  s_mov_b32 s11, 0x00020000
  s_add_u32 s12, s6, 8388608
  s_addc_u32 s13, s7, 0
  s_mov_b32 s14, 2097152
  s_mov_b32 s15, 0x00020000
  s_add_u32 m0, s36, 0
  s_add_u32 s37, s34, 0
  buffer_load_dwordx4 v3, s[8:11], s37 offen lds
  buffer_load_dwordx4 v3, s[8:11], s37 offen offset:1024 lds
  s_add_u32 m0, s36, 32768
  s_add_u32 s37, s34, 4096
  buffer_load_dwordx4 v3, s[8:11], s37 offen lds
  buffer_load_dwordx4 v3, s[8:11], s37 offen offset:1024 lds
  s_add_u32 m0, s36, 65536
  s_add_u32 s37, s34, 8192
  buffer_load_dwordx4 v3, s[8:11], s37 offen lds
  buffer_load_dwordx4 v3, s[8:11], s37 offen offset:1024 lds
  s_cmp_lg_u32 s93, 0
  s_cbranch_scc1 L_c1_kernel_g1_hs_2
  s_and_b32 s50, s16, 7
  s_lshl_b32 s50, s50, 7
  v_lshlrev_b32 v24, 2, v1
  s_mov_b32 s51, 0
  s_mov_b32 exec_lo, 0xffffffff
  s_mov_b32 exec_hi, 0
L_c1_kernel_g1_hl_3:
  buffer_load_dword v25, v24, s[84:87], s50 offen sc1
  s_add_u32 s51, s51, 1
  s_waitcnt vmcnt(0)
  v_cmp_ne_u32 vcc, 1, v25
  s_cmp_ge_u32 s51, 400000
  s_cbranch_scc1 L_c1_kernel_g1_ho_4
  s_cbranch_vccz L_c1_kernel_g1_ho_4
  s_sleep 6
  s_branch L_c1_kernel_g1_hl_3
L_c1_kernel_g1_ho_4:
  s_mov_b64 exec, -1
L_c1_kernel_g1_hs_2:
  s_barrier
  s_add_u32 m0, s36, 16384
  s_add_u32 s37, s35, 0
  buffer_load_dwordx4 v7, s[12:15], s37 offen lds
  s_add_u32 s37, s35, 7168
  buffer_load_dwordx4 v8, s[12:15], s37 offen offset:1024 lds
  s_add_u32 m0, s36, 49152
  s_add_u32 s37, s35, 128
  buffer_load_dwordx4 v7, s[12:15], s37 offen lds
  s_add_u32 s37, s35, 7296
  buffer_load_dwordx4 v8, s[12:15], s37 offen offset:1024 lds
  s_add_u32 m0, s36, 81920
  s_add_u32 s37, s35, 256
  buffer_load_dwordx4 v7, s[12:15], s37 offen lds
  s_add_u32 s37, s35, 7424
  buffer_load_dwordx4 v8, s[12:15], s37 offen offset:1024 lds
  s_mov_b32 s24, s4
  s_mov_b32 s25, s5
  s_mov_b32 s26, 3584
  s_mov_b32 s27, 0x00020000
  s_add_u32 s28, s6, 16777216
  s_addc_u32 s29, s7, 0
  s_mov_b32 s30, 7340032
  s_mov_b32 s31, 0x00020000
  v_lshrrev_b32 v9, 5, v1
  v_lshlrev_b32 v10, 3, v9
  s_lshl_b32 s32, s17, 8
  s_lshl_b32 s33, s18, 7
  s_add_u32 s32, s32, s33
  s_lshl_b32 s38, s18, 13
  v_add_u32 v11, s38, v3
  v_add_u32 v12, 0x10000, v11
  v_and_b32 v13, 31, v1
  v_bfe_u32 v14, v1, 1, 3
  v_xor_b32 v14, v14, v9
  v_lshlrev_b32 v14, 4, v14
  v_lshl_add_u32 v13, v13, 7, v14
  s_lshl_b32 s38, s19, 12
  s_add_u32 s38, s38, 16384
  v_add_u32 v13, s38, v13
  v_xor_b32 v16, 0, v13
  v_add_u32 v20, 0x10000, v16
  v_xor_b32 v17, 32, v13
  v_add_u32 v21, 0x10000, v17
  v_xor_b32 v18, 64, v13
  v_add_u32 v22, 0x10000, v18
  v_xor_b32 v19, 96, v13
  v_add_u32 v23, 0x10000, v19
  v_mov_b32 v32, 0
  v_mov_b32 v33, 0
  v_mov_b32 v34, 0
  v_mov_b32 v35, 0
  v_mov_b32 v36, 0
  v_mov_b32 v37, 0
  v_mov_b32 v38, 0
  v_mov_b32 v39, 0
  v_mov_b32 v40, 0
  v_mov_b32 v41, 0
  v_mov_b32 v42, 0
  v_mov_b32 v43, 0
  v_mov_b32 v44, 0
  v_mov_b32 v45, 0
  v_mov_b32 v46, 0
  v_mov_b32 v47, 0
  v_mov_b32 v48, 0
  v_mov_b32 v49, 0
  v_mov_b32 v50, 0
  v_mov_b32 v51, 0
  v_mov_b32 v52, 0
  v_mov_b32 v53, 0
  v_mov_b32 v54, 0
  v_mov_b32 v55, 0
  v_mov_b32 v56, 0
  v_mov_b32 v57, 0
  v_mov_b32 v58, 0
  v_mov_b32 v59, 0
  v_mov_b32 v60, 0
  v_mov_b32 v61, 0
  v_mov_b32 v62, 0
  v_mov_b32 v63, 0
  s_waitcnt vmcnt(4)
  s_barrier
  ds_read_b128 v[64:67], v11 offset:0
  ds_read_b128 v[68:71], v11 offset:4096
  ds_read_b128 v[72:75], v16 offset:0
  s_waitcnt lgkmcnt(0)
  ds_read_b128 v[80:83], v11 offset:1024
  ds_read_b128 v[84:87], v11 offset:5120
  ds_read_b128 v[88:91], v17 offset:0
  v_mfma_f32_32x32x16_bf16 v[32:47], v[64:67], v[72:75], v[32:47]
  s_add_u32 m0, s36, 98304
  s_add_u32 s37, s34, 12288
  buffer_load_dwordx4 v3, s[8:11], s37 offen lds
  v_mfma_f32_32x32x16_bf16 v[48:63], v[68:71], v[72:75], v[48:63]
  buffer_load_dwordx4 v3, s[8:11], s37 offen offset:1024 lds
  s_waitcnt lgkmcnt(0)
  ds_read_b128 v[64:67], v11 offset:2048
  ds_read_b128 v[68:71], v11 offset:6144
  ds_read_b128 v[72:75], v18 offset:0
  v_mfma_f32_32x32x16_bf16 v[32:47], v[80:83], v[88:91], v[32:47]
  s_add_u32 m0, s36, 114688
  s_add_u32 s37, s35, 384
  buffer_load_dwordx4 v7, s[12:15], s37 offen lds
  v_mfma_f32_32x32x16_bf16 v[48:63], v[84:87], v[88:91], v[48:63]
  s_add_u32 s37, s35, 7552
  buffer_load_dwordx4 v8, s[12:15], s37 offen offset:1024 lds
  s_waitcnt lgkmcnt(0)
  ds_read_b128 v[80:83], v11 offset:3072
  ds_read_b128 v[84:87], v11 offset:7168
  ds_read_b128 v[88:91], v19 offset:0
  v_mfma_f32_32x32x16_bf16 v[32:47], v[64:67], v[72:75], v[32:47]
  v_mfma_f32_32x32x16_bf16 v[48:63], v[68:71], v[72:75], v[48:63]
  s_waitcnt lgkmcnt(0)
  s_waitcnt vmcnt(6)
  s_barrier
  ds_read_b128 v[64:67], v11 offset:32768
  ds_read_b128 v[68:71], v11 offset:36864
  ds_read_b128 v[72:75], v16 offset:32768
  v_mfma_f32_32x32x16_bf16 v[32:47], v[80:83], v[88:91], v[32:47]
  s_add_u32 m0, s36, 0
  s_add_u32 s37, s34, 16384
  buffer_load_dwordx4 v3, s[8:11], s37 offen lds
  v_mfma_f32_32x32x16_bf16 v[48:63], v[84:87], v[88:91], v[48:63]
  buffer_load_dwordx4 v3, s[8:11], s37 offen offset:1024 lds
  s_waitcnt lgkmcnt(0)
  ds_read_b128 v[80:83], v11 offset:33792
  ds_read_b128 v[84:87], v11 offset:37888
  ds_read_b128 v[88:91], v17 offset:32768
  v_mfma_f32_32x32x16_bf16 v[32:47], v[64:67], v[72:75], v[32:47]
  s_add_u32 m0, s36, 16384
  s_add_u32 s37, s35, 512
  buffer_load_dwordx4 v7, s[12:15], s37 offen lds
  v_mfma_f32_32x32x16_bf16 v[48:63], v[68:71], v[72:75], v[48:63]
  s_add_u32 s37, s35, 7680
  buffer_load_dwordx4 v8, s[12:15], s37 offen offset:1024 lds
  s_waitcnt lgkmcnt(0)
  ds_read_b128 v[64:67], v11 offset:34816
  ds_read_b128 v[68:71], v11 offset:38912
  ds_read_b128 v[72:75], v18 offset:32768
  v_mfma_f32_32x32x16_bf16 v[32:47], v[80:83], v[88:91], v[32:47]
  v_mfma_f32_32x32x16_bf16 v[48:63], v[84:87], v[88:91], v[48:63]
  s_waitcnt lgkmcnt(0)
  ds_read_b128 v[80:83], v11 offset:35840
  ds_read_b128 v[84:87], v11 offset:39936
  ds_read_b128 v[88:91], v19 offset:32768
  v_mfma_f32_32x32x16_bf16 v[32:47], v[64:67], v[72:75], v[32:47]
  v_mfma_f32_32x32x16_bf16 v[48:63], v[68:71], v[72:75], v[48:63]
  s_waitcnt lgkmcnt(0)
  s_waitcnt vmcnt(8)
  s_barrier
  ds_read_b128 v[64:67], v12 offset:0
  ds_read_b128 v[68:71], v12 offset:4096
  ds_read_b128 v[72:75], v20 offset:0
  v_mfma_f32_32x32x16_bf16 v[32:47], v[80:83], v[88:91], v[32:47]
  s_add_u32 m0, s36, 32768
  s_add_u32 s37, s34, 20480
  buffer_load_dwordx4 v3, s[8:11], s37 offen lds
  v_mfma_f32_32x32x16_bf16 v[48:63], v[84:87], v[88:91], v[48:63]
  buffer_load_dwordx4 v3, s[8:11], s37 offen offset:1024 lds
  s_waitcnt lgkmcnt(0)
  ds_read_b128 v[80:83], v12 offset:1024
  ds_read_b128 v[84:87], v12 offset:5120
  ds_read_b128 v[88:91], v21 offset:0
  v_mfma_f32_32x32x16_bf16 v[32:47], v[64:67], v[72:75], v[32:47]
  s_add_u32 m0, s36, 49152
  s_add_u32 s37, s35, 640
  buffer_load_dwordx4 v7, s[12:15], s37 offen lds
  v_mfma_f32_32x32x16_bf16 v[48:63], v[68:71], v[72:75], v[48:63]
  s_add_u32 s37, s35, 7808
  buffer_load_dwordx4 v8, s[12:15], s37 offen offset:1024 lds
  s_waitcnt lgkmcnt(0)
  ds_read_b128 v[64:67], v12 offset:2048
  ds_read_b128 v[68:71], v12 offset:6144
  ds_read_b128 v[72:75], v22 offset:0
  v_mfma_f32_32x32x16_bf16 v[32:47], v[80:83], v[88:91], v[32:47]
  v_mfma_f32_32x32x16_bf16 v[48:63], v[84:87], v[88:91], v[48:63]
  s_waitcnt lgkmcnt(0)
  ds_read_b128 v[80:83], v12 offset:3072
  ds_read_b128 v[84:87], v12 offset:7168
  ds_read_b128 v[88:91], v23 offset:0
  v_mfma_f32_32x32x16_bf16 v[32:47], v[64:67], v[72:75], v[32:47]
  v_mfma_f32_32x32x16_bf16 v[48:63], v[68:71], v[72:75], v[48:63]
  s_waitcnt lgkmcnt(0)
  s_waitcnt vmcnt(8)
  s_barrier
  ds_read_b128 v[64:67], v12 offset:32768
  ds_read_b128 v[68:71], v12 offset:36864
  ds_read_b128 v[72:75], v20 offset:32768
  v_mfma_f32_32x32x16_bf16 v[32:47], v[80:83], v[88:91], v[32:47]
  s_add_u32 m0, s36, 65536
  s_add_u32 s37, s34, 24576
  buffer_load_dwordx4 v3, s[8:11], s37 offen lds
  v_mfma_f32_32x32x16_bf16 v[48:63], v[84:87], v[88:91], v[48:63]
  buffer_load_dwordx4 v3, s[8:11], s37 offen offset:1024 lds
  s_waitcnt lgkmcnt(0)
  ds_read_b128 v[80:83], v12 offset:33792
  ds_read_b128 v[84:87], v12 offset:37888
  ds_read_b128 v[88:91], v21 offset:32768
  v_mfma_f32_32x32x16_bf16 v[32:47], v[64:67], v[72:75], v[32:47]
  s_add_u32 m0, s36, 81920
  s_add_u32 s37, s35, 768
  buffer_load_dwordx4 v7, s[12:15], s37 offen lds
  v_mfma_f32_32x32x16_bf16 v[48:63], v[68:71], v[72:75], v[48:63]
  s_add_u32 s37, s35, 7936
  buffer_load_dwordx4 v8, s[12:15], s37 offen offset:1024 lds
  s_waitcnt lgkmcnt(0)
  ds_read_b128 v[64:67], v12 offset:34816
  ds_read_b128 v[68:71], v12 offset:38912
  ds_read_b128 v[72:75], v22 offset:32768
  v_mfma_f32_32x32x16_bf16 v[32:47], v[80:83], v[88:91], v[32:47]
  v_mfma_f32_32x32x16_bf16 v[48:63], v[84:87], v[88:91], v[48:63]
  s_waitcnt lgkmcnt(0)
  ds_read_b128 v[80:83], v12 offset:35840
  ds_read_b128 v[84:87], v12 offset:39936
  ds_read_b128 v[88:91], v23 offset:32768
  v_mfma_f32_32x32x16_bf16 v[32:47], v[64:67], v[72:75], v[32:47]
  v_mfma_f32_32x32x16_bf16 v[48:63], v[68:71], v[72:75], v[48:63]
  s_waitcnt lgkmcnt(0)
  s_waitcnt vmcnt(8)
  s_barrier
  ds_read_b128 v[64:67], v11 offset:0
  ds_read_b128 v[68:71], v11 offset:4096
  ds_read_b128 v[72:75], v16 offset:0
  v_mfma_f32_32x32x16_bf16 v[32:47], v[80:83], v[88:91], v[32:47]
  s_add_u32 m0, s36, 98304
  s_add_u32 s37, s34, 28672
  buffer_load_dwordx4 v3, s[8:11], s37 offen lds
  v_mfma_f32_32x32x16_bf16 v[48:63], v[84:87], v[88:91], v[48:63]
  buffer_load_dwordx4 v3, s[8:11], s37 offen offset:1024 lds
  s_waitcnt lgkmcnt(0)
  ds_read_b128 v[80:83], v11 offset:1024
  ds_read_b128 v[84:87], v11 offset:5120
  ds_read_b128 v[88:91], v17 offset:0
  v_mfma_f32_32x32x16_bf16 v[32:47], v[64:67], v[72:75], v[32:47]
  s_add_u32 m0, s36, 114688
  s_add_u32 s37, s35, 896
  buffer_load_dwordx4 v7, s[12:15], s37 offen lds
  v_mfma_f32_32x32x16_bf16 v[48:63], v[68:71], v[72:75], v[48:63]
  s_add_u32 s37, s35, 8064
  buffer_load_dwordx4 v8, s[12:15], s37 offen offset:1024 lds
  s_waitcnt lgkmcnt(0)
  ds_read_b128 v[64:67], v11 offset:2048
  ds_read_b128 v[68:71], v11 offset:6144
  ds_read_b128 v[72:75], v18 offset:0
  v_mfma_f32_32x32x16_bf16 v[32:47], v[80:83], v[88:91], v[32:47]
  v_mfma_f32_32x32x16_bf16 v[48:63], v[84:87], v[88:91], v[48:63]
  s_waitcnt lgkmcnt(0)
  ds_read_b128 v[80:83], v11 offset:3072
  ds_read_b128 v[84:87], v11 offset:7168
  ds_read_b128 v[88:91], v19 offset:0
  v_mfma_f32_32x32x16_bf16 v[32:47], v[64:67], v[72:75], v[32:47]
  v_mfma_f32_32x32x16_bf16 v[48:63], v[68:71], v[72:75], v[48:63]
  s_waitcnt lgkmcnt(0)
  s_waitcnt vmcnt(8)
  s_barrier
  ds_read_b128 v[64:67], v11 offset:32768
  ds_read_b128 v[68:71], v11 offset:36864
  ds_read_b128 v[72:75], v16 offset:32768
  v_mfma_f32_32x32x16_bf16 v[32:47], v[80:83], v[88:91], v[32:47]
  buffer_load_dwordx2 v[96:97], v10, s[24:27], s32 offen offset:0
  v_mfma_f32_32x32x16_bf16 v[48:63], v[84:87], v[88:91], v[48:63]
  buffer_load_dwordx2 v[98:99], v10, s[24:27], s32 offen offset:16
  s_waitcnt lgkmcnt(0)
  ds_read_b128 v[80:83], v11 offset:33792
  ds_read_b128 v[84:87], v11 offset:37888
  ds_read_b128 v[88:91], v17 offset:32768
  v_mfma_f32_32x32x16_bf16 v[32:47], v[64:67], v[72:75], v[32:47]
  buffer_load_dwordx2 v[100:101], v10, s[24:27], s32 offen offset:32
  v_mfma_f32_32x32x16_bf16 v[48:63], v[68:71], v[72:75], v[48:63]
  buffer_load_dwordx2 v[102:103], v10, s[24:27], s32 offen offset:48
  s_waitcnt lgkmcnt(0)
  ds_read_b128 v[64:67], v11 offset:34816
  ds_read_b128 v[68:71], v11 offset:38912
  ds_read_b128 v[72:75], v18 offset:32768
  v_mfma_f32_32x32x16_bf16 v[32:47], v[80:83], v[88:91], v[32:47]
  buffer_load_dwordx2 v[104:105], v10, s[24:27], s32 offen offset:64
  v_mfma_f32_32x32x16_bf16 v[48:63], v[84:87], v[88:91], v[48:63]
  buffer_load_dwordx2 v[106:107], v10, s[24:27], s32 offen offset:80
  s_waitcnt lgkmcnt(0)
  ds_read_b128 v[80:83], v11 offset:35840
  ds_read_b128 v[84:87], v11 offset:39936
  ds_read_b128 v[88:91], v19 offset:32768
  v_mfma_f32_32x32x16_bf16 v[32:47], v[64:67], v[72:75], v[32:47]
  buffer_load_dwordx2 v[108:109], v10, s[24:27], s32 offen offset:96
  v_mfma_f32_32x32x16_bf16 v[48:63], v[68:71], v[72:75], v[48:63]
  buffer_load_dwordx2 v[110:111], v10, s[24:27], s32 offen offset:112
  s_waitcnt lgkmcnt(0)
  s_waitcnt vmcnt(12)
  s_barrier
  ds_read_b128 v[64:67], v12 offset:0
  ds_read_b128 v[68:71], v12 offset:4096
  ds_read_b128 v[72:75], v20 offset:0
  v_mfma_f32_32x32x16_bf16 v[32:47], v[80:83], v[88:91], v[32:47]
  v_mfma_f32_32x32x16_bf16 v[48:63], v[84:87], v[88:91], v[48:63]
  s_waitcnt lgkmcnt(0)
  ds_read_b128 v[80:83], v12 offset:1024
  ds_read_b128 v[84:87], v12 offset:5120
  ds_read_b128 v[88:91], v21 offset:0
  v_mfma_f32_32x32x16_bf16 v[32:47], v[64:67], v[72:75], v[32:47]
  v_mfma_f32_32x32x16_bf16 v[48:63], v[68:71], v[72:75], v[48:63]
  s_waitcnt lgkmcnt(0)
  ds_read_b128 v[64:67], v12 offset:2048
  ds_read_b128 v[68:71], v12 offset:6144
  ds_read_b128 v[72:75], v22 offset:0
  v_mfma_f32_32x32x16_bf16 v[32:47], v[80:83], v[88:91], v[32:47]
  v_mfma_f32_32x32x16_bf16 v[48:63], v[84:87], v[88:91], v[48:63]
  s_waitcnt lgkmcnt(0)
  ds_read_b128 v[80:83], v12 offset:3072
  ds_read_b128 v[84:87], v12 offset:7168
  ds_read_b128 v[88:91], v23 offset:0
  v_mfma_f32_32x32x16_bf16 v[32:47], v[64:67], v[72:75], v[32:47]
  v_mfma_f32_32x32x16_bf16 v[48:63], v[68:71], v[72:75], v[48:63]
  s_waitcnt lgkmcnt(0)
  s_waitcnt vmcnt(8)
  s_barrier
  ds_read_b128 v[64:67], v12 offset:32768
  ds_read_b128 v[68:71], v12 offset:36864
  ds_read_b128 v[72:75], v20 offset:32768
  v_mfma_f32_32x32x16_bf16 v[32:47], v[80:83], v[88:91], v[32:47]
  v_mfma_f32_32x32x16_bf16 v[48:63], v[84:87], v[88:91], v[48:63]
  s_waitcnt lgkmcnt(0)
  ds_read_b128 v[80:83], v12 offset:33792
  ds_read_b128 v[84:87], v12 offset:37888
  ds_read_b128 v[88:91], v21 offset:32768
  v_mfma_f32_32x32x16_bf16 v[32:47], v[64:67], v[72:75], v[32:47]
  v_mfma_f32_32x32x16_bf16 v[48:63], v[68:71], v[72:75], v[48:63]
  s_waitcnt lgkmcnt(0)
  ds_read_b128 v[64:67], v12 offset:34816
  ds_read_b128 v[68:71], v12 offset:38912
  ds_read_b128 v[72:75], v22 offset:32768
  v_mfma_f32_32x32x16_bf16 v[32:47], v[80:83], v[88:91], v[32:47]
  v_mfma_f32_32x32x16_bf16 v[48:63], v[84:87], v[88:91], v[48:63]
  s_waitcnt lgkmcnt(0)
  ds_read_b128 v[80:83], v12 offset:35840
  ds_read_b128 v[84:87], v12 offset:39936
  ds_read_b128 v[88:91], v23 offset:32768
  v_mfma_f32_32x32x16_bf16 v[32:47], v[64:67], v[72:75], v[32:47]
  v_mfma_f32_32x32x16_bf16 v[48:63], v[68:71], v[72:75], v[48:63]
  s_waitcnt lgkmcnt(0)
  v_mfma_f32_32x32x16_bf16 v[32:47], v[80:83], v[88:91], v[32:47]
  v_mfma_f32_32x32x16_bf16 v[48:63], v[84:87], v[88:91], v[48:63]
  v_mov_b32 v112, 0xc0135761
  v_mov_b32 v113, 0xc0135761
  s_mov_b32 s42, 0xbdd2d3e8
  s_mov_b32 s43, 0xbdd2d3e8
  s_mov_b32 s44, 1.0
  s_mov_b32 s45, 1.0
  s_lshl_b32 s46, s16, 2
  s_add_u32 s46, s46, s19
  s_mul_i32 s46, s46, 112
  s_lshl_b32 s47, s17, 3
  s_add_u32 s46, s46, s47
  s_lshl_b32 s47, s18, 2
  s_add_u32 s46, s46, s47
  s_lshl_b32 s46, s46, 10
  s_waitcnt vmcnt(0)
  s_nop 4
  v_lshlrev_b32 v64, 16, v96
  v_and_b32 v65, 0xffff0000, v96
  v_lshlrev_b32 v66, 16, v97
  v_and_b32 v67, 0xffff0000, v97
  v_lshlrev_b32 v68, 16, v98
  v_and_b32 v69, 0xffff0000, v98
  v_lshlrev_b32 v70, 16, v99
  v_and_b32 v71, 0xffff0000, v99
  v_lshlrev_b32 v72, 16, v100
  v_and_b32 v73, 0xffff0000, v100
  v_lshlrev_b32 v74, 16, v101
  v_and_b32 v75, 0xffff0000, v101
  v_lshlrev_b32 v76, 16, v102
  v_and_b32 v77, 0xffff0000, v102
  v_lshlrev_b32 v78, 16, v103
  v_and_b32 v79, 0xffff0000, v103
  v_lshlrev_b32 v80, 16, v104
  v_and_b32 v81, 0xffff0000, v104
  v_lshlrev_b32 v82, 16, v105
  v_and_b32 v83, 0xffff0000, v105
  v_lshlrev_b32 v84, 16, v106
  v_and_b32 v85, 0xffff0000, v106
  v_lshlrev_b32 v86, 16, v107
  v_and_b32 v87, 0xffff0000, v107
  v_lshlrev_b32 v88, 16, v108
  v_and_b32 v89, 0xffff0000, v108
  v_lshlrev_b32 v90, 16, v109
  v_and_b32 v91, 0xffff0000, v109
  v_lshlrev_b32 v92, 16, v110
  v_and_b32 v93, 0xffff0000, v110
  v_lshlrev_b32 v94, 16, v111
  v_and_b32 v95, 0xffff0000, v111
  v_cvt_pk_bf16_f32 v96, v32, v33
  v_cvt_pk_bf16_f32 v98, v34, v35
  v_cvt_pk_bf16_f32 v100, v36, v37
  v_cvt_pk_bf16_f32 v102, v38, v39
  v_lshlrev_b32 v32, 16, v96
  v_and_b32 v33, 0xffff0000, v96
  v_lshlrev_b32 v34, 16, v98
  v_and_b32 v35, 0xffff0000, v98
  v_lshlrev_b32 v36, 16, v100
  v_and_b32 v37, 0xffff0000, v100
  v_lshlrev_b32 v38, 16, v102
  v_and_b32 v39, 0xffff0000, v102
  v_pk_add_f32 v[32:33], v[32:33], v[64:65]
  v_pk_add_f32 v[34:35], v[34:35], v[66:67]
  v_pk_add_f32 v[36:37], v[36:37], v[68:69]
  v_pk_add_f32 v[38:39], v[38:39], v[70:71]
  v_cvt_pk_bf16_f32 v96, v32, v33
  v_cvt_pk_bf16_f32 v98, v34, v35
  v_cvt_pk_bf16_f32 v100, v36, v37
  v_cvt_pk_bf16_f32 v102, v38, v39
  v_lshlrev_b32 v32, 16, v96
  v_and_b32 v33, 0xffff0000, v96
  v_lshlrev_b32 v34, 16, v98
  v_and_b32 v35, 0xffff0000, v98
  v_lshlrev_b32 v36, 16, v100
  v_and_b32 v37, 0xffff0000, v100
  v_lshlrev_b32 v38, 16, v102
  v_and_b32 v39, 0xffff0000, v102
  v_pk_mul_f32 v[96:97], v[32:33], v[32:33]
  v_pk_mul_f32 v[98:99], v[34:35], v[34:35]
  v_pk_mul_f32 v[100:101], v[36:37], v[36:37]
  v_pk_mul_f32 v[102:103], v[38:39], v[38:39]
  v_pk_fma_f32 v[96:97], v[96:97], s[42:43], v[112:113]
  v_pk_fma_f32 v[98:99], v[98:99], s[42:43], v[112:113]
  v_pk_fma_f32 v[100:101], v[100:101], s[42:43], v[112:113]
  v_pk_fma_f32 v[102:103], v[102:103], s[42:43], v[112:113]
  v_pk_mul_f32 v[96:97], v[96:97], v[32:33]
  v_pk_mul_f32 v[98:99], v[98:99], v[34:35]
  v_pk_mul_f32 v[100:101], v[100:101], v[36:37]
  v_pk_mul_f32 v[102:103], v[102:103], v[38:39]
  v_exp_f32 v96, v96
  v_exp_f32 v97, v97
  v_exp_f32 v98, v98
  v_exp_f32 v99, v99
  v_exp_f32 v100, v100
  v_exp_f32 v101, v101
  v_exp_f32 v102, v102
  v_exp_f32 v103, v103
  s_nop 0
  v_pk_add_f32 v[96:97], v[96:97], s[44:45]
  v_pk_add_f32 v[98:99], v[98:99], s[44:45]
  v_pk_add_f32 v[100:101], v[100:101], s[44:45]
  v_pk_add_f32 v[102:103], v[102:103], s[44:45]
  v_rcp_f32 v96, v96
  v_rcp_f32 v97, v97
  v_rcp_f32 v98, v98
  v_rcp_f32 v99, v99
  v_rcp_f32 v100, v100
  v_rcp_f32 v101, v101
  v_rcp_f32 v102, v102
  v_rcp_f32 v103, v103
  s_nop 0
  v_pk_mul_f32 v[32:33], v[32:33], v[96:97]
  v_pk_mul_f32 v[34:35], v[34:35], v[98:99]
  v_pk_mul_f32 v[36:37], v[36:37], v[100:101]
  v_pk_mul_f32 v[38:39], v[38:39], v[102:103]
  v_cvt_pk_bf16_f32 v116, v32, v33
  v_cvt_pk_bf16_f32 v117, v34, v35
  v_cvt_pk_bf16_f32 v118, v36, v37
  v_cvt_pk_bf16_f32 v119, v38, v39
  buffer_store_dwordx4 v[116:119], v3, s[28:31], s46 offen offset:0 sc1
  v_cvt_pk_bf16_f32 v96, v40, v41
  v_cvt_pk_bf16_f32 v98, v42, v43
  v_cvt_pk_bf16_f32 v100, v44, v45
  v_cvt_pk_bf16_f32 v102, v46, v47
  v_lshlrev_b32 v40, 16, v96
  v_and_b32 v41, 0xffff0000, v96
  v_lshlrev_b32 v42, 16, v98
  v_and_b32 v43, 0xffff0000, v98
  v_lshlrev_b32 v44, 16, v100
  v_and_b32 v45, 0xffff0000, v100
  v_lshlrev_b32 v46, 16, v102
  v_and_b32 v47, 0xffff0000, v102
  v_pk_add_f32 v[40:41], v[40:41], v[72:73]
  v_pk_add_f32 v[42:43], v[42:43], v[74:75]
  v_pk_add_f32 v[44:45], v[44:45], v[76:77]
  v_pk_add_f32 v[46:47], v[46:47], v[78:79]
  v_cvt_pk_bf16_f32 v96, v40, v41
  v_cvt_pk_bf16_f32 v98, v42, v43
  v_cvt_pk_bf16_f32 v100, v44, v45
  v_cvt_pk_bf16_f32 v102, v46, v47
  v_lshlrev_b32 v40, 16, v96
  v_and_b32 v41, 0xffff0000, v96
  v_lshlrev_b32 v42, 16, v98
  v_and_b32 v43, 0xffff0000, v98
  v_lshlrev_b32 v44, 16, v100
  v_and_b32 v45, 0xffff0000, v100
  v_lshlrev_b32 v46, 16, v102
  v_and_b32 v47, 0xffff0000, v102
  v_pk_mul_f32 v[96:97], v[40:41], v[40:41]
  v_pk_mul_f32 v[98:99], v[42:43], v[42:43]
  v_pk_mul_f32 v[100:101], v[44:45], v[44:45]
  v_pk_mul_f32 v[102:103], v[46:47], v[46:47]
  v_pk_fma_f32 v[96:97], v[96:97], s[42:43], v[112:113]
  v_pk_fma_f32 v[98:99], v[98:99], s[42:43], v[112:113]
  v_pk_fma_f32 v[100:101], v[100:101], s[42:43], v[112:113]
  v_pk_fma_f32 v[102:103], v[102:103], s[42:43], v[112:113]
  v_pk_mul_f32 v[96:97], v[96:97], v[40:41]
  v_pk_mul_f32 v[98:99], v[98:99], v[42:43]
  v_pk_mul_f32 v[100:101], v[100:101], v[44:45]
  v_pk_mul_f32 v[102:103], v[102:103], v[46:47]
  v_exp_f32 v96, v96
  v_exp_f32 v97, v97
  v_exp_f32 v98, v98
  v_exp_f32 v99, v99
  v_exp_f32 v100, v100
  v_exp_f32 v101, v101
  v_exp_f32 v102, v102
  v_exp_f32 v103, v103
  s_nop 0
  v_pk_add_f32 v[96:97], v[96:97], s[44:45]
  v_pk_add_f32 v[98:99], v[98:99], s[44:45]
  v_pk_add_f32 v[100:101], v[100:101], s[44:45]
  v_pk_add_f32 v[102:103], v[102:103], s[44:45]
  v_rcp_f32 v96, v96
  v_rcp_f32 v97, v97
  v_rcp_f32 v98, v98
  v_rcp_f32 v99, v99
  v_rcp_f32 v100, v100
  v_rcp_f32 v101, v101
  v_rcp_f32 v102, v102
  v_rcp_f32 v103, v103
  s_nop 0
  v_pk_mul_f32 v[40:41], v[40:41], v[96:97]
  v_pk_mul_f32 v[42:43], v[42:43], v[98:99]
  v_pk_mul_f32 v[44:45], v[44:45], v[100:101]
  v_pk_mul_f32 v[46:47], v[46:47], v[102:103]
  v_cvt_pk_bf16_f32 v120, v40, v41
  v_cvt_pk_bf16_f32 v121, v42, v43
  v_cvt_pk_bf16_f32 v122, v44, v45
  v_cvt_pk_bf16_f32 v123, v46, v47
  buffer_store_dwordx4 v[120:123], v3, s[28:31], s46 offen offset:1024 sc1
  v_cvt_pk_bf16_f32 v96, v48, v49
  v_cvt_pk_bf16_f32 v98, v50, v51
  v_cvt_pk_bf16_f32 v100, v52, v53
  v_cvt_pk_bf16_f32 v102, v54, v55
  v_lshlrev_b32 v48, 16, v96
  v_and_b32 v49, 0xffff0000, v96
  v_lshlrev_b32 v50, 16, v98
  v_and_b32 v51, 0xffff0000, v98
  v_lshlrev_b32 v52, 16, v100
  v_and_b32 v53, 0xffff0000, v100
  v_lshlrev_b32 v54, 16, v102
  v_and_b32 v55, 0xffff0000, v102
  v_pk_add_f32 v[48:49], v[48:49], v[80:81]
  v_pk_add_f32 v[50:51], v[50:51], v[82:83]
  v_pk_add_f32 v[52:53], v[52:53], v[84:85]
  v_pk_add_f32 v[54:55], v[54:55], v[86:87]
  v_cvt_pk_bf16_f32 v96, v48, v49
  v_cvt_pk_bf16_f32 v98, v50, v51
  v_cvt_pk_bf16_f32 v100, v52, v53
  v_cvt_pk_bf16_f32 v102, v54, v55
  v_lshlrev_b32 v48, 16, v96
  v_and_b32 v49, 0xffff0000, v96
  v_lshlrev_b32 v50, 16, v98
  v_and_b32 v51, 0xffff0000, v98
  v_lshlrev_b32 v52, 16, v100
  v_and_b32 v53, 0xffff0000, v100
  v_lshlrev_b32 v54, 16, v102
  v_and_b32 v55, 0xffff0000, v102
  v_pk_mul_f32 v[96:97], v[48:49], v[48:49]
  v_pk_mul_f32 v[98:99], v[50:51], v[50:51]
  v_pk_mul_f32 v[100:101], v[52:53], v[52:53]
  v_pk_mul_f32 v[102:103], v[54:55], v[54:55]
  v_pk_fma_f32 v[96:97], v[96:97], s[42:43], v[112:113]
  v_pk_fma_f32 v[98:99], v[98:99], s[42:43], v[112:113]
  v_pk_fma_f32 v[100:101], v[100:101], s[42:43], v[112:113]
  v_pk_fma_f32 v[102:103], v[102:103], s[42:43], v[112:113]
  v_pk_mul_f32 v[96:97], v[96:97], v[48:49]
  v_pk_mul_f32 v[98:99], v[98:99], v[50:51]
  v_pk_mul_f32 v[100:101], v[100:101], v[52:53]
  v_pk_mul_f32 v[102:103], v[102:103], v[54:55]
  v_exp_f32 v96, v96
  v_exp_f32 v97, v97
  v_exp_f32 v98, v98
  v_exp_f32 v99, v99
  v_exp_f32 v100, v100
  v_exp_f32 v101, v101
  v_exp_f32 v102, v102
  v_exp_f32 v103, v103
  s_nop 0
  v_pk_add_f32 v[96:97], v[96:97], s[44:45]
  v_pk_add_f32 v[98:99], v[98:99], s[44:45]
  v_pk_add_f32 v[100:101], v[100:101], s[44:45]
  v_pk_add_f32 v[102:103], v[102:103], s[44:45]
  v_rcp_f32 v96, v96
  v_rcp_f32 v97, v97
  v_rcp_f32 v98, v98
  v_rcp_f32 v99, v99
  v_rcp_f32 v100, v100
  v_rcp_f32 v101, v101
  v_rcp_f32 v102, v102
  v_rcp_f32 v103, v103
  s_nop 0
  v_pk_mul_f32 v[48:49], v[48:49], v[96:97]
  v_pk_mul_f32 v[50:51], v[50:51], v[98:99]
  v_pk_mul_f32 v[52:53], v[52:53], v[100:101]
  v_pk_mul_f32 v[54:55], v[54:55], v[102:103]
  v_cvt_pk_bf16_f32 v124, v48, v49
  v_cvt_pk_bf16_f32 v125, v50, v51
  v_cvt_pk_bf16_f32 v126, v52, v53
  v_cvt_pk_bf16_f32 v127, v54, v55
  buffer_store_dwordx4 v[124:127], v3, s[28:31], s46 offen offset:2048 sc1
  v_cvt_pk_bf16_f32 v96, v56, v57
  v_cvt_pk_bf16_f32 v98, v58, v59
  v_cvt_pk_bf16_f32 v100, v60, v61
  v_cvt_pk_bf16_f32 v102, v62, v63
  v_lshlrev_b32 v56, 16, v96
  v_and_b32 v57, 0xffff0000, v96
  v_lshlrev_b32 v58, 16, v98
  v_and_b32 v59, 0xffff0000, v98
  v_lshlrev_b32 v60, 16, v100
  v_and_b32 v61, 0xffff0000, v100
  v_lshlrev_b32 v62, 16, v102
  v_and_b32 v63, 0xffff0000, v102
  v_pk_add_f32 v[56:57], v[56:57], v[88:89]
  v_pk_add_f32 v[58:59], v[58:59], v[90:91]
  v_pk_add_f32 v[60:61], v[60:61], v[92:93]
  v_pk_add_f32 v[62:63], v[62:63], v[94:95]
  v_cvt_pk_bf16_f32 v96, v56, v57
  v_cvt_pk_bf16_f32 v98, v58, v59
  v_cvt_pk_bf16_f32 v100, v60, v61
  v_cvt_pk_bf16_f32 v102, v62, v63
  v_lshlrev_b32 v56, 16, v96
  v_and_b32 v57, 0xffff0000, v96
  v_lshlrev_b32 v58, 16, v98
  v_and_b32 v59, 0xffff0000, v98
  v_lshlrev_b32 v60, 16, v100
  v_and_b32 v61, 0xffff0000, v100
  v_lshlrev_b32 v62, 16, v102
  v_and_b32 v63, 0xffff0000, v102
  v_pk_mul_f32 v[96:97], v[56:57], v[56:57]
  v_pk_mul_f32 v[98:99], v[58:59], v[58:59]
  v_pk_mul_f32 v[100:101], v[60:61], v[60:61]
  v_pk_mul_f32 v[102:103], v[62:63], v[62:63]
  v_pk_fma_f32 v[96:97], v[96:97], s[42:43], v[112:113]
  v_pk_fma_f32 v[98:99], v[98:99], s[42:43], v[112:113]
  v_pk_fma_f32 v[100:101], v[100:101], s[42:43], v[112:113]
  v_pk_fma_f32 v[102:103], v[102:103], s[42:43], v[112:113]
  v_pk_mul_f32 v[96:97], v[96:97], v[56:57]
  v_pk_mul_f32 v[98:99], v[98:99], v[58:59]
  v_pk_mul_f32 v[100:101], v[100:101], v[60:61]
  v_pk_mul_f32 v[102:103], v[102:103], v[62:63]
  v_exp_f32 v96, v96
  v_exp_f32 v97, v97
  v_exp_f32 v98, v98
  v_exp_f32 v99, v99
  v_exp_f32 v100, v100
  v_exp_f32 v101, v101
  v_exp_f32 v102, v102
  v_exp_f32 v103, v103
  s_nop 0
  v_pk_add_f32 v[96:97], v[96:97], s[44:45]
  v_pk_add_f32 v[98:99], v[98:99], s[44:45]
  v_pk_add_f32 v[100:101], v[100:101], s[44:45]
  v_pk_add_f32 v[102:103], v[102:103], s[44:45]
  v_rcp_f32 v96, v96
  v_rcp_f32 v97, v97
  v_rcp_f32 v98, v98
  v_rcp_f32 v99, v99
  v_rcp_f32 v100, v100
  v_rcp_f32 v101, v101
  v_rcp_f32 v102, v102
  v_rcp_f32 v103, v103
  s_nop 0
  v_pk_mul_f32 v[56:57], v[56:57], v[96:97]
  v_pk_mul_f32 v[58:59], v[58:59], v[98:99]
  v_pk_mul_f32 v[60:61], v[60:61], v[100:101]
  v_pk_mul_f32 v[62:63], v[62:63], v[102:103]
  v_cvt_pk_bf16_f32 v128, v56, v57
  v_cvt_pk_bf16_f32 v129, v58, v59
  v_cvt_pk_bf16_f32 v130, v60, v61
  v_cvt_pk_bf16_f32 v131, v62, v63
  buffer_store_dwordx4 v[128:131], v3, s[28:31], s46 offen offset:3072 sc1
L_c1_kernel_g1_end_1:
  s_branch L_c1_kernel_g1d_6
L_c1_kernel_g1d_6:
  s_waitcnt vmcnt(0) lgkmcnt(0)
  s_barrier
  s_cmp_lg_u32 s93, 0
  s_cbranch_scc1 L_c1_kernel_pub_7
  s_lshl_b32 s18, s16, 6
  s_lshl_b32 s19, s17, 2
  s_add_u32 s18, s18, s19
  s_add_u32 s18, s18, 1024
  v_mov_b32 v1, 1
  v_mov_b32 v2, 0
  s_mov_b64 exec, 1
  buffer_store_dword v1, v2, s[84:87], s18 offen sc1
  s_mov_b64 exec, -1
L_c1_kernel_pub_7:
L_c1_kernel_g2_5:
  v_mov_b32 v0, v255
  s_mov_b32 s2, s95
  s_mov_b32 s3, s93
  s_cmp_ge_u32 s3, 4
  s_cbranch_scc1 L_c1_kernel_end_1
  s_load_dwordx2 s[6:7], s[0:1], 80
  s_load_dwordx2 s[4:5], s[0:1], 56
  s_load_dwordx2 s[48:49], s[0:1], 64
  v_lshrrev_b32 v2, 6, v0
  v_and_b32 v1, 63, v0
  v_readfirstlane_b32 s3, v2
  s_bfe_u32 s17, s2, 0x30003
  s_lshr_b32 s16, s2, 6
  s_lshl_b32 s16, s16, 3
  s_and_b32 s18, s2, 7
  s_add_u32 s16, s16, s18
  v_lshlrev_b32 v3, 4, v1
  s_waitcnt lgkmcnt(0)
  s_add_u32 s8, s6, 27262976
  s_addc_u32 s9, s7, 0
  s_mov_b32 s10, 1835008
  s_mov_b32 s11, 0x00020000
  s_add_u32 s12, s6, 16777216
  s_addc_u32 s13, s7, 0
  s_mov_b32 s14, 7340032
  s_mov_b32 s15, 0x00020000
  s_mov_b32 s24, s4
  s_mov_b32 s25, s5
  s_mov_b32 s26, 1024
  s_mov_b32 s27, 0x00020000
  s_add_u32 s28, s6, 14680064
  s_addc_u32 s29, s7, 0
  s_mov_b32 s30, 2097152
  s_mov_b32 s31, 0x00020000
  s_mov_b32 s32, s48
  s_mov_b32 s33, s49
  s_mov_b32 s34, 2097152
  s_mov_b32 s35, 0x00020000
  s_mul_i32 s36, s3, 28672
  s_mul_i32 s37, s17, 229376
  s_add_u32 s37, s37, s36
  s_add_u32 s38, s37, 114688
  s_mul_i32 s39, s16, 229376
  s_add_u32 s39, s39, s36
  s_add_u32 s40, s39, 114688
  buffer_load_dwordx4 v[80:83], v3, s[8:11], s37 offen offset:0
  buffer_load_dwordx4 v[84:87], v3, s[8:11], s38 offen offset:0
  buffer_load_dwordx4 v[96:99], v3, s[8:11], s37 offen offset:1024
  buffer_load_dwordx4 v[100:103], v3, s[8:11], s38 offen offset:1024
  buffer_load_dwordx4 v[112:115], v3, s[8:11], s37 offen offset:2048
  buffer_load_dwordx4 v[116:119], v3, s[8:11], s38 offen offset:2048
  buffer_load_dwordx4 v[128:131], v3, s[8:11], s37 offen offset:3072
  buffer_load_dwordx4 v[132:135], v3, s[8:11], s38 offen offset:3072
  s_add_u32 s37, s37, 4096
  s_add_u32 s38, s38, 4096
  buffer_load_dwordx4 v[144:147], v3, s[8:11], s37 offen offset:0
  buffer_load_dwordx4 v[148:151], v3, s[8:11], s38 offen offset:0
  buffer_load_dwordx4 v[160:163], v3, s[8:11], s37 offen offset:1024
  buffer_load_dwordx4 v[164:167], v3, s[8:11], s38 offen offset:1024
  buffer_load_dwordx4 v[176:179], v3, s[8:11], s37 offen offset:2048
  buffer_load_dwordx4 v[180:183], v3, s[8:11], s38 offen offset:2048
  buffer_load_dwordx4 v[192:195], v3, s[8:11], s37 offen offset:3072
  buffer_load_dwordx4 v[196:199], v3, s[8:11], s38 offen offset:3072
  s_add_u32 s37, s37, 4096
  s_add_u32 s38, s38, 4096
  s_cmp_lg_u32 s93, 0
  s_cbranch_scc1 L_c1_kernel_g2_hs_2
  s_lshr_b32 s50, s16, 1
  s_lshl_b32 s50, s50, 6
  s_add_u32 s50, s50, 1024
  v_lshlrev_b32 v8, 2, v1
  s_mov_b32 s51, 0
  s_mov_b32 exec_lo, 0x3fff
  s_mov_b32 exec_hi, 0
L_c1_kernel_g2_hl_3:
  buffer_load_dword v9, v8, s[84:87], s50 offen sc1
  s_add_u32 s51, s51, 1
  s_waitcnt vmcnt(0)
  v_cmp_ne_u32 vcc, 1, v9
  s_cmp_ge_u32 s51, 400000
  s_cbranch_scc1 L_c1_kernel_g2_ho_4
  s_cbranch_vccz L_c1_kernel_g2_ho_4
  s_sleep 6
  s_branch L_c1_kernel_g2_hl_3
L_c1_kernel_g2_ho_4:
  s_mov_b64 exec, -1
L_c1_kernel_g2_hs_2:
  s_barrier
  buffer_load_dwordx4 v[88:91], v3, s[12:15], s39 offen offset:0
  buffer_load_dwordx4 v[92:95], v3, s[12:15], s40 offen offset:0
  buffer_load_dwordx4 v[104:107], v3, s[12:15], s39 offen offset:1024
  buffer_load_dwordx4 v[108:111], v3, s[12:15], s40 offen offset:1024
  buffer_load_dwordx4 v[120:123], v3, s[12:15], s39 offen offset:2048
  buffer_load_dwordx4 v[124:127], v3, s[12:15], s40 offen offset:2048
  buffer_load_dwordx4 v[136:139], v3, s[12:15], s39 offen offset:3072
  buffer_load_dwordx4 v[140:143], v3, s[12:15], s40 offen offset:3072
  s_add_u32 s39, s39, 4096
  s_add_u32 s40, s40, 4096
  buffer_load_dwordx4 v[152:155], v3, s[12:15], s39 offen offset:0
  buffer_load_dwordx4 v[156:159], v3, s[12:15], s40 offen offset:0
  buffer_load_dwordx4 v[168:171], v3, s[12:15], s39 offen offset:1024
  buffer_load_dwordx4 v[172:175], v3, s[12:15], s40 offen offset:1024
  buffer_load_dwordx4 v[184:187], v3, s[12:15], s39 offen offset:2048
  buffer_load_dwordx4 v[188:191], v3, s[12:15], s40 offen offset:2048
  buffer_load_dwordx4 v[200:203], v3, s[12:15], s39 offen offset:3072
  buffer_load_dwordx4 v[204:207], v3, s[12:15], s40 offen offset:3072
  s_add_u32 s39, s39, 4096
  s_add_u32 s40, s40, 4096
  s_lshr_b32 s41, s3, 1
  s_and_b32 s42, s3, 1
  v_and_b32 v4, 31, v1
  v_lshrrev_b32 v5, 5, v1
  v_lshlrev_b32 v6, 4, v5
  v_lshl_add_u32 v7, v4, 10, v6
  s_lshl_b32 s43, s17, 1
  s_add_u32 s43, s43, s41
  s_lshl_b32 s43, s43, 6
  s_lshl_b32 s44, s16, 1
  s_add_u32 s44, s44, s42
  s_lshl_b32 s44, s44, 15
  s_add_u32 s44, s44, s43
  v_mov_b32 v16, 0
  v_mov_b32 v17, 0
  v_mov_b32 v18, 0
  v_mov_b32 v19, 0
  v_mov_b32 v20, 0
  v_mov_b32 v21, 0
  v_mov_b32 v22, 0
  v_mov_b32 v23, 0
  v_mov_b32 v24, 0
  v_mov_b32 v25, 0
  v_mov_b32 v26, 0
  v_mov_b32 v27, 0
  v_mov_b32 v28, 0
  v_mov_b32 v29, 0
  v_mov_b32 v30, 0
  v_mov_b32 v31, 0
  v_mov_b32 v32, 0
  v_mov_b32 v33, 0
  v_mov_b32 v34, 0
  v_mov_b32 v35, 0
  v_mov_b32 v36, 0
  v_mov_b32 v37, 0
  v_mov_b32 v38, 0
  v_mov_b32 v39, 0
  v_mov_b32 v40, 0
  v_mov_b32 v41, 0
  v_mov_b32 v42, 0
  v_mov_b32 v43, 0
  v_mov_b32 v44, 0
  v_mov_b32 v45, 0
  v_mov_b32 v46, 0
  v_mov_b32 v47, 0
  v_mov_b32 v48, 0
  v_mov_b32 v49, 0
  v_mov_b32 v50, 0
  v_mov_b32 v51, 0
  v_mov_b32 v52, 0
  v_mov_b32 v53, 0
  v_mov_b32 v54, 0
  v_mov_b32 v55, 0
  v_mov_b32 v56, 0
  v_mov_b32 v57, 0
  v_mov_b32 v58, 0
  v_mov_b32 v59, 0
  v_mov_b32 v60, 0
  v_mov_b32 v61, 0
  v_mov_b32 v62, 0
  v_mov_b32 v63, 0
  v_mov_b32 v64, 0
  v_mov_b32 v65, 0
  v_mov_b32 v66, 0
  v_mov_b32 v67, 0
  v_mov_b32 v68, 0
  v_mov_b32 v69, 0
  v_mov_b32 v70, 0
  v_mov_b32 v71, 0
  v_mov_b32 v72, 0
  v_mov_b32 v73, 0
  v_mov_b32 v74, 0
  v_mov_b32 v75, 0
  v_mov_b32 v76, 0
  v_mov_b32 v77, 0
  v_mov_b32 v78, 0
  v_mov_b32 v79, 0
  s_waitcnt vmcnt(14)
  v_mfma_f32_32x32x16_bf16 v[16:31], v[80:83], v[88:91], v[16:31]
  v_mfma_f32_32x32x16_bf16 v[32:47], v[80:83], v[92:95], v[32:47]
  v_mfma_f32_32x32x16_bf16 v[48:63], v[84:87], v[88:91], v[48:63]
  v_mfma_f32_32x32x16_bf16 v[64:79], v[84:87], v[92:95], v[64:79]
  buffer_load_dwordx4 v[80:83], v3, s[8:11], s37 offen offset:0
  buffer_load_dwordx4 v[84:87], v3, s[8:11], s38 offen offset:0
  buffer_load_dwordx4 v[88:91], v3, s[12:15], s39 offen offset:0
  buffer_load_dwordx4 v[92:95], v3, s[12:15], s40 offen offset:0
  s_waitcnt vmcnt(16)
  v_mfma_f32_32x32x16_bf16 v[16:31], v[96:99], v[104:107], v[16:31]
  v_mfma_f32_32x32x16_bf16 v[32:47], v[96:99], v[108:111], v[32:47]
  v_mfma_f32_32x32x16_bf16 v[48:63], v[100:103], v[104:107], v[48:63]
  v_mfma_f32_32x32x16_bf16 v[64:79], v[100:103], v[108:111], v[64:79]
  buffer_load_dwordx4 v[96:99], v3, s[8:11], s37 offen offset:1024
  buffer_load_dwordx4 v[100:103], v3, s[8:11], s38 offen offset:1024
  buffer_load_dwordx4 v[104:107], v3, s[12:15], s39 offen offset:1024
  buffer_load_dwordx4 v[108:111], v3, s[12:15], s40 offen offset:1024
  s_waitcnt vmcnt(18)
  v_mfma_f32_32x32x16_bf16 v[16:31], v[112:115], v[120:123], v[16:31]
  v_mfma_f32_32x32x16_bf16 v[32:47], v[112:115], v[124:127], v[32:47]
  v_mfma_f32_32x32x16_bf16 v[48:63], v[116:119], v[120:123], v[48:63]
  v_mfma_f32_32x32x16_bf16 v[64:79], v[116:119], v[124:127], v[64:79]
  buffer_load_dwordx4 v[112:115], v3, s[8:11], s37 offen offset:2048
  buffer_load_dwordx4 v[116:119], v3, s[8:11], s38 offen offset:2048
  buffer_load_dwordx4 v[120:123], v3, s[12:15], s39 offen offset:2048
  buffer_load_dwordx4 v[124:127], v3, s[12:15], s40 offen offset:2048
  s_waitcnt vmcnt(20)
  v_mfma_f32_32x32x16_bf16 v[16:31], v[128:131], v[136:139], v[16:31]
  v_mfma_f32_32x32x16_bf16 v[32:47], v[128:131], v[140:143], v[32:47]
  v_mfma_f32_32x32x16_bf16 v[48:63], v[132:135], v[136:139], v[48:63]
  v_mfma_f32_32x32x16_bf16 v[64:79], v[132:135], v[140:143], v[64:79]
  buffer_load_dwordx4 v[128:131], v3, s[8:11], s37 offen offset:3072
  buffer_load_dwordx4 v[132:135], v3, s[8:11], s38 offen offset:3072
  buffer_load_dwordx4 v[136:139], v3, s[12:15], s39 offen offset:3072
  buffer_load_dwordx4 v[140:143], v3, s[12:15], s40 offen offset:3072
  s_add_u32 s37, s37, 4096
  s_add_u32 s38, s38, 4096
  s_add_u32 s39, s39, 4096
  s_add_u32 s40, s40, 4096
  s_waitcnt vmcnt(22)
  v_mfma_f32_32x32x16_bf16 v[16:31], v[144:147], v[152:155], v[16:31]
  v_mfma_f32_32x32x16_bf16 v[32:47], v[144:147], v[156:159], v[32:47]
  v_mfma_f32_32x32x16_bf16 v[48:63], v[148:151], v[152:155], v[48:63]
  v_mfma_f32_32x32x16_bf16 v[64:79], v[148:151], v[156:159], v[64:79]
  buffer_load_dwordx4 v[144:147], v3, s[8:11], s37 offen offset:0
  buffer_load_dwordx4 v[148:151], v3, s[8:11], s38 offen offset:0
  buffer_load_dwordx4 v[152:155], v3, s[12:15], s39 offen offset:0
  buffer_load_dwordx4 v[156:159], v3, s[12:15], s40 offen offset:0
  s_waitcnt vmcnt(24)
  v_mfma_f32_32x32x16_bf16 v[16:31], v[160:163], v[168:171], v[16:31]
  v_mfma_f32_32x32x16_bf16 v[32:47], v[160:163], v[172:175], v[32:47]
  v_mfma_f32_32x32x16_bf16 v[48:63], v[164:167], v[168:171], v[48:63]
  v_mfma_f32_32x32x16_bf16 v[64:79], v[164:167], v[172:175], v[64:79]
  buffer_load_dwordx4 v[160:163], v3, s[8:11], s37 offen offset:1024
  buffer_load_dwordx4 v[164:167], v3, s[8:11], s38 offen offset:1024
  buffer_load_dwordx4 v[168:171], v3, s[12:15], s39 offen offset:1024
  buffer_load_dwordx4 v[172:175], v3, s[12:15], s40 offen offset:1024
  s_waitcnt vmcnt(26)
  v_mfma_f32_32x32x16_bf16 v[16:31], v[176:179], v[184:187], v[16:31]
  v_mfma_f32_32x32x16_bf16 v[32:47], v[176:179], v[188:191], v[32:47]
  v_mfma_f32_32x32x16_bf16 v[48:63], v[180:183], v[184:187], v[48:63]
  v_mfma_f32_32x32x16_bf16 v[64:79], v[180:183], v[188:191], v[64:79]
  buffer_load_dwordx4 v[176:179], v3, s[8:11], s37 offen offset:2048
  buffer_load_dwordx4 v[180:183], v3, s[8:11], s38 offen offset:2048
  buffer_load_dwordx4 v[184:187], v3, s[12:15], s39 offen offset:2048
  buffer_load_dwordx4 v[188:191], v3, s[12:15], s40 offen offset:2048
  s_waitcnt vmcnt(28)
  v_mfma_f32_32x32x16_bf16 v[16:31], v[192:195], v[200:203], v[16:31]
  v_mfma_f32_32x32x16_bf16 v[32:47], v[192:195], v[204:207], v[32:47]
  v_mfma_f32_32x32x16_bf16 v[48:63], v[196:199], v[200:203], v[48:63]
  v_mfma_f32_32x32x16_bf16 v[64:79], v[196:199], v[204:207], v[64:79]
  buffer_load_dwordx4 v[192:195], v3, s[8:11], s37 offen offset:3072
  buffer_load_dwordx4 v[196:199], v3, s[8:11], s38 offen offset:3072
  buffer_load_dwordx4 v[200:203], v3, s[12:15], s39 offen offset:3072
  buffer_load_dwordx4 v[204:207], v3, s[12:15], s40 offen offset:3072
  s_add_u32 s37, s37, 4096
  s_add_u32 s38, s38, 4096
  s_add_u32 s39, s39, 4096
  s_add_u32 s40, s40, 4096
  s_waitcnt vmcnt(28)
  v_mfma_f32_32x32x16_bf16 v[16:31], v[80:83], v[88:91], v[16:31]
  v_mfma_f32_32x32x16_bf16 v[32:47], v[80:83], v[92:95], v[32:47]
  v_mfma_f32_32x32x16_bf16 v[48:63], v[84:87], v[88:91], v[48:63]
  v_mfma_f32_32x32x16_bf16 v[64:79], v[84:87], v[92:95], v[64:79]
  buffer_load_dwordx4 v[80:83], v3, s[8:11], s37 offen offset:0
  buffer_load_dwordx4 v[84:87], v3, s[8:11], s38 offen offset:0
  buffer_load_dwordx4 v[88:91], v3, s[12:15], s39 offen offset:0
  buffer_load_dwordx4 v[92:95], v3, s[12:15], s40 offen offset:0
  s_waitcnt vmcnt(28)
  v_mfma_f32_32x32x16_bf16 v[16:31], v[96:99], v[104:107], v[16:31]
  v_mfma_f32_32x32x16_bf16 v[32:47], v[96:99], v[108:111], v[32:47]
  v_mfma_f32_32x32x16_bf16 v[48:63], v[100:103], v[104:107], v[48:63]
  v_mfma_f32_32x32x16_bf16 v[64:79], v[100:103], v[108:111], v[64:79]
  buffer_load_dwordx4 v[96:99], v3, s[8:11], s37 offen offset:1024
  buffer_load_dwordx4 v[100:103], v3, s[8:11], s38 offen offset:1024
  buffer_load_dwordx4 v[104:107], v3, s[12:15], s39 offen offset:1024
  buffer_load_dwordx4 v[108:111], v3, s[12:15], s40 offen offset:1024
  s_waitcnt vmcnt(28)
  v_mfma_f32_32x32x16_bf16 v[16:31], v[112:115], v[120:123], v[16:31]
  v_mfma_f32_32x32x16_bf16 v[32:47], v[112:115], v[124:127], v[32:47]
  v_mfma_f32_32x32x16_bf16 v[48:63], v[116:119], v[120:123], v[48:63]
  v_mfma_f32_32x32x16_bf16 v[64:79], v[116:119], v[124:127], v[64:79]
  buffer_load_dwordx4 v[112:115], v3, s[8:11], s37 offen offset:2048
  buffer_load_dwordx4 v[116:119], v3, s[8:11], s38 offen offset:2048
  buffer_load_dwordx4 v[120:123], v3, s[12:15], s39 offen offset:2048
  buffer_load_dwordx4 v[124:127], v3, s[12:15], s40 offen offset:2048
  s_waitcnt vmcnt(28)
  v_mfma_f32_32x32x16_bf16 v[16:31], v[128:131], v[136:139], v[16:31]
  v_mfma_f32_32x32x16_bf16 v[32:47], v[128:131], v[140:143], v[32:47]
  v_mfma_f32_32x32x16_bf16 v[48:63], v[132:135], v[136:139], v[48:63]
  v_mfma_f32_32x32x16_bf16 v[64:79], v[132:135], v[140:143], v[64:79]
  buffer_load_dwordx4 v[128:131], v3, s[8:11], s37 offen offset:3072
  buffer_load_dwordx4 v[132:135], v3, s[8:11], s38 offen offset:3072
  buffer_load_dwordx4 v[136:139], v3, s[12:15], s39 offen offset:3072
  buffer_load_dwordx4 v[140:143], v3, s[12:15], s40 offen offset:3072
  s_add_u32 s37, s37, 4096
  s_add_u32 s38, s38, 4096
  s_add_u32 s39, s39, 4096
  s_add_u32 s40, s40, 4096
  s_waitcnt vmcnt(28)
  v_mfma_f32_32x32x16_bf16 v[16:31], v[144:147], v[152:155], v[16:31]
  v_mfma_f32_32x32x16_bf16 v[32:47], v[144:147], v[156:159], v[32:47]
  v_mfma_f32_32x32x16_bf16 v[48:63], v[148:151], v[152:155], v[48:63]
  v_mfma_f32_32x32x16_bf16 v[64:79], v[148:151], v[156:159], v[64:79]
  buffer_load_dwordx4 v[144:147], v3, s[8:11], s37 offen offset:0
  buffer_load_dwordx4 v[148:151], v3, s[8:11], s38 offen offset:0
  buffer_load_dwordx4 v[152:155], v3, s[12:15], s39 offen offset:0
  buffer_load_dwordx4 v[156:159], v3, s[12:15], s40 offen offset:0
  s_waitcnt vmcnt(28)
  v_mfma_f32_32x32x16_bf16 v[16:31], v[160:163], v[168:171], v[16:31]
  v_mfma_f32_32x32x16_bf16 v[32:47], v[160:163], v[172:175], v[32:47]
  v_mfma_f32_32x32x16_bf16 v[48:63], v[164:167], v[168:171], v[48:63]
  v_mfma_f32_32x32x16_bf16 v[64:79], v[164:167], v[172:175], v[64:79]
  buffer_load_dwordx4 v[160:163], v3, s[8:11], s37 offen offset:1024
  buffer_load_dwordx4 v[164:167], v3, s[8:11], s38 offen offset:1024
  buffer_load_dwordx4 v[168:171], v3, s[12:15], s39 offen offset:1024
  buffer_load_dwordx4 v[172:175], v3, s[12:15], s40 offen offset:1024
  s_waitcnt vmcnt(28)
  v_mfma_f32_32x32x16_bf16 v[16:31], v[176:179], v[184:187], v[16:31]
  v_mfma_f32_32x32x16_bf16 v[32:47], v[176:179], v[188:191], v[32:47]
  v_mfma_f32_32x32x16_bf16 v[48:63], v[180:183], v[184:187], v[48:63]
  v_mfma_f32_32x32x16_bf16 v[64:79], v[180:183], v[188:191], v[64:79]
  buffer_load_dwordx4 v[176:179], v3, s[8:11], s37 offen offset:2048
  buffer_load_dwordx4 v[180:183], v3, s[8:11], s38 offen offset:2048
  buffer_load_dwordx4 v[184:187], v3, s[12:15], s39 offen offset:2048
  buffer_load_dwordx4 v[188:191], v3, s[12:15], s40 offen offset:2048
  s_waitcnt vmcnt(28)
  v_mfma_f32_32x32x16_bf16 v[16:31], v[192:195], v[200:203], v[16:31]
  v_mfma_f32_32x32x16_bf16 v[32:47], v[192:195], v[204:207], v[32:47]
  v_mfma_f32_32x32x16_bf16 v[48:63], v[196:199], v[200:203], v[48:63]
  v_mfma_f32_32x32x16_bf16 v[64:79], v[196:199], v[204:207], v[64:79]
  buffer_load_dwordx4 v[192:195], v3, s[8:11], s37 offen offset:3072
  buffer_load_dwordx4 v[196:199], v3, s[8:11], s38 offen offset:3072
  buffer_load_dwordx4 v[200:203], v3, s[12:15], s39 offen offset:3072
  buffer_load_dwordx4 v[204:207], v3, s[12:15], s40 offen offset:3072
  s_add_u32 s37, s37, 4096
  s_add_u32 s38, s38, 4096
  s_add_u32 s39, s39, 4096
  s_add_u32 s40, s40, 4096
  s_waitcnt vmcnt(28)
  v_mfma_f32_32x32x16_bf16 v[16:31], v[80:83], v[88:91], v[16:31]
  v_mfma_f32_32x32x16_bf16 v[32:47], v[80:83], v[92:95], v[32:47]
  v_mfma_f32_32x32x16_bf16 v[48:63], v[84:87], v[88:91], v[48:63]
  v_mfma_f32_32x32x16_bf16 v[64:79], v[84:87], v[92:95], v[64:79]
  buffer_load_dwordx4 v[80:83], v3, s[8:11], s37 offen offset:0
  buffer_load_dwordx4 v[84:87], v3, s[8:11], s38 offen offset:0
  buffer_load_dwordx4 v[88:91], v3, s[12:15], s39 offen offset:0
  buffer_load_dwordx4 v[92:95], v3, s[12:15], s40 offen offset:0
  s_waitcnt vmcnt(28)
  v_mfma_f32_32x32x16_bf16 v[16:31], v[96:99], v[104:107], v[16:31]
  v_mfma_f32_32x32x16_bf16 v[32:47], v[96:99], v[108:111], v[32:47]
  v_mfma_f32_32x32x16_bf16 v[48:63], v[100:103], v[104:107], v[48:63]
  v_mfma_f32_32x32x16_bf16 v[64:79], v[100:103], v[108:111], v[64:79]
  buffer_load_dwordx4 v[96:99], v3, s[8:11], s37 offen offset:1024
  buffer_load_dwordx4 v[100:103], v3, s[8:11], s38 offen offset:1024
  buffer_load_dwordx4 v[104:107], v3, s[12:15], s39 offen offset:1024
  buffer_load_dwordx4 v[108:111], v3, s[12:15], s40 offen offset:1024
  s_waitcnt vmcnt(28)
  v_mfma_f32_32x32x16_bf16 v[16:31], v[112:115], v[120:123], v[16:31]
  v_mfma_f32_32x32x16_bf16 v[32:47], v[112:115], v[124:127], v[32:47]
  v_mfma_f32_32x32x16_bf16 v[48:63], v[116:119], v[120:123], v[48:63]
  v_mfma_f32_32x32x16_bf16 v[64:79], v[116:119], v[124:127], v[64:79]
  buffer_load_dwordx4 v[112:115], v3, s[8:11], s37 offen offset:2048
  buffer_load_dwordx4 v[116:119], v3, s[8:11], s38 offen offset:2048
  buffer_load_dwordx4 v[120:123], v3, s[12:15], s39 offen offset:2048
  buffer_load_dwordx4 v[124:127], v3, s[12:15], s40 offen offset:2048
  s_waitcnt vmcnt(28)
  v_mfma_f32_32x32x16_bf16 v[16:31], v[128:131], v[136:139], v[16:31]
  v_mfma_f32_32x32x16_bf16 v[32:47], v[128:131], v[140:143], v[32:47]
  v_mfma_f32_32x32x16_bf16 v[48:63], v[132:135], v[136:139], v[48:63]
  v_mfma_f32_32x32x16_bf16 v[64:79], v[132:135], v[140:143], v[64:79]
  buffer_load_dwordx4 v[128:131], v3, s[8:11], s37 offen offset:3072
  buffer_load_dwordx4 v[132:135], v3, s[8:11], s38 offen offset:3072
  buffer_load_dwordx4 v[136:139], v3, s[12:15], s39 offen offset:3072
  buffer_load_dwordx4 v[140:143], v3, s[12:15], s40 offen offset:3072
  s_add_u32 s37, s37, 4096
  s_add_u32 s38, s38, 4096
  s_add_u32 s39, s39, 4096
  s_add_u32 s40, s40, 4096
  s_waitcnt vmcnt(28)
  v_mfma_f32_32x32x16_bf16 v[16:31], v[144:147], v[152:155], v[16:31]
  v_mfma_f32_32x32x16_bf16 v[32:47], v[144:147], v[156:159], v[32:47]
  v_mfma_f32_32x32x16_bf16 v[48:63], v[148:151], v[152:155], v[48:63]
  v_mfma_f32_32x32x16_bf16 v[64:79], v[148:151], v[156:159], v[64:79]
  buffer_load_dwordx4 v[208:211], v7, s[28:31], s44 offen
  buffer_load_dwordx4 v[212:215], v7, s[28:31], s44 offen offset:32
  buffer_load_dwordx4 v[216:219], v6, s[24:27], s43 offen
  buffer_load_dwordx4 v[220:223], v6, s[24:27], s43 offen offset:32
  s_waitcnt vmcnt(28)
  v_mfma_f32_32x32x16_bf16 v[16:31], v[160:163], v[168:171], v[16:31]
  v_mfma_f32_32x32x16_bf16 v[32:47], v[160:163], v[172:175], v[32:47]
  v_mfma_f32_32x32x16_bf16 v[48:63], v[164:167], v[168:171], v[48:63]
  v_mfma_f32_32x32x16_bf16 v[64:79], v[164:167], v[172:175], v[64:79]
  s_waitcnt vmcnt(24)
  v_mfma_f32_32x32x16_bf16 v[16:31], v[176:179], v[184:187], v[16:31]
  v_mfma_f32_32x32x16_bf16 v[32:47], v[176:179], v[188:191], v[32:47]
  v_mfma_f32_32x32x16_bf16 v[48:63], v[180:183], v[184:187], v[48:63]
  v_mfma_f32_32x32x16_bf16 v[64:79], v[180:183], v[188:191], v[64:79]
  s_waitcnt vmcnt(20)
  v_mfma_f32_32x32x16_bf16 v[16:31], v[192:195], v[200:203], v[16:31]
  v_mfma_f32_32x32x16_bf16 v[32:47], v[192:195], v[204:207], v[32:47]
  v_mfma_f32_32x32x16_bf16 v[48:63], v[196:199], v[200:203], v[48:63]
  v_mfma_f32_32x32x16_bf16 v[64:79], v[196:199], v[204:207], v[64:79]
  s_waitcnt vmcnt(16)
  v_mfma_f32_32x32x16_bf16 v[16:31], v[80:83], v[88:91], v[16:31]
  v_mfma_f32_32x32x16_bf16 v[32:47], v[80:83], v[92:95], v[32:47]
  v_mfma_f32_32x32x16_bf16 v[48:63], v[84:87], v[88:91], v[48:63]
  v_mfma_f32_32x32x16_bf16 v[64:79], v[84:87], v[92:95], v[64:79]
  s_waitcnt vmcnt(12)
  v_mfma_f32_32x32x16_bf16 v[16:31], v[96:99], v[104:107], v[16:31]
  v_mfma_f32_32x32x16_bf16 v[32:47], v[96:99], v[108:111], v[32:47]
  v_mfma_f32_32x32x16_bf16 v[48:63], v[100:103], v[104:107], v[48:63]
  v_mfma_f32_32x32x16_bf16 v[64:79], v[100:103], v[108:111], v[64:79]
  s_waitcnt vmcnt(8)
  v_mfma_f32_32x32x16_bf16 v[16:31], v[112:115], v[120:123], v[16:31]
  v_mfma_f32_32x32x16_bf16 v[32:47], v[112:115], v[124:127], v[32:47]
  v_mfma_f32_32x32x16_bf16 v[48:63], v[116:119], v[120:123], v[48:63]
  v_mfma_f32_32x32x16_bf16 v[64:79], v[116:119], v[124:127], v[64:79]
  s_waitcnt vmcnt(4)
  v_mfma_f32_32x32x16_bf16 v[16:31], v[128:131], v[136:139], v[16:31]
  v_mfma_f32_32x32x16_bf16 v[32:47], v[128:131], v[140:143], v[32:47]
  v_mfma_f32_32x32x16_bf16 v[48:63], v[132:135], v[136:139], v[48:63]
  v_mfma_f32_32x32x16_bf16 v[64:79], v[132:135], v[140:143], v[64:79]
  s_lshl_b32 s45, s3, 14
  v_add_u32 v8, s45, v3
  s_lshl_b32 s45, s3, 12
  v_add_u32 v9, s45, v3
  s_nop 7
  s_nop 3
  ds_write_b128 v8, v[16:19] offset:0
  ds_write_b128 v8, v[20:23] offset:1024
  ds_write_b128 v8, v[24:27] offset:2048
  ds_write_b128 v8, v[28:31] offset:3072
  ds_write_b128 v8, v[32:35] offset:4096
  ds_write_b128 v8, v[36:39] offset:5120
  ds_write_b128 v8, v[40:43] offset:6144
  ds_write_b128 v8, v[44:47] offset:7168
  ds_write_b128 v8, v[48:51] offset:8192
  ds_write_b128 v8, v[52:55] offset:9216
  ds_write_b128 v8, v[56:59] offset:10240
  ds_write_b128 v8, v[60:63] offset:11264
  ds_write_b128 v8, v[64:67] offset:12288
  ds_write_b128 v8, v[68:71] offset:13312
  ds_write_b128 v8, v[72:75] offset:14336
  ds_write_b128 v8, v[76:79] offset:15360
  s_waitcnt lgkmcnt(0)
  s_barrier
  ds_read_b128 v[80:83], v9 offset:0
  ds_read_b128 v[84:87], v9 offset:1024
  ds_read_b128 v[88:91], v9 offset:2048
  ds_read_b128 v[92:95], v9 offset:3072
  ds_read_b128 v[96:99], v9 offset:16384
  ds_read_b128 v[100:103], v9 offset:17408
  ds_read_b128 v[104:107], v9 offset:18432
  ds_read_b128 v[108:111], v9 offset:19456
  ds_read_b128 v[112:115], v9 offset:32768
  ds_read_b128 v[116:119], v9 offset:33792
  ds_read_b128 v[120:123], v9 offset:34816
  ds_read_b128 v[124:127], v9 offset:35840
  ds_read_b128 v[128:131], v9 offset:49152
  ds_read_b128 v[132:135], v9 offset:50176
  ds_read_b128 v[136:139], v9 offset:51200
  ds_read_b128 v[140:143], v9 offset:52224
  s_waitcnt lgkmcnt(0)
  v_pk_add_f32 v[80:81], v[80:81], v[96:97]
  v_pk_add_f32 v[112:113], v[112:113], v[128:129]
  v_pk_add_f32 v[82:83], v[82:83], v[98:99]
  v_pk_add_f32 v[114:115], v[114:115], v[130:131]
  v_pk_add_f32 v[84:85], v[84:85], v[100:101]
  v_pk_add_f32 v[116:117], v[116:117], v[132:133]
  v_pk_add_f32 v[86:87], v[86:87], v[102:103]
  v_pk_add_f32 v[118:119], v[118:119], v[134:135]
  v_pk_add_f32 v[88:89], v[88:89], v[104:105]
  v_pk_add_f32 v[120:121], v[120:121], v[136:137]
  v_pk_add_f32 v[90:91], v[90:91], v[106:107]
  v_pk_add_f32 v[122:123], v[122:123], v[138:139]
  v_pk_add_f32 v[92:93], v[92:93], v[108:109]
  v_pk_add_f32 v[124:125], v[124:125], v[140:141]
  v_pk_add_f32 v[94:95], v[94:95], v[110:111]
  v_pk_add_f32 v[126:127], v[126:127], v[142:143]
  v_pk_add_f32 v[80:81], v[80:81], v[112:113]
  v_pk_add_f32 v[82:83], v[82:83], v[114:115]
  v_pk_add_f32 v[84:85], v[84:85], v[116:117]
  v_pk_add_f32 v[86:87], v[86:87], v[118:119]
  v_pk_add_f32 v[88:89], v[88:89], v[120:121]
  v_pk_add_f32 v[90:91], v[90:91], v[122:123]
  v_pk_add_f32 v[92:93], v[92:93], v[124:125]
  v_pk_add_f32 v[94:95], v[94:95], v[126:127]
  s_waitcnt vmcnt(0)
  v_cvt_pk_bf16_f32 v16, v80, v81
  v_lshlrev_b32 v80, 16, v16
  v_and_b32 v81, 0xffff0000, v16
  v_lshlrev_b32 v18, 16, v216
  v_and_b32 v19, 0xffff0000, v216
  v_pk_add_f32 v[80:81], v[80:81], v[18:19]
  v_cvt_pk_bf16_f32 v16, v80, v81
  v_lshlrev_b32 v80, 16, v16
  v_and_b32 v81, 0xffff0000, v16
  v_lshlrev_b32 v18, 16, v208
  v_and_b32 v19, 0xffff0000, v208
  v_pk_add_f32 v[80:81], v[80:81], v[18:19]
  v_cvt_pk_bf16_f32 v24, v80, v81
  v_cvt_pk_bf16_f32 v16, v82, v83
  v_lshlrev_b32 v82, 16, v16
  v_and_b32 v83, 0xffff0000, v16
  v_lshlrev_b32 v18, 16, v217
  v_and_b32 v19, 0xffff0000, v217
  v_pk_add_f32 v[82:83], v[82:83], v[18:19]
  v_cvt_pk_bf16_f32 v16, v82, v83
  v_lshlrev_b32 v82, 16, v16
  v_and_b32 v83, 0xffff0000, v16
  v_lshlrev_b32 v18, 16, v209
  v_and_b32 v19, 0xffff0000, v209
  v_pk_add_f32 v[82:83], v[82:83], v[18:19]
  v_cvt_pk_bf16_f32 v25, v82, v83
  v_cvt_pk_bf16_f32 v16, v84, v85
  v_lshlrev_b32 v84, 16, v16
  v_and_b32 v85, 0xffff0000, v16
  v_lshlrev_b32 v18, 16, v218
  v_and_b32 v19, 0xffff0000, v218
  v_pk_add_f32 v[84:85], v[84:85], v[18:19]
  v_cvt_pk_bf16_f32 v16, v84, v85
  v_lshlrev_b32 v84, 16, v16
  v_and_b32 v85, 0xffff0000, v16
  v_lshlrev_b32 v18, 16, v210
  v_and_b32 v19, 0xffff0000, v210
  v_pk_add_f32 v[84:85], v[84:85], v[18:19]
  v_cvt_pk_bf16_f32 v26, v84, v85
  v_cvt_pk_bf16_f32 v16, v86, v87
  v_lshlrev_b32 v86, 16, v16
  v_and_b32 v87, 0xffff0000, v16
  v_lshlrev_b32 v18, 16, v219
  v_and_b32 v19, 0xffff0000, v219
  v_pk_add_f32 v[86:87], v[86:87], v[18:19]
  v_cvt_pk_bf16_f32 v16, v86, v87
  v_lshlrev_b32 v86, 16, v16
  v_and_b32 v87, 0xffff0000, v16
  v_lshlrev_b32 v18, 16, v211
  v_and_b32 v19, 0xffff0000, v211
  v_pk_add_f32 v[86:87], v[86:87], v[18:19]
  v_cvt_pk_bf16_f32 v27, v86, v87
  v_cvt_pk_bf16_f32 v16, v88, v89
  v_lshlrev_b32 v88, 16, v16
  v_and_b32 v89, 0xffff0000, v16
  v_lshlrev_b32 v18, 16, v220
  v_and_b32 v19, 0xffff0000, v220
  v_pk_add_f32 v[88:89], v[88:89], v[18:19]
  v_cvt_pk_bf16_f32 v16, v88, v89
  v_lshlrev_b32 v88, 16, v16
  v_and_b32 v89, 0xffff0000, v16
  v_lshlrev_b32 v18, 16, v212
  v_and_b32 v19, 0xffff0000, v212
  v_pk_add_f32 v[88:89], v[88:89], v[18:19]
  v_cvt_pk_bf16_f32 v28, v88, v89
  v_cvt_pk_bf16_f32 v16, v90, v91
  v_lshlrev_b32 v90, 16, v16
  v_and_b32 v91, 0xffff0000, v16
  v_lshlrev_b32 v18, 16, v221
  v_and_b32 v19, 0xffff0000, v221
  v_pk_add_f32 v[90:91], v[90:91], v[18:19]
  v_cvt_pk_bf16_f32 v16, v90, v91
  v_lshlrev_b32 v90, 16, v16
  v_and_b32 v91, 0xffff0000, v16
  v_lshlrev_b32 v18, 16, v213
  v_and_b32 v19, 0xffff0000, v213
  v_pk_add_f32 v[90:91], v[90:91], v[18:19]
  v_cvt_pk_bf16_f32 v29, v90, v91
  v_cvt_pk_bf16_f32 v16, v92, v93
  v_lshlrev_b32 v92, 16, v16
  v_and_b32 v93, 0xffff0000, v16
  v_lshlrev_b32 v18, 16, v222
  v_and_b32 v19, 0xffff0000, v222
  v_pk_add_f32 v[92:93], v[92:93], v[18:19]
  v_cvt_pk_bf16_f32 v16, v92, v93
  v_lshlrev_b32 v92, 16, v16
  v_and_b32 v93, 0xffff0000, v16
  v_lshlrev_b32 v18, 16, v214
  v_and_b32 v19, 0xffff0000, v214
  v_pk_add_f32 v[92:93], v[92:93], v[18:19]
  v_cvt_pk_bf16_f32 v30, v92, v93
  v_cvt_pk_bf16_f32 v16, v94, v95
  v_lshlrev_b32 v94, 16, v16
  v_and_b32 v95, 0xffff0000, v16
  v_lshlrev_b32 v18, 16, v223
  v_and_b32 v19, 0xffff0000, v223
  v_pk_add_f32 v[94:95], v[94:95], v[18:19]
  v_cvt_pk_bf16_f32 v16, v94, v95
  v_lshlrev_b32 v94, 16, v16
  v_and_b32 v95, 0xffff0000, v16
  v_lshlrev_b32 v18, 16, v215
  v_and_b32 v19, 0xffff0000, v215
  v_pk_add_f32 v[94:95], v[94:95], v[18:19]
  v_cvt_pk_bf16_f32 v31, v94, v95
  buffer_store_dwordx4 v[24:27], v7, s[32:35], s44 offen
  buffer_store_dwordx4 v[28:31], v7, s[32:35], s44 offen offset:32
L_c1_kernel_g2_end_1:
  s_branch L_c1_kernel_end_1
L_c1_kernel_end_1:
  s_endpgm
.section .rodata,"a"
.p2align 6
.amdhsa_kernel p1a_kernel
  .amdhsa_next_free_vgpr 80
  .amdhsa_next_free_sgpr 96
  .amdhsa_accum_offset 80
  .amdhsa_group_segment_fixed_size 0
  .amdhsa_kernarg_size 88
  .amdhsa_user_sgpr_count 2
  .amdhsa_user_sgpr_kernarg_segment_ptr 1
  .amdhsa_system_sgpr_workgroup_id_x 1
.end_amdhsa_kernel
.p2align 6
.amdhsa_kernel p2_kernel
  .amdhsa_next_free_vgpr 104
  .amdhsa_next_free_sgpr 96
  .amdhsa_accum_offset 104
  .amdhsa_group_segment_fixed_size 0
  .amdhsa_kernarg_size 88
  .amdhsa_user_sgpr_count 2
  .amdhsa_user_sgpr_kernarg_segment_ptr 1
  .amdhsa_system_sgpr_workgroup_id_x 1
.end_amdhsa_kernel
.p2align 6
.amdhsa_kernel c0_kernel
  .amdhsa_next_free_vgpr 256
  .amdhsa_next_free_sgpr 100
  .amdhsa_accum_offset 256
  .amdhsa_group_segment_fixed_size 0
  .amdhsa_kernarg_size 88
  .amdhsa_user_sgpr_count 2
  .amdhsa_user_sgpr_kernarg_segment_ptr 1
  .amdhsa_system_sgpr_workgroup_id_x 1
.end_amdhsa_kernel
.p2align 6
.amdhsa_kernel c1_kernel
  .amdhsa_next_free_vgpr 256
  .amdhsa_next_free_sgpr 100
  .amdhsa_accum_offset 256
  .amdhsa_group_segment_fixed_size 0
  .amdhsa_kernarg_size 88
  .amdhsa_user_sgpr_count 2
  .amdhsa_user_sgpr_kernarg_segment_ptr 1
  .amdhsa_system_sgpr_workgroup_id_x 1
.end_amdhsa_kernel
```
